```python
import torch

def _softmax(x, axis=-1):
    return torch.softmax(x, dim=axis)

def _gelu(x):
    return torch.nn.functional.gelu(x, approximate='tanh')

def _silu(x):
    return torch.nn.functional.silu(x)

def _sigmoid(x):
    return torch.sigmoid(x)

def _layernorm(x, axis=-1, eps=1e-05):
    m = x.mean(dim=axis, keepdim=True)
    v = x.var(dim=axis, keepdim=True, unbiased=False)
    return (x - m) / torch.sqrt(v + eps)

def _scatter_add(tgt, idx, src, axis=0):
    return tgt.clone().index_add_(axis, idx, src)

def _segment_sum(src, seg, n):
    out = torch.zeros((n,) + src.shape[1:], dtype=src.dtype)
    return out.index_add_(0, seg, src)

def _pad(x, pw):
    flat = tuple((v for pair in reversed(pw) for v in pair))
    return torch.nn.functional.pad(x, flat)
kernel_name = 'concat_heads__softmax_full_mha__memory_aug_recurrent_mem_tr__prompt'

def setup_inputs():

    _w = lambda a: (lambda t: t.to(torch.bfloat16) if t.is_floating_point() else t)(torch.as_tensor(a))

    def _A_setup():
        B, S, D = (1, 2048, 640)
        return {'x': _w((lambda *s: torch.randn(*s, dtype=torch.bfloat16) * 0.2)(B, S, D)), 'wqkv': _w((lambda *s: torch.randn(*s, dtype=torch.bfloat16) * 0.2)(D, 3 * D)), 'wo': _w((lambda *s: torch.randn(*s, dtype=torch.bfloat16) * 0.05)(D, D))}
    _A_in = _A_setup()

    def _B_setup():
        B, S, Dm = (1, 2048, 640)
        H, Dh = (32, 128)
        M, seg = (8, 32)
        seg = min(seg, S)
        S = S // seg * seg
        return {'x': _w((lambda *s: torch.randn(*s, dtype=torch.bfloat16) * 0.05)(B, S, Dm)), 'mem0': _w((lambda *s: torch.randn(*s, dtype=torch.bfloat16) * 0.8)(B, M, Dm)), 'Wq': _w((lambda *s: torch.randn(*s, dtype=torch.bfloat16) * 1.6)(Dm, H, Dh) * Dm ** (-0.5)), 'Wk': _w((lambda *s: torch.randn(*s, dtype=torch.bfloat16) * 1.6)(Dm, H, Dh) * Dm ** (-0.5)), 'Wv': _w((lambda *s: torch.randn(*s, dtype=torch.bfloat16) * 0.8)(Dm, H, Dh) * Dm ** (-0.5)), 'Wo': _w((lambda *s: torch.randn(*s, dtype=torch.bfloat16) * 0.8)(H, Dh, Dm) * (H * Dh) ** (-0.5)), 'seg_len': seg}
    _B_in = _B_setup()
    return {'A_x': _A_in['x'], 'A_wqkv': _A_in['wqkv'], 'A_wo': _A_in['wo'], 'B_x': _B_in['x'], 'B_mem0': _B_in['mem0'], 'B_Wq': _B_in['Wq'], 'B_Wk': _B_in['Wk'], 'B_Wv': _B_in['Wv'], 'B_Wo': _B_in['Wo'], 'B_seg_len': _B_in['seg_len']}

def reference(A_x, A_wqkv, A_wo, B_x, B_mem0, B_Wq, B_Wk, B_Wv, B_Wo, B_seg_len):

    def _A_ref(x, wqkv, wo):
        B, S, D = x.shape
        H = 32
        Dh = D // H
        qkv = (lambda x, *d: x.permute(*d))((x @ wqkv).reshape(B, S, 3, H, Dh), 2, 0, 3, 1, 4)
        q, k, v = (qkv[0], qkv[1], qkv[2])
        scale = Dh ** (-0.5)
        scores = torch.einsum('bhqd,bhkd->bhqk', q, k) * scale
        p = _softmax(scores, axis=-1)
        o = torch.einsum('bhqk,bhkd->bhqd', p, v)
        return (lambda x, *d: x.permute(*d))(o, 0, 2, 1, 3).reshape(B, S, D) @ wo

    def _B_ref(x, mem0, Wq, Wk, Wv, Wo, seg_len):
        B, S, Dm = x.shape
        H, Dh = (Wq.shape[1], Wq.shape[2])
        M = mem0.shape[1]
        scale = Dh ** (-0.5)
        n_seg = S // seg_len
        L = M + seg_len
        idx = torch.arange(L)
        mask = (idx[:, None] < M) | (idx[:, None] >= idx[None, :])
        mem = mem0
        outs = []
        for s in range(n_seg):
            xs = x[:, s * seg_len:(s + 1) * seg_len, :].clone()
            h = torch.concatenate([mem, xs], axis=1)
            q = torch.einsum('btd,dhe->bhte', h, Wq)
            k = torch.einsum('btd,dhe->bhte', h, Wk)
            v = torch.einsum('btd,dhe->bhte', h, Wv)
            scores = torch.einsum('bhqe,bhke->bhqk', q, k) * scale
            scores = torch.where(mask[None, None], scores, -1000000000.0)
            p = _softmax(scores, axis=-1)
            o = torch.einsum('bhqk,bhke->bhqe', p, v)
            o = torch.einsum('bhte,hed->btd', o, Wo)
            mem = o[:, :M, :].clone()
            outs.append(o[:, M:, :])
        return torch.concatenate(outs, axis=1)
    a = _A_ref(A_x, A_wqkv, A_wo)
    b = _B_ref(B_x, B_mem0, B_Wq, B_Wk, B_Wv, B_Wo, B_seg_len)
    return torch.concatenate([a, b], axis=-1)
```

```asm
; @launch grid=(256,1,1) block=(256,1,1) lds=163840
.amdgcn_target "amdgcn-amd-amdhsa--gfx950"
.text
.globl concat_heads__softmax_full_mha__memory_aug_recurrent_mem_tr__prompt_kernel
.p2align 8
.type concat_heads__softmax_full_mha__memory_aug_recurrent_mem_tr__prompt_kernel,@function
concat_heads__softmax_full_mha__memory_aug_recurrent_mem_tr__prompt_kernel:
    s_load_dwordx16 s[64:79], s[0:1], 0
    s_load_dwordx8 s[80:87], s[0:1], 64
    s_load_dwordx2 s[88:89], s[0:1], 96
    v_and_b32 v1, 63, v0
    v_lshrrev_b32 v2, 6, v0
    s_nop 0
    v_readfirstlane_b32 s24, v2
    v_and_b32 v2, 15, v1
    v_lshrrev_b32 v3, 4, v1
    s_waitcnt lgkmcnt(0)
    s_mov_b32 s4, s88
    s_mov_b32 s5, s89
    s_mov_b32 s6, 268435456
    s_mov_b32 s7, 0x00020000
    s_mov_b32 s16, s84
    s_mov_b32 s17, s85
    s_mov_b32 s18, 5242880
    s_mov_b32 s19, 0x00020000
    s_mov_b32 s20, s86
    s_mov_b32 s21, s87
    s_mov_b32 s22, 256
    s_mov_b32 s23, 0x00020000
    s_cmp_ge_u32 s2, 256
    s_cbranch_scc1 EXIT
    v_mov_b32 v4, 12
    s_cmp_lg_u32 s2, 0
    s_cbranch_scc1 XW
    s_getreg_b32 s31, hwreg(HW_REG_XCC_ID)
    s_and_b32 s31, s31, 7
    s_add_u32 s31, s31, 8
    v_mov_b32 v5, s31
    buffer_store_dword v5, v4, s[20:23], 0 offen sc1
    s_branch XD
XW:
    s_mov_b32 s30, 50000
XL:
    buffer_load_dword v5, v4, s[20:23], 0 offen sc1
    s_waitcnt vmcnt(0)
    v_readfirstlane_b32 s31, v5
    s_cmp_lg_u32 s31, 0
    s_cbranch_scc1 XD
    s_sub_u32 s30, s30, 1
    s_cmp_lg_u32 s30, 0
    s_cbranch_scc1 XL
    s_endpgm
XD:
    s_add_u32 s31, s31, s2
    s_and_b32 s31, s31, 7
    s_lshr_b32 s25, s2, 3
    s_cmp_eq_u32 s31, 0
    s_cbranch_scc1 R_QKR
    s_cmp_eq_u32 s31, 1
    s_cbranch_scc1 R_VO
    s_cmp_ge_u32 s31, 4
    s_cbranch_scc1 R_STR
    s_sub_u32 s31, s31, 2
    s_cmp_lt_u32 s25, 20
    s_cbranch_scc0 R_AUX
    s_mul_i32 s31, s31, 20
    s_add_u32 s25, s25, s31
    s_branch R_R
R_AUX:
    s_mul_i32 s31, s31, 12
    s_add_u32 s25, s25, s31
    s_sub_u32 s25, s25, 20
    s_cmp_lt_u32 s25, 16
    s_cbranch_scc1 R_MISC
R_AQ:
    s_mul_i32 s33, s25, 43
    s_lshr_b32 s33, s33, 8
    s_mul_i32 s32, s33, 6
    s_sub_u32 s32, s25, s32
    s_lshl_b32 s33, s33, 1
    s_mov_b32 s8, s66
    s_mov_b32 s9, s67
    s_mov_b32 s10, 2457600
    s_mov_b32 s11, 0x00020000
    s_mov_b32 s40, s64
    s_mov_b32 s41, s65
    s_mov_b32 s42, 2621440
    s_mov_b32 s43, 0x00020000
    v_add_u32 v9, 0, v1
    v_mul_u32_u24 v9, 1639, v9
    v_lshrrev_b32 v9, 16, v9
    v_mov_b32 v10, s24
    v_mul_u32_u24 v10, 8, v10
    v_add_u32 v10, v9, v10
    v_mul_u32_u24 v10, 3840, v10
    v_add_u32 v4, 0, v1
    v_mul_u32_u24 v5, 40, v9
    v_sub_u32 v4, v4, v5
    v_lshlrev_b32 v4, 4, v4
    v_add_u32 v10, v10, v4
    v_add_u32 v9, 64, v1
    v_mul_u32_u24 v9, 1639, v9
    v_lshrrev_b32 v9, 16, v9
    v_mov_b32 v11, s24
    v_mul_u32_u24 v11, 8, v11
    v_add_u32 v11, v9, v11
    v_mul_u32_u24 v11, 3840, v11
    v_add_u32 v4, 64, v1
    v_mul_u32_u24 v5, 40, v9
    v_sub_u32 v4, v4, v5
    v_lshlrev_b32 v4, 4, v4
    v_add_u32 v11, v11, v4
    v_add_u32 v9, 128, v1
    v_mul_u32_u24 v9, 1639, v9
    v_lshrrev_b32 v9, 16, v9
    v_mov_b32 v12, s24
    v_mul_u32_u24 v12, 8, v12
    v_add_u32 v12, v9, v12
    v_mul_u32_u24 v12, 3840, v12
    v_add_u32 v4, 128, v1
    v_mul_u32_u24 v5, 40, v9
    v_sub_u32 v4, v4, v5
    v_lshlrev_b32 v4, 4, v4
    v_add_u32 v12, v12, v4
    v_add_u32 v9, 192, v1
    v_mul_u32_u24 v9, 1639, v9
    v_lshrrev_b32 v9, 16, v9
    v_mov_b32 v13, s24
    v_mul_u32_u24 v13, 8, v13
    v_add_u32 v13, v9, v13
    v_mul_u32_u24 v13, 3840, v13
    v_add_u32 v4, 192, v1
    v_mul_u32_u24 v5, 40, v9
    v_sub_u32 v4, v4, v5
    v_lshlrev_b32 v4, 4, v4
    v_add_u32 v13, v13, v4
    v_add_u32 v9, 256, v1
    v_mul_u32_u24 v9, 1639, v9
    v_lshrrev_b32 v9, 16, v9
    v_mov_b32 v14, s24
    v_mul_u32_u24 v14, 8, v14
    v_add_u32 v14, v9, v14
    v_mul_u32_u24 v14, 3840, v14
    v_add_u32 v4, 256, v1
    v_mul_u32_u24 v5, 40, v9
    v_sub_u32 v4, v4, v5
    v_lshlrev_b32 v4, 4, v4
    v_add_u32 v14, v14, v4
    v_lshlrev_b32 v15, 3, v3
    v_and_b32 v4, 15, v1
    v_lshrrev_b32 v4, 2, v4
    v_add_u32 v15, v15, v4
    v_mul_u32_u24 v15, 640, v15
    v_mov_b32 v4, s24
    v_mul_u32_u24 v4, 160, v4
    v_add_u32 v15, v15, v4
    v_and_b32 v4, 3, v1
    v_lshlrev_b32 v4, 3, v4
    v_add_u32 v15, v15, v4
    v_add_u32 v16, 69632, v15
    s_mul_i32 s29, s32, 640
    s_mul_i32 s26, s24, 5120
    s_add_u32 m0, s26, 0
    s_add_u32 s27, s29, 0
    buffer_load_dwordx4 v10, s[8:11], s27 offen lds
    s_add_u32 m0, s26, 1024
    s_add_u32 s27, s29, 0
    buffer_load_dwordx4 v11, s[8:11], s27 offen lds
    s_add_u32 m0, s26, 2048
    s_add_u32 s27, s29, 0
    buffer_load_dwordx4 v12, s[8:11], s27 offen lds
    s_add_u32 m0, s26, 3072
    s_add_u32 s27, s29, 0
    buffer_load_dwordx4 v13, s[8:11], s27 offen lds
    s_add_u32 m0, s26, 4096
    s_add_u32 s27, s29, 0
    buffer_load_dwordx4 v14, s[8:11], s27 offen lds
    s_add_u32 m0, s26, 20480
    s_add_u32 s27, s29, 122880
    buffer_load_dwordx4 v10, s[8:11], s27 offen lds
    s_add_u32 m0, s26, 21504
    s_add_u32 s27, s29, 122880
    buffer_load_dwordx4 v11, s[8:11], s27 offen lds
    s_add_u32 m0, s26, 22528
    s_add_u32 s27, s29, 122880
    buffer_load_dwordx4 v12, s[8:11], s27 offen lds
    s_add_u32 m0, s26, 23552
    s_add_u32 s27, s29, 122880
    buffer_load_dwordx4 v13, s[8:11], s27 offen lds
    s_add_u32 m0, s26, 24576
    s_add_u32 s27, s29, 122880
    buffer_load_dwordx4 v14, s[8:11], s27 offen lds
    s_add_u32 m0, s26, 69632
    s_add_u32 s27, s29, 245760
    buffer_load_dwordx4 v10, s[8:11], s27 offen lds
    s_add_u32 m0, s26, 70656
    s_add_u32 s27, s29, 245760
    buffer_load_dwordx4 v11, s[8:11], s27 offen lds
    s_add_u32 m0, s26, 71680
    s_add_u32 s27, s29, 245760
    buffer_load_dwordx4 v12, s[8:11], s27 offen lds
    s_add_u32 m0, s26, 72704
    s_add_u32 s27, s29, 245760
    buffer_load_dwordx4 v13, s[8:11], s27 offen lds
    s_add_u32 m0, s26, 73728
    s_add_u32 s27, s29, 245760
    buffer_load_dwordx4 v14, s[8:11], s27 offen lds
    s_add_u32 m0, s26, 90112
    s_add_u32 s27, s29, 368640
    buffer_load_dwordx4 v10, s[8:11], s27 offen lds
    s_add_u32 m0, s26, 91136
    s_add_u32 s27, s29, 368640
    buffer_load_dwordx4 v11, s[8:11], s27 offen lds
    s_add_u32 m0, s26, 92160
    s_add_u32 s27, s29, 368640
    buffer_load_dwordx4 v12, s[8:11], s27 offen lds
    s_add_u32 m0, s26, 93184
    s_add_u32 s27, s29, 368640
    buffer_load_dwordx4 v13, s[8:11], s27 offen lds
    s_add_u32 m0, s26, 94208
    s_add_u32 s27, s29, 368640
    buffer_load_dwordx4 v14, s[8:11], s27 offen lds
    s_waitcnt vmcnt(10)
    s_barrier
    ds_read_b64_tr_b16 a[0:1], v15 offset:0
    ds_read_b64_tr_b16 a[2:3], v15 offset:2560
    ds_read_b64_tr_b16 a[4:5], v15 offset:20480
    ds_read_b64_tr_b16 a[6:7], v15 offset:23040
    ds_read_b64_tr_b16 a[80:81], v15 offset:32
    ds_read_b64_tr_b16 a[82:83], v15 offset:2592
    ds_read_b64_tr_b16 a[84:85], v15 offset:20512
    ds_read_b64_tr_b16 a[86:87], v15 offset:23072
    ds_read_b64_tr_b16 a[160:161], v15 offset:64
    ds_read_b64_tr_b16 a[162:163], v15 offset:2624
    ds_read_b64_tr_b16 a[164:165], v15 offset:20544
    ds_read_b64_tr_b16 a[166:167], v15 offset:23104
    ds_read_b64_tr_b16 a[240:241], v15 offset:96
    ds_read_b64_tr_b16 a[242:243], v15 offset:2656
    ds_read_b64_tr_b16 a[244:245], v15 offset:20576
    ds_read_b64_tr_b16 a[246:247], v15 offset:23136
    ds_read_b64_tr_b16 v[176:177], v15 offset:128
    ds_read_b64_tr_b16 v[178:179], v15 offset:2688
    ds_read_b64_tr_b16 v[180:181], v15 offset:20608
    ds_read_b64_tr_b16 v[182:183], v15 offset:23168
    s_waitcnt lgkmcnt(0)
    s_barrier
    s_add_u32 m0, s26, 0
    s_add_u32 s27, s29, 491520
    buffer_load_dwordx4 v10, s[8:11], s27 offen lds
    s_add_u32 m0, s26, 1024
    s_add_u32 s27, s29, 491520
    buffer_load_dwordx4 v11, s[8:11], s27 offen lds
    s_add_u32 m0, s26, 2048
    s_add_u32 s27, s29, 491520
    buffer_load_dwordx4 v12, s[8:11], s27 offen lds
    s_add_u32 m0, s26, 3072
    s_add_u32 s27, s29, 491520
    buffer_load_dwordx4 v13, s[8:11], s27 offen lds
    s_add_u32 m0, s26, 4096
    s_add_u32 s27, s29, 491520
    buffer_load_dwordx4 v14, s[8:11], s27 offen lds
    s_add_u32 m0, s26, 20480
    s_add_u32 s27, s29, 614400
    buffer_load_dwordx4 v10, s[8:11], s27 offen lds
    s_add_u32 m0, s26, 21504
    s_add_u32 s27, s29, 614400
    buffer_load_dwordx4 v11, s[8:11], s27 offen lds
    s_add_u32 m0, s26, 22528
    s_add_u32 s27, s29, 614400
    buffer_load_dwordx4 v12, s[8:11], s27 offen lds
    s_add_u32 m0, s26, 23552
    s_add_u32 s27, s29, 614400
    buffer_load_dwordx4 v13, s[8:11], s27 offen lds
    s_add_u32 m0, s26, 24576
    s_add_u32 s27, s29, 614400
    buffer_load_dwordx4 v14, s[8:11], s27 offen lds
    s_waitcnt vmcnt(10)
    s_barrier
    ds_read_b64_tr_b16 a[8:9], v16 offset:0
    ds_read_b64_tr_b16 a[10:11], v16 offset:2560
    ds_read_b64_tr_b16 a[12:13], v16 offset:20480
    ds_read_b64_tr_b16 a[14:15], v16 offset:23040
    ds_read_b64_tr_b16 a[88:89], v16 offset:32
    ds_read_b64_tr_b16 a[90:91], v16 offset:2592
    ds_read_b64_tr_b16 a[92:93], v16 offset:20512
    ds_read_b64_tr_b16 a[94:95], v16 offset:23072
    ds_read_b64_tr_b16 a[168:169], v16 offset:64
    ds_read_b64_tr_b16 a[170:171], v16 offset:2624
    ds_read_b64_tr_b16 a[172:173], v16 offset:20544
    ds_read_b64_tr_b16 a[174:175], v16 offset:23104
    ds_read_b64_tr_b16 a[248:249], v16 offset:96
    ds_read_b64_tr_b16 a[250:251], v16 offset:2656
    ds_read_b64_tr_b16 a[252:253], v16 offset:20576
    ds_read_b64_tr_b16 a[254:255], v16 offset:23136
    ds_read_b64_tr_b16 v[184:185], v16 offset:128
    ds_read_b64_tr_b16 v[186:187], v16 offset:2688
    ds_read_b64_tr_b16 v[188:189], v16 offset:20608
    ds_read_b64_tr_b16 v[190:191], v16 offset:23168
    s_waitcnt lgkmcnt(0)
    s_barrier
    s_add_u32 m0, s26, 69632
    s_add_u32 s27, s29, 737280
    buffer_load_dwordx4 v10, s[8:11], s27 offen lds
    s_add_u32 m0, s26, 70656
    s_add_u32 s27, s29, 737280
    buffer_load_dwordx4 v11, s[8:11], s27 offen lds
    s_add_u32 m0, s26, 71680
    s_add_u32 s27, s29, 737280
    buffer_load_dwordx4 v12, s[8:11], s27 offen lds
    s_add_u32 m0, s26, 72704
    s_add_u32 s27, s29, 737280
    buffer_load_dwordx4 v13, s[8:11], s27 offen lds
    s_add_u32 m0, s26, 73728
    s_add_u32 s27, s29, 737280
    buffer_load_dwordx4 v14, s[8:11], s27 offen lds
    s_add_u32 m0, s26, 90112
    s_add_u32 s27, s29, 860160
    buffer_load_dwordx4 v10, s[8:11], s27 offen lds
    s_add_u32 m0, s26, 91136
    s_add_u32 s27, s29, 860160
    buffer_load_dwordx4 v11, s[8:11], s27 offen lds
    s_add_u32 m0, s26, 92160
    s_add_u32 s27, s29, 860160
    buffer_load_dwordx4 v12, s[8:11], s27 offen lds
    s_add_u32 m0, s26, 93184
    s_add_u32 s27, s29, 860160
    buffer_load_dwordx4 v13, s[8:11], s27 offen lds
    s_add_u32 m0, s26, 94208
    s_add_u32 s27, s29, 860160
    buffer_load_dwordx4 v14, s[8:11], s27 offen lds
    s_waitcnt vmcnt(10)
    s_barrier
    ds_read_b64_tr_b16 a[16:17], v15 offset:0
    ds_read_b64_tr_b16 a[18:19], v15 offset:2560
    ds_read_b64_tr_b16 a[20:21], v15 offset:20480
    ds_read_b64_tr_b16 a[22:23], v15 offset:23040
    ds_read_b64_tr_b16 a[96:97], v15 offset:32
    ds_read_b64_tr_b16 a[98:99], v15 offset:2592
    ds_read_b64_tr_b16 a[100:101], v15 offset:20512
    ds_read_b64_tr_b16 a[102:103], v15 offset:23072
    ds_read_b64_tr_b16 a[176:177], v15 offset:64
    ds_read_b64_tr_b16 a[178:179], v15 offset:2624
    ds_read_b64_tr_b16 a[180:181], v15 offset:20544
    ds_read_b64_tr_b16 a[182:183], v15 offset:23104
    ds_read_b64_tr_b16 v[112:113], v15 offset:96
    ds_read_b64_tr_b16 v[114:115], v15 offset:2656
    ds_read_b64_tr_b16 v[116:117], v15 offset:20576
    ds_read_b64_tr_b16 v[118:119], v15 offset:23136
    ds_read_b64_tr_b16 v[192:193], v15 offset:128
    ds_read_b64_tr_b16 v[194:195], v15 offset:2688
    ds_read_b64_tr_b16 v[196:197], v15 offset:20608
    ds_read_b64_tr_b16 v[198:199], v15 offset:23168
    s_waitcnt lgkmcnt(0)
    s_barrier
    s_add_u32 m0, s26, 0
    s_add_u32 s27, s29, 983040
    buffer_load_dwordx4 v10, s[8:11], s27 offen lds
    s_add_u32 m0, s26, 1024
    s_add_u32 s27, s29, 983040
    buffer_load_dwordx4 v11, s[8:11], s27 offen lds
    s_add_u32 m0, s26, 2048
    s_add_u32 s27, s29, 983040
    buffer_load_dwordx4 v12, s[8:11], s27 offen lds
    s_add_u32 m0, s26, 3072
    s_add_u32 s27, s29, 983040
    buffer_load_dwordx4 v13, s[8:11], s27 offen lds
    s_add_u32 m0, s26, 4096
    s_add_u32 s27, s29, 983040
    buffer_load_dwordx4 v14, s[8:11], s27 offen lds
    s_add_u32 m0, s26, 20480
    s_add_u32 s27, s29, 1105920
    buffer_load_dwordx4 v10, s[8:11], s27 offen lds
    s_add_u32 m0, s26, 21504
    s_add_u32 s27, s29, 1105920
    buffer_load_dwordx4 v11, s[8:11], s27 offen lds
    s_add_u32 m0, s26, 22528
    s_add_u32 s27, s29, 1105920
    buffer_load_dwordx4 v12, s[8:11], s27 offen lds
    s_add_u32 m0, s26, 23552
    s_add_u32 s27, s29, 1105920
    buffer_load_dwordx4 v13, s[8:11], s27 offen lds
    s_add_u32 m0, s26, 24576
    s_add_u32 s27, s29, 1105920
    buffer_load_dwordx4 v14, s[8:11], s27 offen lds
    s_waitcnt vmcnt(10)
    s_barrier
    ds_read_b64_tr_b16 a[24:25], v16 offset:0
    ds_read_b64_tr_b16 a[26:27], v16 offset:2560
    ds_read_b64_tr_b16 a[28:29], v16 offset:20480
    ds_read_b64_tr_b16 a[30:31], v16 offset:23040
    ds_read_b64_tr_b16 a[104:105], v16 offset:32
    ds_read_b64_tr_b16 a[106:107], v16 offset:2592
    ds_read_b64_tr_b16 a[108:109], v16 offset:20512
    ds_read_b64_tr_b16 a[110:111], v16 offset:23072
    ds_read_b64_tr_b16 a[184:185], v16 offset:64
    ds_read_b64_tr_b16 a[186:187], v16 offset:2624
    ds_read_b64_tr_b16 a[188:189], v16 offset:20544
    ds_read_b64_tr_b16 a[190:191], v16 offset:23104
    ds_read_b64_tr_b16 v[120:121], v16 offset:96
    ds_read_b64_tr_b16 v[122:123], v16 offset:2656
    ds_read_b64_tr_b16 v[124:125], v16 offset:20576
    ds_read_b64_tr_b16 v[126:127], v16 offset:23136
    ds_read_b64_tr_b16 v[200:201], v16 offset:128
    ds_read_b64_tr_b16 v[202:203], v16 offset:2688
    ds_read_b64_tr_b16 v[204:205], v16 offset:20608
    ds_read_b64_tr_b16 v[206:207], v16 offset:23168
    s_waitcnt lgkmcnt(0)
    s_barrier
    s_add_u32 m0, s26, 69632
    s_add_u32 s27, s29, 1228800
    buffer_load_dwordx4 v10, s[8:11], s27 offen lds
    s_add_u32 m0, s26, 70656
    s_add_u32 s27, s29, 1228800
    buffer_load_dwordx4 v11, s[8:11], s27 offen lds
    s_add_u32 m0, s26, 71680
    s_add_u32 s27, s29, 1228800
    buffer_load_dwordx4 v12, s[8:11], s27 offen lds
    s_add_u32 m0, s26, 72704
    s_add_u32 s27, s29, 1228800
    buffer_load_dwordx4 v13, s[8:11], s27 offen lds
    s_add_u32 m0, s26, 73728
    s_add_u32 s27, s29, 1228800
    buffer_load_dwordx4 v14, s[8:11], s27 offen lds
    s_add_u32 m0, s26, 90112
    s_add_u32 s27, s29, 1351680
    buffer_load_dwordx4 v10, s[8:11], s27 offen lds
    s_add_u32 m0, s26, 91136
    s_add_u32 s27, s29, 1351680
    buffer_load_dwordx4 v11, s[8:11], s27 offen lds
    s_add_u32 m0, s26, 92160
    s_add_u32 s27, s29, 1351680
    buffer_load_dwordx4 v12, s[8:11], s27 offen lds
    s_add_u32 m0, s26, 93184
    s_add_u32 s27, s29, 1351680
    buffer_load_dwordx4 v13, s[8:11], s27 offen lds
    s_add_u32 m0, s26, 94208
    s_add_u32 s27, s29, 1351680
    buffer_load_dwordx4 v14, s[8:11], s27 offen lds
    s_waitcnt vmcnt(10)
    s_barrier
    ds_read_b64_tr_b16 a[32:33], v15 offset:0
    ds_read_b64_tr_b16 a[34:35], v15 offset:2560
    ds_read_b64_tr_b16 a[36:37], v15 offset:20480
    ds_read_b64_tr_b16 a[38:39], v15 offset:23040
    ds_read_b64_tr_b16 a[112:113], v15 offset:32
    ds_read_b64_tr_b16 a[114:115], v15 offset:2592
    ds_read_b64_tr_b16 a[116:117], v15 offset:20512
    ds_read_b64_tr_b16 a[118:119], v15 offset:23072
    ds_read_b64_tr_b16 a[192:193], v15 offset:64
    ds_read_b64_tr_b16 a[194:195], v15 offset:2624
    ds_read_b64_tr_b16 a[196:197], v15 offset:20544
    ds_read_b64_tr_b16 a[198:199], v15 offset:23104
    ds_read_b64_tr_b16 v[128:129], v15 offset:96
    ds_read_b64_tr_b16 v[130:131], v15 offset:2656
    ds_read_b64_tr_b16 v[132:133], v15 offset:20576
    ds_read_b64_tr_b16 v[134:135], v15 offset:23136
    ds_read_b64_tr_b16 v[208:209], v15 offset:128
    ds_read_b64_tr_b16 v[210:211], v15 offset:2688
    ds_read_b64_tr_b16 v[212:213], v15 offset:20608
    ds_read_b64_tr_b16 v[214:215], v15 offset:23168
    s_waitcnt lgkmcnt(0)
    s_barrier
    s_add_u32 m0, s26, 0
    s_add_u32 s27, s29, 1474560
    buffer_load_dwordx4 v10, s[8:11], s27 offen lds
    s_add_u32 m0, s26, 1024
    s_add_u32 s27, s29, 1474560
    buffer_load_dwordx4 v11, s[8:11], s27 offen lds
    s_add_u32 m0, s26, 2048
    s_add_u32 s27, s29, 1474560
    buffer_load_dwordx4 v12, s[8:11], s27 offen lds
    s_add_u32 m0, s26, 3072
    s_add_u32 s27, s29, 1474560
    buffer_load_dwordx4 v13, s[8:11], s27 offen lds
    s_add_u32 m0, s26, 4096
    s_add_u32 s27, s29, 1474560
    buffer_load_dwordx4 v14, s[8:11], s27 offen lds
    s_add_u32 m0, s26, 20480
    s_add_u32 s27, s29, 1597440
    buffer_load_dwordx4 v10, s[8:11], s27 offen lds
    s_add_u32 m0, s26, 21504
    s_add_u32 s27, s29, 1597440
    buffer_load_dwordx4 v11, s[8:11], s27 offen lds
    s_add_u32 m0, s26, 22528
    s_add_u32 s27, s29, 1597440
    buffer_load_dwordx4 v12, s[8:11], s27 offen lds
    s_add_u32 m0, s26, 23552
    s_add_u32 s27, s29, 1597440
    buffer_load_dwordx4 v13, s[8:11], s27 offen lds
    s_add_u32 m0, s26, 24576
    s_add_u32 s27, s29, 1597440
    buffer_load_dwordx4 v14, s[8:11], s27 offen lds
    s_waitcnt vmcnt(10)
    s_barrier
    ds_read_b64_tr_b16 a[40:41], v16 offset:0
    ds_read_b64_tr_b16 a[42:43], v16 offset:2560
    ds_read_b64_tr_b16 a[44:45], v16 offset:20480
    ds_read_b64_tr_b16 a[46:47], v16 offset:23040
    ds_read_b64_tr_b16 a[120:121], v16 offset:32
    ds_read_b64_tr_b16 a[122:123], v16 offset:2592
    ds_read_b64_tr_b16 a[124:125], v16 offset:20512
    ds_read_b64_tr_b16 a[126:127], v16 offset:23072
    ds_read_b64_tr_b16 a[200:201], v16 offset:64
    ds_read_b64_tr_b16 a[202:203], v16 offset:2624
    ds_read_b64_tr_b16 a[204:205], v16 offset:20544
    ds_read_b64_tr_b16 a[206:207], v16 offset:23104
    ds_read_b64_tr_b16 v[136:137], v16 offset:96
    ds_read_b64_tr_b16 v[138:139], v16 offset:2656
    ds_read_b64_tr_b16 v[140:141], v16 offset:20576
    ds_read_b64_tr_b16 v[142:143], v16 offset:23136
    ds_read_b64_tr_b16 v[216:217], v16 offset:128
    ds_read_b64_tr_b16 v[218:219], v16 offset:2688
    ds_read_b64_tr_b16 v[220:221], v16 offset:20608
    ds_read_b64_tr_b16 v[222:223], v16 offset:23168
    s_waitcnt lgkmcnt(0)
    s_barrier
    s_add_u32 m0, s26, 69632
    s_add_u32 s27, s29, 1720320
    buffer_load_dwordx4 v10, s[8:11], s27 offen lds
    s_add_u32 m0, s26, 70656
    s_add_u32 s27, s29, 1720320
    buffer_load_dwordx4 v11, s[8:11], s27 offen lds
    s_add_u32 m0, s26, 71680
    s_add_u32 s27, s29, 1720320
    buffer_load_dwordx4 v12, s[8:11], s27 offen lds
    s_add_u32 m0, s26, 72704
    s_add_u32 s27, s29, 1720320
    buffer_load_dwordx4 v13, s[8:11], s27 offen lds
    s_add_u32 m0, s26, 73728
    s_add_u32 s27, s29, 1720320
    buffer_load_dwordx4 v14, s[8:11], s27 offen lds
    s_add_u32 m0, s26, 90112
    s_add_u32 s27, s29, 1843200
    buffer_load_dwordx4 v10, s[8:11], s27 offen lds
    s_add_u32 m0, s26, 91136
    s_add_u32 s27, s29, 1843200
    buffer_load_dwordx4 v11, s[8:11], s27 offen lds
    s_add_u32 m0, s26, 92160
    s_add_u32 s27, s29, 1843200
    buffer_load_dwordx4 v12, s[8:11], s27 offen lds
    s_add_u32 m0, s26, 93184
    s_add_u32 s27, s29, 1843200
    buffer_load_dwordx4 v13, s[8:11], s27 offen lds
    s_add_u32 m0, s26, 94208
    s_add_u32 s27, s29, 1843200
    buffer_load_dwordx4 v14, s[8:11], s27 offen lds
    s_waitcnt vmcnt(10)
    s_barrier
    ds_read_b64_tr_b16 a[48:49], v15 offset:0
    ds_read_b64_tr_b16 a[50:51], v15 offset:2560
    ds_read_b64_tr_b16 a[52:53], v15 offset:20480
    ds_read_b64_tr_b16 a[54:55], v15 offset:23040
    ds_read_b64_tr_b16 a[128:129], v15 offset:32
    ds_read_b64_tr_b16 a[130:131], v15 offset:2592
    ds_read_b64_tr_b16 a[132:133], v15 offset:20512
    ds_read_b64_tr_b16 a[134:135], v15 offset:23072
    ds_read_b64_tr_b16 a[208:209], v15 offset:64
    ds_read_b64_tr_b16 a[210:211], v15 offset:2624
    ds_read_b64_tr_b16 a[212:213], v15 offset:20544
    ds_read_b64_tr_b16 a[214:215], v15 offset:23104
    ds_read_b64_tr_b16 v[144:145], v15 offset:96
    ds_read_b64_tr_b16 v[146:147], v15 offset:2656
    ds_read_b64_tr_b16 v[148:149], v15 offset:20576
    ds_read_b64_tr_b16 v[150:151], v15 offset:23136
    ds_read_b64_tr_b16 v[224:225], v15 offset:128
    ds_read_b64_tr_b16 v[226:227], v15 offset:2688
    ds_read_b64_tr_b16 v[228:229], v15 offset:20608
    ds_read_b64_tr_b16 v[230:231], v15 offset:23168
    s_waitcnt lgkmcnt(0)
    s_barrier
    s_add_u32 m0, s26, 0
    s_add_u32 s27, s29, 1966080
    buffer_load_dwordx4 v10, s[8:11], s27 offen lds
    s_add_u32 m0, s26, 1024
    s_add_u32 s27, s29, 1966080
    buffer_load_dwordx4 v11, s[8:11], s27 offen lds
    s_add_u32 m0, s26, 2048
    s_add_u32 s27, s29, 1966080
    buffer_load_dwordx4 v12, s[8:11], s27 offen lds
    s_add_u32 m0, s26, 3072
    s_add_u32 s27, s29, 1966080
    buffer_load_dwordx4 v13, s[8:11], s27 offen lds
    s_add_u32 m0, s26, 4096
    s_add_u32 s27, s29, 1966080
    buffer_load_dwordx4 v14, s[8:11], s27 offen lds
    s_add_u32 m0, s26, 20480
    s_add_u32 s27, s29, 2088960
    buffer_load_dwordx4 v10, s[8:11], s27 offen lds
    s_add_u32 m0, s26, 21504
    s_add_u32 s27, s29, 2088960
    buffer_load_dwordx4 v11, s[8:11], s27 offen lds
    s_add_u32 m0, s26, 22528
    s_add_u32 s27, s29, 2088960
    buffer_load_dwordx4 v12, s[8:11], s27 offen lds
    s_add_u32 m0, s26, 23552
    s_add_u32 s27, s29, 2088960
    buffer_load_dwordx4 v13, s[8:11], s27 offen lds
    s_add_u32 m0, s26, 24576
    s_add_u32 s27, s29, 2088960
    buffer_load_dwordx4 v14, s[8:11], s27 offen lds
    s_waitcnt vmcnt(10)
    s_barrier
    ds_read_b64_tr_b16 a[56:57], v16 offset:0
    ds_read_b64_tr_b16 a[58:59], v16 offset:2560
    ds_read_b64_tr_b16 a[60:61], v16 offset:20480
    ds_read_b64_tr_b16 a[62:63], v16 offset:23040
    ds_read_b64_tr_b16 a[136:137], v16 offset:32
    ds_read_b64_tr_b16 a[138:139], v16 offset:2592
    ds_read_b64_tr_b16 a[140:141], v16 offset:20512
    ds_read_b64_tr_b16 a[142:143], v16 offset:23072
    ds_read_b64_tr_b16 a[216:217], v16 offset:64
    ds_read_b64_tr_b16 a[218:219], v16 offset:2624
    ds_read_b64_tr_b16 a[220:221], v16 offset:20544
    ds_read_b64_tr_b16 a[222:223], v16 offset:23104
    ds_read_b64_tr_b16 v[152:153], v16 offset:96
    ds_read_b64_tr_b16 v[154:155], v16 offset:2656
    ds_read_b64_tr_b16 v[156:157], v16 offset:20576
    ds_read_b64_tr_b16 v[158:159], v16 offset:23136
    ds_read_b64_tr_b16 v[232:233], v16 offset:128
    ds_read_b64_tr_b16 v[234:235], v16 offset:2688
    ds_read_b64_tr_b16 v[236:237], v16 offset:20608
    ds_read_b64_tr_b16 v[238:239], v16 offset:23168
    s_waitcnt lgkmcnt(0)
    s_barrier
    s_add_u32 m0, s26, 69632
    s_add_u32 s27, s29, 2211840
    buffer_load_dwordx4 v10, s[8:11], s27 offen lds
    s_add_u32 m0, s26, 70656
    s_add_u32 s27, s29, 2211840
    buffer_load_dwordx4 v11, s[8:11], s27 offen lds
    s_add_u32 m0, s26, 71680
    s_add_u32 s27, s29, 2211840
    buffer_load_dwordx4 v12, s[8:11], s27 offen lds
    s_add_u32 m0, s26, 72704
    s_add_u32 s27, s29, 2211840
    buffer_load_dwordx4 v13, s[8:11], s27 offen lds
    s_add_u32 m0, s26, 73728
    s_add_u32 s27, s29, 2211840
    buffer_load_dwordx4 v14, s[8:11], s27 offen lds
    s_add_u32 m0, s26, 90112
    s_add_u32 s27, s29, 2334720
    buffer_load_dwordx4 v10, s[8:11], s27 offen lds
    s_add_u32 m0, s26, 91136
    s_add_u32 s27, s29, 2334720
    buffer_load_dwordx4 v11, s[8:11], s27 offen lds
    s_add_u32 m0, s26, 92160
    s_add_u32 s27, s29, 2334720
    buffer_load_dwordx4 v12, s[8:11], s27 offen lds
    s_add_u32 m0, s26, 93184
    s_add_u32 s27, s29, 2334720
    buffer_load_dwordx4 v13, s[8:11], s27 offen lds
    s_add_u32 m0, s26, 94208
    s_add_u32 s27, s29, 2334720
    buffer_load_dwordx4 v14, s[8:11], s27 offen lds
    s_waitcnt vmcnt(10)
    s_barrier
    ds_read_b64_tr_b16 a[64:65], v15 offset:0
    ds_read_b64_tr_b16 a[66:67], v15 offset:2560
    ds_read_b64_tr_b16 a[68:69], v15 offset:20480
    ds_read_b64_tr_b16 a[70:71], v15 offset:23040
    ds_read_b64_tr_b16 a[144:145], v15 offset:32
    ds_read_b64_tr_b16 a[146:147], v15 offset:2592
    ds_read_b64_tr_b16 a[148:149], v15 offset:20512
    ds_read_b64_tr_b16 a[150:151], v15 offset:23072
    ds_read_b64_tr_b16 a[224:225], v15 offset:64
    ds_read_b64_tr_b16 a[226:227], v15 offset:2624
    ds_read_b64_tr_b16 a[228:229], v15 offset:20544
    ds_read_b64_tr_b16 a[230:231], v15 offset:23104
    ds_read_b64_tr_b16 v[160:161], v15 offset:96
    ds_read_b64_tr_b16 v[162:163], v15 offset:2656
    ds_read_b64_tr_b16 v[164:165], v15 offset:20576
    ds_read_b64_tr_b16 v[166:167], v15 offset:23136
    ds_read_b64_tr_b16 v[240:241], v15 offset:128
    ds_read_b64_tr_b16 v[242:243], v15 offset:2688
    ds_read_b64_tr_b16 v[244:245], v15 offset:20608
    ds_read_b64_tr_b16 v[246:247], v15 offset:23168
    s_waitcnt lgkmcnt(0)
    s_barrier
    s_waitcnt vmcnt(0)
    s_barrier
    ds_read_b64_tr_b16 a[72:73], v16 offset:0
    ds_read_b64_tr_b16 a[74:75], v16 offset:2560
    ds_read_b64_tr_b16 a[76:77], v16 offset:20480
    ds_read_b64_tr_b16 a[78:79], v16 offset:23040
    ds_read_b64_tr_b16 a[152:153], v16 offset:32
    ds_read_b64_tr_b16 a[154:155], v16 offset:2592
    ds_read_b64_tr_b16 a[156:157], v16 offset:20512
    ds_read_b64_tr_b16 a[158:159], v16 offset:23072
    ds_read_b64_tr_b16 a[232:233], v16 offset:64
    ds_read_b64_tr_b16 a[234:235], v16 offset:2624
    ds_read_b64_tr_b16 a[236:237], v16 offset:20544
    ds_read_b64_tr_b16 a[238:239], v16 offset:23104
    ds_read_b64_tr_b16 v[168:169], v16 offset:96
    ds_read_b64_tr_b16 v[170:171], v16 offset:2656
    ds_read_b64_tr_b16 v[172:173], v16 offset:20576
    ds_read_b64_tr_b16 v[174:175], v16 offset:23136
    ds_read_b64_tr_b16 v[248:249], v16 offset:128
    ds_read_b64_tr_b16 v[250:251], v16 offset:2688
    ds_read_b64_tr_b16 v[252:253], v16 offset:20608
    ds_read_b64_tr_b16 v[254:255], v16 offset:23168
    s_waitcnt lgkmcnt(0)
    s_barrier
    s_mul_i32 s34, s33, 327680
    v_mul_u32_u24 v30, 1280, v2
    v_lshlrev_b32 v4, 4, v3
    v_add_u32 v30, v30, v4
    v_mov_b32 v4, s24
    v_mul_u32_u24 v4, 320, v4
    v_add_u32 v30, v30, v4
    s_mul_i32 s47, s24, 10240
    s_add_u32 s28, s47, 69632
    s_add_u32 m0, s28, 0
    s_add_u32 s27, s34, 0
    buffer_load_dwordx4 v30, s[40:43], s27 offen lds
    s_add_u32 m0, s28, 1024
    s_add_u32 s27, s34, 20480
    buffer_load_dwordx4 v30, s[40:43], s27 offen lds
    s_add_u32 m0, s28, 2048
    s_add_u32 s27, s34, 64
    buffer_load_dwordx4 v30, s[40:43], s27 offen lds
    s_add_u32 m0, s28, 3072
    s_add_u32 s27, s34, 20544
    buffer_load_dwordx4 v30, s[40:43], s27 offen lds
    s_add_u32 m0, s28, 4096
    s_add_u32 s27, s34, 128
    buffer_load_dwordx4 v30, s[40:43], s27 offen lds
    s_add_u32 m0, s28, 5120
    s_add_u32 s27, s34, 20608
    buffer_load_dwordx4 v30, s[40:43], s27 offen lds
    s_add_u32 m0, s28, 6144
    s_add_u32 s27, s34, 192
    buffer_load_dwordx4 v30, s[40:43], s27 offen lds
    s_add_u32 m0, s28, 7168
    s_add_u32 s27, s34, 20672
    buffer_load_dwordx4 v30, s[40:43], s27 offen lds
    s_add_u32 m0, s28, 8192
    s_add_u32 s27, s34, 256
    buffer_load_dwordx4 v30, s[40:43], s27 offen lds
    s_add_u32 m0, s28, 9216
    s_add_u32 s27, s34, 20736
    buffer_load_dwordx4 v30, s[40:43], s27 offen lds
    s_add_u32 s28, s47, 110592
    s_add_u32 s36, s34, 40960
    s_add_u32 m0, s28, 0
    s_add_u32 s27, s36, 0
    buffer_load_dwordx4 v30, s[40:43], s27 offen lds
    s_add_u32 m0, s28, 1024
    s_add_u32 s27, s36, 20480
    buffer_load_dwordx4 v30, s[40:43], s27 offen lds
    s_add_u32 m0, s28, 2048
    s_add_u32 s27, s36, 64
    buffer_load_dwordx4 v30, s[40:43], s27 offen lds
    s_add_u32 m0, s28, 3072
    s_add_u32 s27, s36, 20544
    buffer_load_dwordx4 v30, s[40:43], s27 offen lds
    s_add_u32 m0, s28, 4096
    s_add_u32 s27, s36, 128
    buffer_load_dwordx4 v30, s[40:43], s27 offen lds
    s_add_u32 m0, s28, 5120
    s_add_u32 s27, s36, 20608
    buffer_load_dwordx4 v30, s[40:43], s27 offen lds
    s_add_u32 m0, s28, 6144
    s_add_u32 s27, s36, 192
    buffer_load_dwordx4 v30, s[40:43], s27 offen lds
    s_add_u32 m0, s28, 7168
    s_add_u32 s27, s36, 20672
    buffer_load_dwordx4 v30, s[40:43], s27 offen lds
    s_add_u32 m0, s28, 8192
    s_add_u32 s27, s36, 256
    buffer_load_dwordx4 v30, s[40:43], s27 offen lds
    s_add_u32 m0, s28, 9216
    s_add_u32 s27, s36, 20736
    buffer_load_dwordx4 v30, s[40:43], s27 offen lds
    v_lshlrev_b32 v31, 4, v1
    v_add_u32 v31, 69632, v31
    s_and_b32 s37, s32, 1
    s_lshl_b32 s37, s37, 4
    s_lshl_b32 s38, s24, 2
    s_add_u32 s37, s37, s38
    s_cmp_ge_u32 s32, 4
    s_cbranch_scc1 AQV_1
    v_add_u32 v9, 0, v3
    v_mul_u32_u24 v9, 52, v9
    v_lshrrev_b32 v9, 8, v9
    v_add_u32 v8, 0, v3
    v_mul_u32_u24 v4, 5, v9
    v_sub_u32 v8, v8, v4
    v_mul_u32_u24 v10, 1536, v9
    v_lshrrev_b32 v4, 1, v8
    v_lshlrev_b32 v4, 9, v4
    v_add_u32 v10, v10, v4
    v_and_b32 v4, 1, v8
    v_lshlrev_b32 v4, 3, v4
    v_add_u32 v10, v10, v4
    v_lshlrev_b32 v4, 4, v2
    v_add_u32 v10, v10, v4
    v_mov_b32 v4, s24
    v_mul_u32_u24 v4, 6144, v4
    v_add_u32 v4, 40960, v4
    v_add_u32 v10, v10, v4
    v_add_u32 v9, 4, v3
    v_mul_u32_u24 v9, 52, v9
    v_lshrrev_b32 v9, 8, v9
    v_add_u32 v8, 4, v3
    v_mul_u32_u24 v4, 5, v9
    v_sub_u32 v8, v8, v4
    v_mul_u32_u24 v11, 1536, v9
    v_lshrrev_b32 v4, 1, v8
    v_lshlrev_b32 v4, 9, v4
    v_add_u32 v11, v11, v4
    v_and_b32 v4, 1, v8
    v_lshlrev_b32 v4, 3, v4
    v_add_u32 v11, v11, v4
    v_lshlrev_b32 v4, 4, v2
    v_add_u32 v11, v11, v4
    v_mov_b32 v4, s24
    v_mul_u32_u24 v4, 6144, v4
    v_add_u32 v4, 40960, v4
    v_add_u32 v11, v11, v4
    v_add_u32 v9, 8, v3
    v_mul_u32_u24 v9, 52, v9
    v_lshrrev_b32 v9, 8, v9
    v_add_u32 v8, 8, v3
    v_mul_u32_u24 v4, 5, v9
    v_sub_u32 v8, v8, v4
    v_mul_u32_u24 v12, 1536, v9
    v_lshrrev_b32 v4, 1, v8
    v_lshlrev_b32 v4, 9, v4
    v_add_u32 v12, v12, v4
    v_and_b32 v4, 1, v8
    v_lshlrev_b32 v4, 3, v4
    v_add_u32 v12, v12, v4
    v_lshlrev_b32 v4, 4, v2
    v_add_u32 v12, v12, v4
    v_mov_b32 v4, s24
    v_mul_u32_u24 v4, 6144, v4
    v_add_u32 v4, 40960, v4
    v_add_u32 v12, v12, v4
    v_add_u32 v9, 12, v3
    v_mul_u32_u24 v9, 52, v9
    v_lshrrev_b32 v9, 8, v9
    v_add_u32 v8, 12, v3
    v_mul_u32_u24 v4, 5, v9
    v_sub_u32 v8, v8, v4
    v_mul_u32_u24 v13, 1536, v9
    v_lshrrev_b32 v4, 1, v8
    v_lshlrev_b32 v4, 9, v4
    v_add_u32 v13, v13, v4
    v_and_b32 v4, 1, v8
    v_lshlrev_b32 v4, 3, v4
    v_add_u32 v13, v13, v4
    v_lshlrev_b32 v4, 4, v2
    v_add_u32 v13, v13, v4
    v_mov_b32 v4, s24
    v_mul_u32_u24 v4, 6144, v4
    v_add_u32 v4, 40960, v4
    v_add_u32 v13, v13, v4
    v_add_u32 v9, 16, v3
    v_mul_u32_u24 v9, 52, v9
    v_lshrrev_b32 v9, 8, v9
    v_add_u32 v8, 16, v3
    v_mul_u32_u24 v4, 5, v9
    v_sub_u32 v8, v8, v4
    v_mul_u32_u24 v14, 1536, v9
    v_lshrrev_b32 v4, 1, v8
    v_lshlrev_b32 v4, 9, v4
    v_add_u32 v14, v14, v4
    v_and_b32 v4, 1, v8
    v_lshlrev_b32 v4, 3, v4
    v_add_u32 v14, v14, v4
    v_lshlrev_b32 v4, 4, v2
    v_add_u32 v14, v14, v4
    v_mov_b32 v4, s24
    v_mul_u32_u24 v4, 6144, v4
    v_add_u32 v4, 40960, v4
    v_add_u32 v14, v14, v4
    v_mul_u32_u24 v15, 1536, v3
    v_add_u32 v15, 1024, v15
    v_add_u32 v15, 8, v15
    v_lshlrev_b32 v4, 4, v2
    v_add_u32 v15, v15, v4
    v_mov_b32 v4, s24
    v_mul_u32_u24 v4, 6144, v4
    v_add_u32 v4, 40960, v4
    v_add_u32 v15, v15, v4
    v_mov_b32 v16, 0
    v_mov_b32 v17, 0
    ds_write_b64 v15, v[16:17]
    ds_write_b64 v15, v[16:17] offset:256
    v_add_u32 v9, 0, v1
    v_mul_u32_u24 v9, 683, v9
    v_lshrrev_b32 v9, 16, v9
    v_add_u32 v8, 0, v1
    v_mul_u32_u24 v4, 96, v9
    v_sub_u32 v8, v8, v4
    v_add_u32 v18, s37, v9
    v_mul_u32_u24 v18, 98304, v18
    v_lshlrev_b32 v4, 4, v8
    v_add_u32 v18, v18, v4
    v_add_u32 v9, 64, v1
    v_mul_u32_u24 v9, 683, v9
    v_lshrrev_b32 v9, 16, v9
    v_add_u32 v8, 64, v1
    v_mul_u32_u24 v4, 96, v9
    v_sub_u32 v8, v8, v4
    v_add_u32 v19, s37, v9
    v_mul_u32_u24 v19, 98304, v19
    v_lshlrev_b32 v4, 4, v8
    v_add_u32 v19, v19, v4
    v_add_u32 v9, 128, v1
    v_mul_u32_u24 v9, 683, v9
    v_lshrrev_b32 v9, 16, v9
    v_add_u32 v8, 128, v1
    v_mul_u32_u24 v4, 96, v9
    v_sub_u32 v8, v8, v4
    v_add_u32 v20, s37, v9
    v_mul_u32_u24 v20, 98304, v20
    v_lshlrev_b32 v4, 4, v8
    v_add_u32 v20, v20, v4
    v_add_u32 v9, 192, v1
    v_mul_u32_u24 v9, 683, v9
    v_lshrrev_b32 v9, 16, v9
    v_add_u32 v8, 192, v1
    v_mul_u32_u24 v4, 96, v9
    v_sub_u32 v8, v8, v4
    v_add_u32 v21, s37, v9
    v_mul_u32_u24 v21, 98304, v21
    v_lshlrev_b32 v4, 4, v8
    v_add_u32 v21, v21, v4
    v_add_u32 v9, 256, v1
    v_mul_u32_u24 v9, 683, v9
    v_lshrrev_b32 v9, 16, v9
    v_add_u32 v8, 256, v1
    v_mul_u32_u24 v4, 96, v9
    v_sub_u32 v8, v8, v4
    v_add_u32 v22, s37, v9
    v_mul_u32_u24 v22, 98304, v22
    v_lshlrev_b32 v4, 4, v8
    v_add_u32 v22, v22, v4
    v_add_u32 v9, 320, v1
    v_mul_u32_u24 v9, 683, v9
    v_lshrrev_b32 v9, 16, v9
    v_add_u32 v8, 320, v1
    v_mul_u32_u24 v4, 96, v9
    v_sub_u32 v8, v8, v4
    v_add_u32 v23, s37, v9
    v_mul_u32_u24 v23, 98304, v23
    v_lshlrev_b32 v4, 4, v8
    v_add_u32 v23, v23, v4
    v_lshlrev_b32 v24, 4, v1
    v_mov_b32 v4, s24
    v_mul_u32_u24 v4, 6144, v4
    v_add_u32 v4, 40960, v4
    v_add_u32 v24, v24, v4
    s_mul_i32 s37, s33, 12288
    s_cmp_lt_u32 s32, 2
    s_cselect_b32 s38, 0, 4194304
    s_add_u32 s38, s38, 52428800
    s_cmp_lt_u32 s32, 2
    s_cselect_b32 s39, 1051011932, 1.0
    s_add_u32 s37, s37, s38
    s_mov_b32 s35, 0
    s_mov_b32 s44, 69632
    s_mov_b32 s45, 110592
    s_mov_b32 s46, 0
    s_waitcnt vmcnt(10)
    s_branch PW_8
AQK_3:
    s_cmp_eq_u32 s35, 1
    s_cbranch_scc1 FW_7
    s_cmp_eq_u32 s35, 16
    s_cbranch_scc1 FW_7
    s_cmp_eq_u32 s35, 15
    s_cbranch_scc1 LW_10
    s_waitcnt vmcnt(16)
    s_branch PW_8
LW_10:
    s_waitcnt vmcnt(6)
    s_branch PW_8
FW_7:
    s_waitcnt vmcnt(0)
PW_8:
    s_barrier
    s_cmp_eq_u32 s35, 16
    s_cbranch_scc1 E_6
    v_lshlrev_b32 v31, 4, v1
    v_add_u32 v31, s44, v31
    s_cmp_ge_u32 s35, 14
    s_cbranch_scc1 SK_4
    s_add_u32 s36, s34, 81920
    s_add_u32 s28, s47, s46
    s_add_u32 m0, s28, 0
    s_add_u32 s27, s36, 0
    buffer_load_dwordx4 v30, s[40:43], s27 offen lds
    s_add_u32 m0, s28, 1024
    s_add_u32 s27, s36, 20480
    buffer_load_dwordx4 v30, s[40:43], s27 offen lds
    s_add_u32 m0, s28, 2048
    s_add_u32 s27, s36, 64
    buffer_load_dwordx4 v30, s[40:43], s27 offen lds
    s_add_u32 m0, s28, 3072
    s_add_u32 s27, s36, 20544
    buffer_load_dwordx4 v30, s[40:43], s27 offen lds
    s_add_u32 m0, s28, 4096
    s_add_u32 s27, s36, 128
    buffer_load_dwordx4 v30, s[40:43], s27 offen lds
    s_add_u32 m0, s28, 5120
    s_add_u32 s27, s36, 20608
    buffer_load_dwordx4 v30, s[40:43], s27 offen lds
    s_add_u32 m0, s28, 6144
    s_add_u32 s27, s36, 192
    buffer_load_dwordx4 v30, s[40:43], s27 offen lds
    s_add_u32 m0, s28, 7168
    s_add_u32 s27, s36, 20672
    buffer_load_dwordx4 v30, s[40:43], s27 offen lds
    s_add_u32 m0, s28, 8192
    s_add_u32 s27, s36, 256
    buffer_load_dwordx4 v30, s[40:43], s27 offen lds
    s_add_u32 m0, s28, 9216
    s_add_u32 s27, s36, 20736
    buffer_load_dwordx4 v30, s[40:43], s27 offen lds
SK_4:
    ds_read_b128 v[32:35], v31 offset:0
    ds_read_b128 v[36:39], v31 offset:1024
    ds_read_b128 v[40:43], v31 offset:2048
    ds_read_b128 v[44:47], v31 offset:3072
    s_waitcnt lgkmcnt(2)
    v_mfma_f32_16x16x32_bf16 v[48:51], a[0:3], v[32:35], 0
    v_mfma_f32_16x16x32_bf16 v[56:59], a[80:83], v[32:35], 0
    v_mfma_f32_16x16x32_bf16 v[64:67], a[160:163], v[32:35], 0
    v_mfma_f32_16x16x32_bf16 v[72:75], a[240:243], v[32:35], 0
    v_mfma_f32_16x16x32_bf16 v[80:83], v[176:179], v[32:35], 0
    v_mfma_f32_16x16x32_bf16 v[52:55], a[0:3], v[36:39], 0
    v_mfma_f32_16x16x32_bf16 v[60:63], a[80:83], v[36:39], 0
    v_mfma_f32_16x16x32_bf16 v[68:71], a[160:163], v[36:39], 0
    v_mfma_f32_16x16x32_bf16 v[76:79], a[240:243], v[36:39], 0
    v_mfma_f32_16x16x32_bf16 v[84:87], v[176:179], v[36:39], 0
    ds_read_b128 v[32:35], v31 offset:4096
    ds_read_b128 v[36:39], v31 offset:5120
    s_waitcnt lgkmcnt(2)
    v_mfma_f32_16x16x32_bf16 v[48:51], a[4:7], v[40:43], v[48:51]
    v_mfma_f32_16x16x32_bf16 v[56:59], a[84:87], v[40:43], v[56:59]
    v_mfma_f32_16x16x32_bf16 v[64:67], a[164:167], v[40:43], v[64:67]
    v_mfma_f32_16x16x32_bf16 v[72:75], a[244:247], v[40:43], v[72:75]
    v_mfma_f32_16x16x32_bf16 v[80:83], v[180:183], v[40:43], v[80:83]
    v_mfma_f32_16x16x32_bf16 v[52:55], a[4:7], v[44:47], v[52:55]
    v_mfma_f32_16x16x32_bf16 v[60:63], a[84:87], v[44:47], v[60:63]
    v_mfma_f32_16x16x32_bf16 v[68:71], a[164:167], v[44:47], v[68:71]
    v_mfma_f32_16x16x32_bf16 v[76:79], a[244:247], v[44:47], v[76:79]
    v_mfma_f32_16x16x32_bf16 v[84:87], v[180:183], v[44:47], v[84:87]
    ds_read_b128 v[40:43], v31 offset:6144
    ds_read_b128 v[44:47], v31 offset:7168
    s_waitcnt lgkmcnt(2)
    v_mfma_f32_16x16x32_bf16 v[48:51], a[8:11], v[32:35], v[48:51]
    v_mfma_f32_16x16x32_bf16 v[56:59], a[88:91], v[32:35], v[56:59]
    v_mfma_f32_16x16x32_bf16 v[64:67], a[168:171], v[32:35], v[64:67]
    v_mfma_f32_16x16x32_bf16 v[72:75], a[248:251], v[32:35], v[72:75]
    v_mfma_f32_16x16x32_bf16 v[80:83], v[184:187], v[32:35], v[80:83]
    v_mfma_f32_16x16x32_bf16 v[52:55], a[8:11], v[36:39], v[52:55]
    v_mfma_f32_16x16x32_bf16 v[60:63], a[88:91], v[36:39], v[60:63]
    v_mfma_f32_16x16x32_bf16 v[68:71], a[168:171], v[36:39], v[68:71]
    v_mfma_f32_16x16x32_bf16 v[76:79], a[248:251], v[36:39], v[76:79]
    v_mfma_f32_16x16x32_bf16 v[84:87], v[184:187], v[36:39], v[84:87]
    ds_read_b128 v[32:35], v31 offset:8192
    ds_read_b128 v[36:39], v31 offset:9216
    s_waitcnt lgkmcnt(2)
    v_mfma_f32_16x16x32_bf16 v[48:51], a[12:15], v[40:43], v[48:51]
    v_mfma_f32_16x16x32_bf16 v[56:59], a[92:95], v[40:43], v[56:59]
    v_mfma_f32_16x16x32_bf16 v[64:67], a[172:175], v[40:43], v[64:67]
    v_mfma_f32_16x16x32_bf16 v[72:75], a[252:255], v[40:43], v[72:75]
    v_mfma_f32_16x16x32_bf16 v[80:83], v[188:191], v[40:43], v[80:83]
    v_mfma_f32_16x16x32_bf16 v[52:55], a[12:15], v[44:47], v[52:55]
    v_mfma_f32_16x16x32_bf16 v[60:63], a[92:95], v[44:47], v[60:63]
    v_mfma_f32_16x16x32_bf16 v[68:71], a[172:175], v[44:47], v[68:71]
    v_mfma_f32_16x16x32_bf16 v[76:79], a[252:255], v[44:47], v[76:79]
    v_mfma_f32_16x16x32_bf16 v[84:87], v[188:191], v[44:47], v[84:87]
    ds_read_b128 v[40:43], v31 offset:10240
    ds_read_b128 v[44:47], v31 offset:11264
    s_waitcnt lgkmcnt(2)
    v_mfma_f32_16x16x32_bf16 v[48:51], a[16:19], v[32:35], v[48:51]
    v_mfma_f32_16x16x32_bf16 v[56:59], a[96:99], v[32:35], v[56:59]
    v_mfma_f32_16x16x32_bf16 v[64:67], a[176:179], v[32:35], v[64:67]
    v_mfma_f32_16x16x32_bf16 v[72:75], v[112:115], v[32:35], v[72:75]
    v_mfma_f32_16x16x32_bf16 v[80:83], v[192:195], v[32:35], v[80:83]
    v_mfma_f32_16x16x32_bf16 v[52:55], a[16:19], v[36:39], v[52:55]
    v_mfma_f32_16x16x32_bf16 v[60:63], a[96:99], v[36:39], v[60:63]
    v_mfma_f32_16x16x32_bf16 v[68:71], a[176:179], v[36:39], v[68:71]
    v_mfma_f32_16x16x32_bf16 v[76:79], v[112:115], v[36:39], v[76:79]
    v_mfma_f32_16x16x32_bf16 v[84:87], v[192:195], v[36:39], v[84:87]
    ds_read_b128 v[32:35], v31 offset:12288
    ds_read_b128 v[36:39], v31 offset:13312
    s_waitcnt lgkmcnt(2)
    v_mfma_f32_16x16x32_bf16 v[48:51], a[20:23], v[40:43], v[48:51]
    v_mfma_f32_16x16x32_bf16 v[56:59], a[100:103], v[40:43], v[56:59]
    v_mfma_f32_16x16x32_bf16 v[64:67], a[180:183], v[40:43], v[64:67]
    v_mfma_f32_16x16x32_bf16 v[72:75], v[116:119], v[40:43], v[72:75]
    v_mfma_f32_16x16x32_bf16 v[80:83], v[196:199], v[40:43], v[80:83]
    v_mfma_f32_16x16x32_bf16 v[52:55], a[20:23], v[44:47], v[52:55]
    v_mfma_f32_16x16x32_bf16 v[60:63], a[100:103], v[44:47], v[60:63]
    v_mfma_f32_16x16x32_bf16 v[68:71], a[180:183], v[44:47], v[68:71]
    v_mfma_f32_16x16x32_bf16 v[76:79], v[116:119], v[44:47], v[76:79]
    v_mfma_f32_16x16x32_bf16 v[84:87], v[196:199], v[44:47], v[84:87]
    ds_read_b128 v[40:43], v31 offset:14336
    ds_read_b128 v[44:47], v31 offset:15360
    s_waitcnt lgkmcnt(2)
    v_mfma_f32_16x16x32_bf16 v[48:51], a[24:27], v[32:35], v[48:51]
    v_mfma_f32_16x16x32_bf16 v[56:59], a[104:107], v[32:35], v[56:59]
    v_mfma_f32_16x16x32_bf16 v[64:67], a[184:187], v[32:35], v[64:67]
    v_mfma_f32_16x16x32_bf16 v[72:75], v[120:123], v[32:35], v[72:75]
    v_mfma_f32_16x16x32_bf16 v[80:83], v[200:203], v[32:35], v[80:83]
    v_mfma_f32_16x16x32_bf16 v[52:55], a[24:27], v[36:39], v[52:55]
    v_mfma_f32_16x16x32_bf16 v[60:63], a[104:107], v[36:39], v[60:63]
    v_mfma_f32_16x16x32_bf16 v[68:71], a[184:187], v[36:39], v[68:71]
    v_mfma_f32_16x16x32_bf16 v[76:79], v[120:123], v[36:39], v[76:79]
    v_mfma_f32_16x16x32_bf16 v[84:87], v[200:203], v[36:39], v[84:87]
    ds_read_b128 v[32:35], v31 offset:16384
    ds_read_b128 v[36:39], v31 offset:17408
    s_waitcnt lgkmcnt(2)
    v_mfma_f32_16x16x32_bf16 v[48:51], a[28:31], v[40:43], v[48:51]
    v_mfma_f32_16x16x32_bf16 v[56:59], a[108:111], v[40:43], v[56:59]
    v_mfma_f32_16x16x32_bf16 v[64:67], a[188:191], v[40:43], v[64:67]
    v_mfma_f32_16x16x32_bf16 v[72:75], v[124:127], v[40:43], v[72:75]
    v_mfma_f32_16x16x32_bf16 v[80:83], v[204:207], v[40:43], v[80:83]
    v_mfma_f32_16x16x32_bf16 v[52:55], a[28:31], v[44:47], v[52:55]
    v_mfma_f32_16x16x32_bf16 v[60:63], a[108:111], v[44:47], v[60:63]
    v_mfma_f32_16x16x32_bf16 v[68:71], a[188:191], v[44:47], v[68:71]
    v_mfma_f32_16x16x32_bf16 v[76:79], v[124:127], v[44:47], v[76:79]
    v_mfma_f32_16x16x32_bf16 v[84:87], v[204:207], v[44:47], v[84:87]
    ds_read_b128 v[40:43], v31 offset:18432
    ds_read_b128 v[44:47], v31 offset:19456
    s_waitcnt lgkmcnt(2)
    v_mfma_f32_16x16x32_bf16 v[48:51], a[32:35], v[32:35], v[48:51]
    v_mfma_f32_16x16x32_bf16 v[56:59], a[112:115], v[32:35], v[56:59]
    v_mfma_f32_16x16x32_bf16 v[64:67], a[192:195], v[32:35], v[64:67]
    v_mfma_f32_16x16x32_bf16 v[72:75], v[128:131], v[32:35], v[72:75]
    v_mfma_f32_16x16x32_bf16 v[80:83], v[208:211], v[32:35], v[80:83]
    v_mfma_f32_16x16x32_bf16 v[52:55], a[32:35], v[36:39], v[52:55]
    v_mfma_f32_16x16x32_bf16 v[60:63], a[112:115], v[36:39], v[60:63]
    v_mfma_f32_16x16x32_bf16 v[68:71], a[192:195], v[36:39], v[68:71]
    v_mfma_f32_16x16x32_bf16 v[76:79], v[128:131], v[36:39], v[76:79]
    v_mfma_f32_16x16x32_bf16 v[84:87], v[208:211], v[36:39], v[84:87]
    ds_read_b128 v[32:35], v31 offset:20480
    ds_read_b128 v[36:39], v31 offset:21504
    s_waitcnt lgkmcnt(2)
    v_mfma_f32_16x16x32_bf16 v[48:51], a[36:39], v[40:43], v[48:51]
    v_mfma_f32_16x16x32_bf16 v[56:59], a[116:119], v[40:43], v[56:59]
    v_mfma_f32_16x16x32_bf16 v[64:67], a[196:199], v[40:43], v[64:67]
    v_mfma_f32_16x16x32_bf16 v[72:75], v[132:135], v[40:43], v[72:75]
    v_mfma_f32_16x16x32_bf16 v[80:83], v[212:215], v[40:43], v[80:83]
    v_mfma_f32_16x16x32_bf16 v[52:55], a[36:39], v[44:47], v[52:55]
    v_mfma_f32_16x16x32_bf16 v[60:63], a[116:119], v[44:47], v[60:63]
    v_mfma_f32_16x16x32_bf16 v[68:71], a[196:199], v[44:47], v[68:71]
    v_mfma_f32_16x16x32_bf16 v[76:79], v[132:135], v[44:47], v[76:79]
    v_mfma_f32_16x16x32_bf16 v[84:87], v[212:215], v[44:47], v[84:87]
    ds_read_b128 v[40:43], v31 offset:22528
    ds_read_b128 v[44:47], v31 offset:23552
    s_waitcnt lgkmcnt(2)
    v_mfma_f32_16x16x32_bf16 v[48:51], a[40:43], v[32:35], v[48:51]
    v_mfma_f32_16x16x32_bf16 v[56:59], a[120:123], v[32:35], v[56:59]
    v_mfma_f32_16x16x32_bf16 v[64:67], a[200:203], v[32:35], v[64:67]
    v_mfma_f32_16x16x32_bf16 v[72:75], v[136:139], v[32:35], v[72:75]
    v_mfma_f32_16x16x32_bf16 v[80:83], v[216:219], v[32:35], v[80:83]
    v_mfma_f32_16x16x32_bf16 v[52:55], a[40:43], v[36:39], v[52:55]
    v_mfma_f32_16x16x32_bf16 v[60:63], a[120:123], v[36:39], v[60:63]
    v_mfma_f32_16x16x32_bf16 v[68:71], a[200:203], v[36:39], v[68:71]
    v_mfma_f32_16x16x32_bf16 v[76:79], v[136:139], v[36:39], v[76:79]
    v_mfma_f32_16x16x32_bf16 v[84:87], v[216:219], v[36:39], v[84:87]
    ds_read_b128 v[32:35], v31 offset:24576
    ds_read_b128 v[36:39], v31 offset:25600
    s_waitcnt lgkmcnt(2)
    v_mfma_f32_16x16x32_bf16 v[48:51], a[44:47], v[40:43], v[48:51]
    v_mfma_f32_16x16x32_bf16 v[56:59], a[124:127], v[40:43], v[56:59]
    v_mfma_f32_16x16x32_bf16 v[64:67], a[204:207], v[40:43], v[64:67]
    v_mfma_f32_16x16x32_bf16 v[72:75], v[140:143], v[40:43], v[72:75]
    v_mfma_f32_16x16x32_bf16 v[80:83], v[220:223], v[40:43], v[80:83]
    v_mfma_f32_16x16x32_bf16 v[52:55], a[44:47], v[44:47], v[52:55]
    v_mfma_f32_16x16x32_bf16 v[60:63], a[124:127], v[44:47], v[60:63]
    v_mfma_f32_16x16x32_bf16 v[68:71], a[204:207], v[44:47], v[68:71]
    v_mfma_f32_16x16x32_bf16 v[76:79], v[140:143], v[44:47], v[76:79]
    v_mfma_f32_16x16x32_bf16 v[84:87], v[220:223], v[44:47], v[84:87]
    ds_read_b128 v[40:43], v31 offset:26624
    ds_read_b128 v[44:47], v31 offset:27648
    s_waitcnt lgkmcnt(2)
    v_mfma_f32_16x16x32_bf16 v[48:51], a[48:51], v[32:35], v[48:51]
    v_mfma_f32_16x16x32_bf16 v[56:59], a[128:131], v[32:35], v[56:59]
    v_mfma_f32_16x16x32_bf16 v[64:67], a[208:211], v[32:35], v[64:67]
    v_mfma_f32_16x16x32_bf16 v[72:75], v[144:147], v[32:35], v[72:75]
    v_mfma_f32_16x16x32_bf16 v[80:83], v[224:227], v[32:35], v[80:83]
    v_mfma_f32_16x16x32_bf16 v[52:55], a[48:51], v[36:39], v[52:55]
    v_mfma_f32_16x16x32_bf16 v[60:63], a[128:131], v[36:39], v[60:63]
    v_mfma_f32_16x16x32_bf16 v[68:71], a[208:211], v[36:39], v[68:71]
    v_mfma_f32_16x16x32_bf16 v[76:79], v[144:147], v[36:39], v[76:79]
    v_mfma_f32_16x16x32_bf16 v[84:87], v[224:227], v[36:39], v[84:87]
    ds_read_b128 v[32:35], v31 offset:28672
    ds_read_b128 v[36:39], v31 offset:29696
    s_waitcnt lgkmcnt(2)
    v_mfma_f32_16x16x32_bf16 v[48:51], a[52:55], v[40:43], v[48:51]
    v_mfma_f32_16x16x32_bf16 v[56:59], a[132:135], v[40:43], v[56:59]
    v_mfma_f32_16x16x32_bf16 v[64:67], a[212:215], v[40:43], v[64:67]
    v_mfma_f32_16x16x32_bf16 v[72:75], v[148:151], v[40:43], v[72:75]
    v_mfma_f32_16x16x32_bf16 v[80:83], v[228:231], v[40:43], v[80:83]
    v_mfma_f32_16x16x32_bf16 v[52:55], a[52:55], v[44:47], v[52:55]
    v_mfma_f32_16x16x32_bf16 v[60:63], a[132:135], v[44:47], v[60:63]
    v_mfma_f32_16x16x32_bf16 v[68:71], a[212:215], v[44:47], v[68:71]
    v_mfma_f32_16x16x32_bf16 v[76:79], v[148:151], v[44:47], v[76:79]
    v_mfma_f32_16x16x32_bf16 v[84:87], v[228:231], v[44:47], v[84:87]
    ds_read_b128 v[40:43], v31 offset:30720
    ds_read_b128 v[44:47], v31 offset:31744
    s_waitcnt lgkmcnt(2)
    v_mfma_f32_16x16x32_bf16 v[48:51], a[56:59], v[32:35], v[48:51]
    v_mfma_f32_16x16x32_bf16 v[56:59], a[136:139], v[32:35], v[56:59]
    v_mfma_f32_16x16x32_bf16 v[64:67], a[216:219], v[32:35], v[64:67]
    v_mfma_f32_16x16x32_bf16 v[72:75], v[152:155], v[32:35], v[72:75]
    v_mfma_f32_16x16x32_bf16 v[80:83], v[232:235], v[32:35], v[80:83]
    v_mfma_f32_16x16x32_bf16 v[52:55], a[56:59], v[36:39], v[52:55]
    v_mfma_f32_16x16x32_bf16 v[60:63], a[136:139], v[36:39], v[60:63]
    v_mfma_f32_16x16x32_bf16 v[68:71], a[216:219], v[36:39], v[68:71]
    v_mfma_f32_16x16x32_bf16 v[76:79], v[152:155], v[36:39], v[76:79]
    v_mfma_f32_16x16x32_bf16 v[84:87], v[232:235], v[36:39], v[84:87]
    ds_read_b128 v[32:35], v31 offset:32768
    ds_read_b128 v[36:39], v31 offset:33792
    s_waitcnt lgkmcnt(2)
    v_mfma_f32_16x16x32_bf16 v[48:51], a[60:63], v[40:43], v[48:51]
    v_mfma_f32_16x16x32_bf16 v[56:59], a[140:143], v[40:43], v[56:59]
    v_mfma_f32_16x16x32_bf16 v[64:67], a[220:223], v[40:43], v[64:67]
    v_mfma_f32_16x16x32_bf16 v[72:75], v[156:159], v[40:43], v[72:75]
    v_mfma_f32_16x16x32_bf16 v[80:83], v[236:239], v[40:43], v[80:83]
    v_mfma_f32_16x16x32_bf16 v[52:55], a[60:63], v[44:47], v[52:55]
    v_mfma_f32_16x16x32_bf16 v[60:63], a[140:143], v[44:47], v[60:63]
    v_mfma_f32_16x16x32_bf16 v[68:71], a[220:223], v[44:47], v[68:71]
    v_mfma_f32_16x16x32_bf16 v[76:79], v[156:159], v[44:47], v[76:79]
    v_mfma_f32_16x16x32_bf16 v[84:87], v[236:239], v[44:47], v[84:87]
    ds_read_b128 v[40:43], v31 offset:34816
    ds_read_b128 v[44:47], v31 offset:35840
    s_waitcnt lgkmcnt(2)
    v_mfma_f32_16x16x32_bf16 v[48:51], a[64:67], v[32:35], v[48:51]
    v_mfma_f32_16x16x32_bf16 v[56:59], a[144:147], v[32:35], v[56:59]
    v_mfma_f32_16x16x32_bf16 v[64:67], a[224:227], v[32:35], v[64:67]
    v_mfma_f32_16x16x32_bf16 v[72:75], v[160:163], v[32:35], v[72:75]
    v_mfma_f32_16x16x32_bf16 v[80:83], v[240:243], v[32:35], v[80:83]
    v_mfma_f32_16x16x32_bf16 v[52:55], a[64:67], v[36:39], v[52:55]
    v_mfma_f32_16x16x32_bf16 v[60:63], a[144:147], v[36:39], v[60:63]
    v_mfma_f32_16x16x32_bf16 v[68:71], a[224:227], v[36:39], v[68:71]
    v_mfma_f32_16x16x32_bf16 v[76:79], v[160:163], v[36:39], v[76:79]
    v_mfma_f32_16x16x32_bf16 v[84:87], v[240:243], v[36:39], v[84:87]
    ds_read_b128 v[32:35], v31 offset:36864
    ds_read_b128 v[36:39], v31 offset:37888
    s_waitcnt lgkmcnt(2)
    v_mfma_f32_16x16x32_bf16 v[48:51], a[68:71], v[40:43], v[48:51]
    v_mfma_f32_16x16x32_bf16 v[56:59], a[148:151], v[40:43], v[56:59]
    v_mfma_f32_16x16x32_bf16 v[64:67], a[228:231], v[40:43], v[64:67]
    v_mfma_f32_16x16x32_bf16 v[72:75], v[164:167], v[40:43], v[72:75]
    v_mfma_f32_16x16x32_bf16 v[80:83], v[244:247], v[40:43], v[80:83]
    v_mfma_f32_16x16x32_bf16 v[52:55], a[68:71], v[44:47], v[52:55]
    v_mfma_f32_16x16x32_bf16 v[60:63], a[148:151], v[44:47], v[60:63]
    v_mfma_f32_16x16x32_bf16 v[68:71], a[228:231], v[44:47], v[68:71]
    v_mfma_f32_16x16x32_bf16 v[76:79], v[164:167], v[44:47], v[76:79]
    v_mfma_f32_16x16x32_bf16 v[84:87], v[244:247], v[44:47], v[84:87]
    ds_read_b128 v[40:43], v31 offset:38912
    ds_read_b128 v[44:47], v31 offset:39936
    s_waitcnt lgkmcnt(2)
    v_mfma_f32_16x16x32_bf16 v[48:51], a[72:75], v[32:35], v[48:51]
    v_mfma_f32_16x16x32_bf16 v[56:59], a[152:155], v[32:35], v[56:59]
    v_mfma_f32_16x16x32_bf16 v[64:67], a[232:235], v[32:35], v[64:67]
    v_mfma_f32_16x16x32_bf16 v[72:75], v[168:171], v[32:35], v[72:75]
    v_mfma_f32_16x16x32_bf16 v[80:83], v[248:251], v[32:35], v[80:83]
    v_mfma_f32_16x16x32_bf16 v[52:55], a[72:75], v[36:39], v[52:55]
    v_mfma_f32_16x16x32_bf16 v[60:63], a[152:155], v[36:39], v[60:63]
    v_mfma_f32_16x16x32_bf16 v[68:71], a[232:235], v[36:39], v[68:71]
    v_mfma_f32_16x16x32_bf16 v[76:79], v[168:171], v[36:39], v[76:79]
    v_mfma_f32_16x16x32_bf16 v[84:87], v[248:251], v[36:39], v[84:87]
    s_waitcnt lgkmcnt(0)
    v_mfma_f32_16x16x32_bf16 v[48:51], a[76:79], v[40:43], v[48:51]
    v_mfma_f32_16x16x32_bf16 v[56:59], a[156:159], v[40:43], v[56:59]
    v_mfma_f32_16x16x32_bf16 v[64:67], a[236:239], v[40:43], v[64:67]
    v_mfma_f32_16x16x32_bf16 v[72:75], v[172:175], v[40:43], v[72:75]
    v_mfma_f32_16x16x32_bf16 v[80:83], v[252:255], v[40:43], v[80:83]
    v_mfma_f32_16x16x32_bf16 v[52:55], a[76:79], v[44:47], v[52:55]
    v_mfma_f32_16x16x32_bf16 v[60:63], a[156:159], v[44:47], v[60:63]
    v_mfma_f32_16x16x32_bf16 v[68:71], a[236:239], v[44:47], v[68:71]
    v_mfma_f32_16x16x32_bf16 v[76:79], v[172:175], v[44:47], v[76:79]
    v_mfma_f32_16x16x32_bf16 v[84:87], v[252:255], v[44:47], v[84:87]
    v_mul_f32 v48, s39, v48
    v_mul_f32 v49, s39, v49
    v_mul_f32 v50, s39, v50
    v_mul_f32 v51, s39, v51
    v_cvt_pk_bf16_f32 v48, v48, v49
    v_cvt_pk_bf16_f32 v49, v50, v51
    ds_write_b64 v10, v[48:49] offset:0
    v_mul_f32 v52, s39, v52
    v_mul_f32 v53, s39, v53
    v_mul_f32 v54, s39, v54
    v_mul_f32 v55, s39, v55
    v_cvt_pk_bf16_f32 v52, v52, v53
    v_cvt_pk_bf16_f32 v53, v54, v55
    ds_write_b64 v10, v[52:53] offset:256
    v_mul_f32 v56, s39, v56
    v_mul_f32 v57, s39, v57
    v_mul_f32 v58, s39, v58
    v_mul_f32 v59, s39, v59
    v_cvt_pk_bf16_f32 v56, v56, v57
    v_cvt_pk_bf16_f32 v57, v58, v59
    ds_write_b64 v11, v[56:57] offset:0
    v_mul_f32 v60, s39, v60
    v_mul_f32 v61, s39, v61
    v_mul_f32 v62, s39, v62
    v_mul_f32 v63, s39, v63
    v_cvt_pk_bf16_f32 v60, v60, v61
    v_cvt_pk_bf16_f32 v61, v62, v63
    ds_write_b64 v11, v[60:61] offset:256
    v_mul_f32 v64, s39, v64
    v_mul_f32 v65, s39, v65
    v_mul_f32 v66, s39, v66
    v_mul_f32 v67, s39, v67
    v_cvt_pk_bf16_f32 v64, v64, v65
    v_cvt_pk_bf16_f32 v65, v66, v67
    ds_write_b64 v12, v[64:65] offset:0
    v_mul_f32 v68, s39, v68
    v_mul_f32 v69, s39, v69
    v_mul_f32 v70, s39, v70
    v_mul_f32 v71, s39, v71
    v_cvt_pk_bf16_f32 v68, v68, v69
    v_cvt_pk_bf16_f32 v69, v70, v71
    ds_write_b64 v12, v[68:69] offset:256
    v_mul_f32 v72, s39, v72
    v_mul_f32 v73, s39, v73
    v_mul_f32 v74, s39, v74
    v_mul_f32 v75, s39, v75
    v_cvt_pk_bf16_f32 v72, v72, v73
    v_cvt_pk_bf16_f32 v73, v74, v75
    ds_write_b64 v13, v[72:73] offset:0
    v_mul_f32 v76, s39, v76
    v_mul_f32 v77, s39, v77
    v_mul_f32 v78, s39, v78
    v_mul_f32 v79, s39, v79
    v_cvt_pk_bf16_f32 v76, v76, v77
    v_cvt_pk_bf16_f32 v77, v78, v79
    ds_write_b64 v13, v[76:77] offset:256
    v_mul_f32 v80, s39, v80
    v_mul_f32 v81, s39, v81
    v_mul_f32 v82, s39, v82
    v_mul_f32 v83, s39, v83
    v_cvt_pk_bf16_f32 v80, v80, v81
    v_cvt_pk_bf16_f32 v81, v82, v83
    ds_write_b64 v14, v[80:81] offset:0
    v_mul_f32 v84, s39, v84
    v_mul_f32 v85, s39, v85
    v_mul_f32 v86, s39, v86
    v_mul_f32 v87, s39, v87
    v_cvt_pk_bf16_f32 v84, v84, v85
    v_cvt_pk_bf16_f32 v85, v86, v87
    ds_write_b64 v14, v[84:85] offset:256
    s_waitcnt lgkmcnt(0)
    ds_read_b128 v[88:91], v24 offset:0
    ds_read_b128 v[92:95], v24 offset:1024
    ds_read_b128 v[96:99], v24 offset:2048
    ds_read_b128 v[100:103], v24 offset:3072
    ds_read_b128 v[104:107], v24 offset:4096
    ds_read_b128 v[108:111], v24 offset:5120
    s_waitcnt lgkmcnt(5)
    buffer_store_dwordx4 v[88:91], v18, s[4:7], s37 offen sc1
    s_waitcnt lgkmcnt(4)
    buffer_store_dwordx4 v[92:95], v19, s[4:7], s37 offen sc1
    s_waitcnt lgkmcnt(3)
    buffer_store_dwordx4 v[96:99], v20, s[4:7], s37 offen sc1
    s_waitcnt lgkmcnt(2)
    buffer_store_dwordx4 v[100:103], v21, s[4:7], s37 offen sc1
    s_waitcnt lgkmcnt(1)
    buffer_store_dwordx4 v[104:107], v22, s[4:7], s37 offen sc1
    s_waitcnt lgkmcnt(0)
    buffer_store_dwordx4 v[108:111], v23, s[4:7], s37 offen sc1
    s_add_u32 s37, s37, 1536
    s_mov_b32 s31, s44
    s_mov_b32 s44, s45
    s_mov_b32 s45, s46
    s_mov_b32 s46, s31
    s_add_u32 s34, s34, 40960
    s_add_u32 s35, s35, 1
    s_branch AQK_3
E_6:
    s_branch AQE_2
AQV_1:
    v_lshrrev_b32 v9, 2, v2
    v_add_u32 v9, 0, v9
    v_mul_u32_u24 v9, 52, v9
    v_lshrrev_b32 v9, 8, v9
    v_lshrrev_b32 v8, 2, v2
    v_add_u32 v8, 0, v8
    v_mul_u32_u24 v4, 5, v9
    v_sub_u32 v8, v8, v4
    v_mul_u32_u24 v10, 1536, v9
    v_lshlrev_b32 v4, 2, v8
    v_and_b32 v5, 3, v2
    v_add_u32 v4, v4, v5
    v_lshlrev_b32 v4, 4, v4
    v_add_u32 v10, v10, v4
    v_and_b32 v4, 1, v3
    v_mul_u32_u24 v4, 384, v4
    v_add_u32 v10, v10, v4
    v_lshrrev_b32 v4, 1, v3
    v_lshlrev_b32 v4, 3, v4
    v_add_u32 v10, v10, v4
    v_mov_b32 v4, s24
    v_mul_u32_u24 v4, 6144, v4
    v_add_u32 v4, 40960, v4
    v_add_u32 v10, v10, v4
    v_lshrrev_b32 v9, 2, v2
    v_add_u32 v9, 4, v9
    v_mul_u32_u24 v9, 52, v9
    v_lshrrev_b32 v9, 8, v9
    v_lshrrev_b32 v8, 2, v2
    v_add_u32 v8, 4, v8
    v_mul_u32_u24 v4, 5, v9
    v_sub_u32 v8, v8, v4
    v_mul_u32_u24 v11, 1536, v9
    v_lshlrev_b32 v4, 2, v8
    v_and_b32 v5, 3, v2
    v_add_u32 v4, v4, v5
    v_lshlrev_b32 v4, 4, v4
    v_add_u32 v11, v11, v4
    v_and_b32 v4, 1, v3
    v_mul_u32_u24 v4, 384, v4
    v_add_u32 v11, v11, v4
    v_lshrrev_b32 v4, 1, v3
    v_lshlrev_b32 v4, 3, v4
    v_add_u32 v11, v11, v4
    v_mov_b32 v4, s24
    v_mul_u32_u24 v4, 6144, v4
    v_add_u32 v4, 40960, v4
    v_add_u32 v11, v11, v4
    v_lshrrev_b32 v9, 2, v2
    v_add_u32 v9, 8, v9
    v_mul_u32_u24 v9, 52, v9
    v_lshrrev_b32 v9, 8, v9
    v_lshrrev_b32 v8, 2, v2
    v_add_u32 v8, 8, v8
    v_mul_u32_u24 v4, 5, v9
    v_sub_u32 v8, v8, v4
    v_mul_u32_u24 v12, 1536, v9
    v_lshlrev_b32 v4, 2, v8
    v_and_b32 v5, 3, v2
    v_add_u32 v4, v4, v5
    v_lshlrev_b32 v4, 4, v4
    v_add_u32 v12, v12, v4
    v_and_b32 v4, 1, v3
    v_mul_u32_u24 v4, 384, v4
    v_add_u32 v12, v12, v4
    v_lshrrev_b32 v4, 1, v3
    v_lshlrev_b32 v4, 3, v4
    v_add_u32 v12, v12, v4
    v_mov_b32 v4, s24
    v_mul_u32_u24 v4, 6144, v4
    v_add_u32 v4, 40960, v4
    v_add_u32 v12, v12, v4
    v_lshrrev_b32 v9, 2, v2
    v_add_u32 v9, 12, v9
    v_mul_u32_u24 v9, 52, v9
    v_lshrrev_b32 v9, 8, v9
    v_lshrrev_b32 v8, 2, v2
    v_add_u32 v8, 12, v8
    v_mul_u32_u24 v4, 5, v9
    v_sub_u32 v8, v8, v4
    v_mul_u32_u24 v13, 1536, v9
    v_lshlrev_b32 v4, 2, v8
    v_and_b32 v5, 3, v2
    v_add_u32 v4, v4, v5
    v_lshlrev_b32 v4, 4, v4
    v_add_u32 v13, v13, v4
    v_and_b32 v4, 1, v3
    v_mul_u32_u24 v4, 384, v4
    v_add_u32 v13, v13, v4
    v_lshrrev_b32 v4, 1, v3
    v_lshlrev_b32 v4, 3, v4
    v_add_u32 v13, v13, v4
    v_mov_b32 v4, s24
    v_mul_u32_u24 v4, 6144, v4
    v_add_u32 v4, 40960, v4
    v_add_u32 v13, v13, v4
    v_lshrrev_b32 v9, 2, v2
    v_add_u32 v9, 16, v9
    v_mul_u32_u24 v9, 52, v9
    v_lshrrev_b32 v9, 8, v9
    v_lshrrev_b32 v8, 2, v2
    v_add_u32 v8, 16, v8
    v_mul_u32_u24 v4, 5, v9
    v_sub_u32 v8, v8, v4
    v_mul_u32_u24 v14, 1536, v9
    v_lshlrev_b32 v4, 2, v8
    v_and_b32 v5, 3, v2
    v_add_u32 v4, v4, v5
    v_lshlrev_b32 v4, 4, v4
    v_add_u32 v14, v14, v4
    v_and_b32 v4, 1, v3
    v_mul_u32_u24 v4, 384, v4
    v_add_u32 v14, v14, v4
    v_lshrrev_b32 v4, 1, v3
    v_lshlrev_b32 v4, 3, v4
    v_add_u32 v14, v14, v4
    v_mov_b32 v4, s24
    v_mul_u32_u24 v4, 6144, v4
    v_add_u32 v4, 40960, v4
    v_add_u32 v14, v14, v4
    v_and_b32 v15, 3, v2
    v_mul_u32_u24 v15, 1536, v15
    v_lshrrev_b32 v4, 2, v2
    v_add_u32 v4, 20, v4
    v_lshlrev_b32 v4, 4, v4
    v_add_u32 v15, v15, v4
    v_and_b32 v4, 1, v3
    v_mul_u32_u24 v4, 384, v4
    v_add_u32 v15, v15, v4
    v_lshrrev_b32 v4, 1, v3
    v_lshlrev_b32 v4, 3, v4
    v_add_u32 v15, v15, v4
    v_mov_b32 v4, s24
    v_mul_u32_u24 v4, 6144, v4
    v_add_u32 v4, 40960, v4
    v_add_u32 v15, v15, v4
    v_mov_b32 v16, 0x3f803f80
    v_mov_b32 v17, 0x3f803f80
    ds_write_b64 v15, v[16:17]
    ds_write_b64 v15, v[16:17] offset:768
    v_add_u32 v9, 0, v1
    v_mul_u32_u24 v9, 683, v9
    v_lshrrev_b32 v9, 16, v9
    v_add_u32 v8, 0, v1
    v_mul_u32_u24 v4, 96, v9
    v_sub_u32 v8, v8, v4
    v_mul_u32_u24 v7, 43, v8
    v_lshrrev_b32 v7, 10, v7
    v_add_u32 v18, s37, v9
    v_mul_u32_u24 v18, 131072, v18
    v_lshlrev_b32 v4, 4, v8
    v_add_u32 v18, v18, v4
    v_lshlrev_b32 v4, 7, v7
    v_add_u32 v18, v18, v4
    v_add_u32 v9, 64, v1
    v_mul_u32_u24 v9, 683, v9
    v_lshrrev_b32 v9, 16, v9
    v_add_u32 v8, 64, v1
    v_mul_u32_u24 v4, 96, v9
    v_sub_u32 v8, v8, v4
    v_mul_u32_u24 v7, 43, v8
    v_lshrrev_b32 v7, 10, v7
    v_add_u32 v19, s37, v9
    v_mul_u32_u24 v19, 131072, v19
    v_lshlrev_b32 v4, 4, v8
    v_add_u32 v19, v19, v4
    v_lshlrev_b32 v4, 7, v7
    v_add_u32 v19, v19, v4
    v_add_u32 v9, 128, v1
    v_mul_u32_u24 v9, 683, v9
    v_lshrrev_b32 v9, 16, v9
    v_add_u32 v8, 128, v1
    v_mul_u32_u24 v4, 96, v9
    v_sub_u32 v8, v8, v4
    v_mul_u32_u24 v7, 43, v8
    v_lshrrev_b32 v7, 10, v7
    v_add_u32 v20, s37, v9
    v_mul_u32_u24 v20, 131072, v20
    v_lshlrev_b32 v4, 4, v8
    v_add_u32 v20, v20, v4
    v_lshlrev_b32 v4, 7, v7
    v_add_u32 v20, v20, v4
    v_add_u32 v9, 192, v1
    v_mul_u32_u24 v9, 683, v9
    v_lshrrev_b32 v9, 16, v9
    v_add_u32 v8, 192, v1
    v_mul_u32_u24 v4, 96, v9
    v_sub_u32 v8, v8, v4
    v_mul_u32_u24 v7, 43, v8
    v_lshrrev_b32 v7, 10, v7
    v_add_u32 v21, s37, v9
    v_mul_u32_u24 v21, 131072, v21
    v_lshlrev_b32 v4, 4, v8
    v_add_u32 v21, v21, v4
    v_lshlrev_b32 v4, 7, v7
    v_add_u32 v21, v21, v4
    v_add_u32 v9, 256, v1
    v_mul_u32_u24 v9, 683, v9
    v_lshrrev_b32 v9, 16, v9
    v_add_u32 v8, 256, v1
    v_mul_u32_u24 v4, 96, v9
    v_sub_u32 v8, v8, v4
    v_mul_u32_u24 v7, 43, v8
    v_lshrrev_b32 v7, 10, v7
    v_add_u32 v22, s37, v9
    v_mul_u32_u24 v22, 131072, v22
    v_lshlrev_b32 v4, 4, v8
    v_add_u32 v22, v22, v4
    v_lshlrev_b32 v4, 7, v7
    v_add_u32 v22, v22, v4
    v_add_u32 v9, 320, v1
    v_mul_u32_u24 v9, 683, v9
    v_lshrrev_b32 v9, 16, v9
    v_add_u32 v8, 320, v1
    v_mul_u32_u24 v4, 96, v9
    v_sub_u32 v8, v8, v4
    v_mul_u32_u24 v7, 43, v8
    v_lshrrev_b32 v7, 10, v7
    v_add_u32 v23, s37, v9
    v_mul_u32_u24 v23, 131072, v23
    v_lshlrev_b32 v4, 4, v8
    v_add_u32 v23, v23, v4
    v_lshlrev_b32 v4, 7, v7
    v_add_u32 v23, v23, v4
    v_lshlrev_b32 v24, 4, v1
    v_mov_b32 v4, s24
    v_mul_u32_u24 v4, 6144, v4
    v_add_u32 v4, 40960, v4
    v_add_u32 v24, v24, v4
    s_mul_i32 s37, s33, 16384
    s_add_u32 s37, s37, 60817408
    s_mov_b32 s35, 0
    s_mov_b32 s44, 69632
    s_mov_b32 s45, 110592
    s_mov_b32 s46, 0
    s_waitcnt vmcnt(10)
    s_branch PW_16
AV_11:
    s_cmp_eq_u32 s35, 1
    s_cbranch_scc1 FW_15
    s_cmp_eq_u32 s35, 16
    s_cbranch_scc1 FW_15
    s_cmp_eq_u32 s35, 15
    s_cbranch_scc1 LW_18
    s_waitcnt vmcnt(16)
    s_branch PW_16
LW_18:
    s_waitcnt vmcnt(6)
    s_branch PW_16
FW_15:
    s_waitcnt vmcnt(0)
PW_16:
    s_barrier
    s_cmp_eq_u32 s35, 16
    s_cbranch_scc1 E_14
    v_lshlrev_b32 v31, 4, v1
    v_add_u32 v31, s44, v31
    s_cmp_ge_u32 s35, 14
    s_cbranch_scc1 SK_12
    s_add_u32 s36, s34, 81920
    s_add_u32 s28, s47, s46
    s_add_u32 m0, s28, 0
    s_add_u32 s27, s36, 0
    buffer_load_dwordx4 v30, s[40:43], s27 offen lds
    s_add_u32 m0, s28, 1024
    s_add_u32 s27, s36, 20480
    buffer_load_dwordx4 v30, s[40:43], s27 offen lds
    s_add_u32 m0, s28, 2048
    s_add_u32 s27, s36, 64
    buffer_load_dwordx4 v30, s[40:43], s27 offen lds
    s_add_u32 m0, s28, 3072
    s_add_u32 s27, s36, 20544
    buffer_load_dwordx4 v30, s[40:43], s27 offen lds
    s_add_u32 m0, s28, 4096
    s_add_u32 s27, s36, 128
    buffer_load_dwordx4 v30, s[40:43], s27 offen lds
    s_add_u32 m0, s28, 5120
    s_add_u32 s27, s36, 20608
    buffer_load_dwordx4 v30, s[40:43], s27 offen lds
    s_add_u32 m0, s28, 6144
    s_add_u32 s27, s36, 192
    buffer_load_dwordx4 v30, s[40:43], s27 offen lds
    s_add_u32 m0, s28, 7168
    s_add_u32 s27, s36, 20672
    buffer_load_dwordx4 v30, s[40:43], s27 offen lds
    s_add_u32 m0, s28, 8192
    s_add_u32 s27, s36, 256
    buffer_load_dwordx4 v30, s[40:43], s27 offen lds
    s_add_u32 m0, s28, 9216
    s_add_u32 s27, s36, 20736
    buffer_load_dwordx4 v30, s[40:43], s27 offen lds
SK_12:
    ds_read_b128 v[32:35], v31 offset:0
    ds_read_b128 v[36:39], v31 offset:1024
    ds_read_b128 v[40:43], v31 offset:2048
    ds_read_b128 v[44:47], v31 offset:3072
    s_waitcnt lgkmcnt(2)
    v_mfma_f32_16x16x32_bf16 v[48:51], v[32:35], a[0:3], 0
    v_mfma_f32_16x16x32_bf16 v[56:59], v[32:35], a[80:83], 0
    v_mfma_f32_16x16x32_bf16 v[64:67], v[32:35], a[160:163], 0
    v_mfma_f32_16x16x32_bf16 v[72:75], v[32:35], a[240:243], 0
    v_mfma_f32_16x16x32_bf16 v[80:83], v[32:35], v[176:179], 0
    v_mfma_f32_16x16x32_bf16 v[52:55], v[36:39], a[0:3], 0
    v_mfma_f32_16x16x32_bf16 v[60:63], v[36:39], a[80:83], 0
    v_mfma_f32_16x16x32_bf16 v[68:71], v[36:39], a[160:163], 0
    v_mfma_f32_16x16x32_bf16 v[76:79], v[36:39], a[240:243], 0
    v_mfma_f32_16x16x32_bf16 v[84:87], v[36:39], v[176:179], 0
    ds_read_b128 v[32:35], v31 offset:4096
    ds_read_b128 v[36:39], v31 offset:5120
    s_waitcnt lgkmcnt(2)
    v_mfma_f32_16x16x32_bf16 v[48:51], v[40:43], a[4:7], v[48:51]
    v_mfma_f32_16x16x32_bf16 v[56:59], v[40:43], a[84:87], v[56:59]
    v_mfma_f32_16x16x32_bf16 v[64:67], v[40:43], a[164:167], v[64:67]
    v_mfma_f32_16x16x32_bf16 v[72:75], v[40:43], a[244:247], v[72:75]
    v_mfma_f32_16x16x32_bf16 v[80:83], v[40:43], v[180:183], v[80:83]
    v_mfma_f32_16x16x32_bf16 v[52:55], v[44:47], a[4:7], v[52:55]
    v_mfma_f32_16x16x32_bf16 v[60:63], v[44:47], a[84:87], v[60:63]
    v_mfma_f32_16x16x32_bf16 v[68:71], v[44:47], a[164:167], v[68:71]
    v_mfma_f32_16x16x32_bf16 v[76:79], v[44:47], a[244:247], v[76:79]
    v_mfma_f32_16x16x32_bf16 v[84:87], v[44:47], v[180:183], v[84:87]
    ds_read_b128 v[40:43], v31 offset:6144
    ds_read_b128 v[44:47], v31 offset:7168
    s_waitcnt lgkmcnt(2)
    v_mfma_f32_16x16x32_bf16 v[48:51], v[32:35], a[8:11], v[48:51]
    v_mfma_f32_16x16x32_bf16 v[56:59], v[32:35], a[88:91], v[56:59]
    v_mfma_f32_16x16x32_bf16 v[64:67], v[32:35], a[168:171], v[64:67]
    v_mfma_f32_16x16x32_bf16 v[72:75], v[32:35], a[248:251], v[72:75]
    v_mfma_f32_16x16x32_bf16 v[80:83], v[32:35], v[184:187], v[80:83]
    v_mfma_f32_16x16x32_bf16 v[52:55], v[36:39], a[8:11], v[52:55]
    v_mfma_f32_16x16x32_bf16 v[60:63], v[36:39], a[88:91], v[60:63]
    v_mfma_f32_16x16x32_bf16 v[68:71], v[36:39], a[168:171], v[68:71]
    v_mfma_f32_16x16x32_bf16 v[76:79], v[36:39], a[248:251], v[76:79]
    v_mfma_f32_16x16x32_bf16 v[84:87], v[36:39], v[184:187], v[84:87]
    ds_read_b128 v[32:35], v31 offset:8192
    ds_read_b128 v[36:39], v31 offset:9216
    s_waitcnt lgkmcnt(2)
    v_mfma_f32_16x16x32_bf16 v[48:51], v[40:43], a[12:15], v[48:51]
    v_mfma_f32_16x16x32_bf16 v[56:59], v[40:43], a[92:95], v[56:59]
    v_mfma_f32_16x16x32_bf16 v[64:67], v[40:43], a[172:175], v[64:67]
    v_mfma_f32_16x16x32_bf16 v[72:75], v[40:43], a[252:255], v[72:75]
    v_mfma_f32_16x16x32_bf16 v[80:83], v[40:43], v[188:191], v[80:83]
    v_mfma_f32_16x16x32_bf16 v[52:55], v[44:47], a[12:15], v[52:55]
    v_mfma_f32_16x16x32_bf16 v[60:63], v[44:47], a[92:95], v[60:63]
    v_mfma_f32_16x16x32_bf16 v[68:71], v[44:47], a[172:175], v[68:71]
    v_mfma_f32_16x16x32_bf16 v[76:79], v[44:47], a[252:255], v[76:79]
    v_mfma_f32_16x16x32_bf16 v[84:87], v[44:47], v[188:191], v[84:87]
    ds_read_b128 v[40:43], v31 offset:10240
    ds_read_b128 v[44:47], v31 offset:11264
    s_waitcnt lgkmcnt(2)
    v_mfma_f32_16x16x32_bf16 v[48:51], v[32:35], a[16:19], v[48:51]
    v_mfma_f32_16x16x32_bf16 v[56:59], v[32:35], a[96:99], v[56:59]
    v_mfma_f32_16x16x32_bf16 v[64:67], v[32:35], a[176:179], v[64:67]
    v_mfma_f32_16x16x32_bf16 v[72:75], v[32:35], v[112:115], v[72:75]
    v_mfma_f32_16x16x32_bf16 v[80:83], v[32:35], v[192:195], v[80:83]
    v_mfma_f32_16x16x32_bf16 v[52:55], v[36:39], a[16:19], v[52:55]
    v_mfma_f32_16x16x32_bf16 v[60:63], v[36:39], a[96:99], v[60:63]
    v_mfma_f32_16x16x32_bf16 v[68:71], v[36:39], a[176:179], v[68:71]
    v_mfma_f32_16x16x32_bf16 v[76:79], v[36:39], v[112:115], v[76:79]
    v_mfma_f32_16x16x32_bf16 v[84:87], v[36:39], v[192:195], v[84:87]
    ds_read_b128 v[32:35], v31 offset:12288
    ds_read_b128 v[36:39], v31 offset:13312
    s_waitcnt lgkmcnt(2)
    v_mfma_f32_16x16x32_bf16 v[48:51], v[40:43], a[20:23], v[48:51]
    v_mfma_f32_16x16x32_bf16 v[56:59], v[40:43], a[100:103], v[56:59]
    v_mfma_f32_16x16x32_bf16 v[64:67], v[40:43], a[180:183], v[64:67]
    v_mfma_f32_16x16x32_bf16 v[72:75], v[40:43], v[116:119], v[72:75]
    v_mfma_f32_16x16x32_bf16 v[80:83], v[40:43], v[196:199], v[80:83]
    v_mfma_f32_16x16x32_bf16 v[52:55], v[44:47], a[20:23], v[52:55]
    v_mfma_f32_16x16x32_bf16 v[60:63], v[44:47], a[100:103], v[60:63]
    v_mfma_f32_16x16x32_bf16 v[68:71], v[44:47], a[180:183], v[68:71]
    v_mfma_f32_16x16x32_bf16 v[76:79], v[44:47], v[116:119], v[76:79]
    v_mfma_f32_16x16x32_bf16 v[84:87], v[44:47], v[196:199], v[84:87]
    ds_read_b128 v[40:43], v31 offset:14336
    ds_read_b128 v[44:47], v31 offset:15360
    s_waitcnt lgkmcnt(2)
    v_mfma_f32_16x16x32_bf16 v[48:51], v[32:35], a[24:27], v[48:51]
    v_mfma_f32_16x16x32_bf16 v[56:59], v[32:35], a[104:107], v[56:59]
    v_mfma_f32_16x16x32_bf16 v[64:67], v[32:35], a[184:187], v[64:67]
    v_mfma_f32_16x16x32_bf16 v[72:75], v[32:35], v[120:123], v[72:75]
    v_mfma_f32_16x16x32_bf16 v[80:83], v[32:35], v[200:203], v[80:83]
    v_mfma_f32_16x16x32_bf16 v[52:55], v[36:39], a[24:27], v[52:55]
    v_mfma_f32_16x16x32_bf16 v[60:63], v[36:39], a[104:107], v[60:63]
    v_mfma_f32_16x16x32_bf16 v[68:71], v[36:39], a[184:187], v[68:71]
    v_mfma_f32_16x16x32_bf16 v[76:79], v[36:39], v[120:123], v[76:79]
    v_mfma_f32_16x16x32_bf16 v[84:87], v[36:39], v[200:203], v[84:87]
    ds_read_b128 v[32:35], v31 offset:16384
    ds_read_b128 v[36:39], v31 offset:17408
    s_waitcnt lgkmcnt(2)
    v_mfma_f32_16x16x32_bf16 v[48:51], v[40:43], a[28:31], v[48:51]
    v_mfma_f32_16x16x32_bf16 v[56:59], v[40:43], a[108:111], v[56:59]
    v_mfma_f32_16x16x32_bf16 v[64:67], v[40:43], a[188:191], v[64:67]
    v_mfma_f32_16x16x32_bf16 v[72:75], v[40:43], v[124:127], v[72:75]
    v_mfma_f32_16x16x32_bf16 v[80:83], v[40:43], v[204:207], v[80:83]
    v_mfma_f32_16x16x32_bf16 v[52:55], v[44:47], a[28:31], v[52:55]
    v_mfma_f32_16x16x32_bf16 v[60:63], v[44:47], a[108:111], v[60:63]
    v_mfma_f32_16x16x32_bf16 v[68:71], v[44:47], a[188:191], v[68:71]
    v_mfma_f32_16x16x32_bf16 v[76:79], v[44:47], v[124:127], v[76:79]
    v_mfma_f32_16x16x32_bf16 v[84:87], v[44:47], v[204:207], v[84:87]
    ds_read_b128 v[40:43], v31 offset:18432
    ds_read_b128 v[44:47], v31 offset:19456
    s_waitcnt lgkmcnt(2)
    v_mfma_f32_16x16x32_bf16 v[48:51], v[32:35], a[32:35], v[48:51]
    v_mfma_f32_16x16x32_bf16 v[56:59], v[32:35], a[112:115], v[56:59]
    v_mfma_f32_16x16x32_bf16 v[64:67], v[32:35], a[192:195], v[64:67]
    v_mfma_f32_16x16x32_bf16 v[72:75], v[32:35], v[128:131], v[72:75]
    v_mfma_f32_16x16x32_bf16 v[80:83], v[32:35], v[208:211], v[80:83]
    v_mfma_f32_16x16x32_bf16 v[52:55], v[36:39], a[32:35], v[52:55]
    v_mfma_f32_16x16x32_bf16 v[60:63], v[36:39], a[112:115], v[60:63]
    v_mfma_f32_16x16x32_bf16 v[68:71], v[36:39], a[192:195], v[68:71]
    v_mfma_f32_16x16x32_bf16 v[76:79], v[36:39], v[128:131], v[76:79]
    v_mfma_f32_16x16x32_bf16 v[84:87], v[36:39], v[208:211], v[84:87]
    ds_read_b128 v[32:35], v31 offset:20480
    ds_read_b128 v[36:39], v31 offset:21504
    s_waitcnt lgkmcnt(2)
    v_mfma_f32_16x16x32_bf16 v[48:51], v[40:43], a[36:39], v[48:51]
    v_mfma_f32_16x16x32_bf16 v[56:59], v[40:43], a[116:119], v[56:59]
    v_mfma_f32_16x16x32_bf16 v[64:67], v[40:43], a[196:199], v[64:67]
    v_mfma_f32_16x16x32_bf16 v[72:75], v[40:43], v[132:135], v[72:75]
    v_mfma_f32_16x16x32_bf16 v[80:83], v[40:43], v[212:215], v[80:83]
    v_mfma_f32_16x16x32_bf16 v[52:55], v[44:47], a[36:39], v[52:55]
    v_mfma_f32_16x16x32_bf16 v[60:63], v[44:47], a[116:119], v[60:63]
    v_mfma_f32_16x16x32_bf16 v[68:71], v[44:47], a[196:199], v[68:71]
    v_mfma_f32_16x16x32_bf16 v[76:79], v[44:47], v[132:135], v[76:79]
    v_mfma_f32_16x16x32_bf16 v[84:87], v[44:47], v[212:215], v[84:87]
    ds_read_b128 v[40:43], v31 offset:22528
    ds_read_b128 v[44:47], v31 offset:23552
    s_waitcnt lgkmcnt(2)
    v_mfma_f32_16x16x32_bf16 v[48:51], v[32:35], a[40:43], v[48:51]
    v_mfma_f32_16x16x32_bf16 v[56:59], v[32:35], a[120:123], v[56:59]
    v_mfma_f32_16x16x32_bf16 v[64:67], v[32:35], a[200:203], v[64:67]
    v_mfma_f32_16x16x32_bf16 v[72:75], v[32:35], v[136:139], v[72:75]
    v_mfma_f32_16x16x32_bf16 v[80:83], v[32:35], v[216:219], v[80:83]
    v_mfma_f32_16x16x32_bf16 v[52:55], v[36:39], a[40:43], v[52:55]
    v_mfma_f32_16x16x32_bf16 v[60:63], v[36:39], a[120:123], v[60:63]
    v_mfma_f32_16x16x32_bf16 v[68:71], v[36:39], a[200:203], v[68:71]
    v_mfma_f32_16x16x32_bf16 v[76:79], v[36:39], v[136:139], v[76:79]
    v_mfma_f32_16x16x32_bf16 v[84:87], v[36:39], v[216:219], v[84:87]
    ds_read_b128 v[32:35], v31 offset:24576
    ds_read_b128 v[36:39], v31 offset:25600
    s_waitcnt lgkmcnt(2)
    v_mfma_f32_16x16x32_bf16 v[48:51], v[40:43], a[44:47], v[48:51]
    v_mfma_f32_16x16x32_bf16 v[56:59], v[40:43], a[124:127], v[56:59]
    v_mfma_f32_16x16x32_bf16 v[64:67], v[40:43], a[204:207], v[64:67]
    v_mfma_f32_16x16x32_bf16 v[72:75], v[40:43], v[140:143], v[72:75]
    v_mfma_f32_16x16x32_bf16 v[80:83], v[40:43], v[220:223], v[80:83]
    v_mfma_f32_16x16x32_bf16 v[52:55], v[44:47], a[44:47], v[52:55]
    v_mfma_f32_16x16x32_bf16 v[60:63], v[44:47], a[124:127], v[60:63]
    v_mfma_f32_16x16x32_bf16 v[68:71], v[44:47], a[204:207], v[68:71]
    v_mfma_f32_16x16x32_bf16 v[76:79], v[44:47], v[140:143], v[76:79]
    v_mfma_f32_16x16x32_bf16 v[84:87], v[44:47], v[220:223], v[84:87]
    ds_read_b128 v[40:43], v31 offset:26624
    ds_read_b128 v[44:47], v31 offset:27648
    s_waitcnt lgkmcnt(2)
    v_mfma_f32_16x16x32_bf16 v[48:51], v[32:35], a[48:51], v[48:51]
    v_mfma_f32_16x16x32_bf16 v[56:59], v[32:35], a[128:131], v[56:59]
    v_mfma_f32_16x16x32_bf16 v[64:67], v[32:35], a[208:211], v[64:67]
    v_mfma_f32_16x16x32_bf16 v[72:75], v[32:35], v[144:147], v[72:75]
    v_mfma_f32_16x16x32_bf16 v[80:83], v[32:35], v[224:227], v[80:83]
    v_mfma_f32_16x16x32_bf16 v[52:55], v[36:39], a[48:51], v[52:55]
    v_mfma_f32_16x16x32_bf16 v[60:63], v[36:39], a[128:131], v[60:63]
    v_mfma_f32_16x16x32_bf16 v[68:71], v[36:39], a[208:211], v[68:71]
    v_mfma_f32_16x16x32_bf16 v[76:79], v[36:39], v[144:147], v[76:79]
    v_mfma_f32_16x16x32_bf16 v[84:87], v[36:39], v[224:227], v[84:87]
    ds_read_b128 v[32:35], v31 offset:28672
    ds_read_b128 v[36:39], v31 offset:29696
    s_waitcnt lgkmcnt(2)
    v_mfma_f32_16x16x32_bf16 v[48:51], v[40:43], a[52:55], v[48:51]
    v_mfma_f32_16x16x32_bf16 v[56:59], v[40:43], a[132:135], v[56:59]
    v_mfma_f32_16x16x32_bf16 v[64:67], v[40:43], a[212:215], v[64:67]
    v_mfma_f32_16x16x32_bf16 v[72:75], v[40:43], v[148:151], v[72:75]
    v_mfma_f32_16x16x32_bf16 v[80:83], v[40:43], v[228:231], v[80:83]
    v_mfma_f32_16x16x32_bf16 v[52:55], v[44:47], a[52:55], v[52:55]
    v_mfma_f32_16x16x32_bf16 v[60:63], v[44:47], a[132:135], v[60:63]
    v_mfma_f32_16x16x32_bf16 v[68:71], v[44:47], a[212:215], v[68:71]
    v_mfma_f32_16x16x32_bf16 v[76:79], v[44:47], v[148:151], v[76:79]
    v_mfma_f32_16x16x32_bf16 v[84:87], v[44:47], v[228:231], v[84:87]
    ds_read_b128 v[40:43], v31 offset:30720
    ds_read_b128 v[44:47], v31 offset:31744
    s_waitcnt lgkmcnt(2)
    v_mfma_f32_16x16x32_bf16 v[48:51], v[32:35], a[56:59], v[48:51]
    v_mfma_f32_16x16x32_bf16 v[56:59], v[32:35], a[136:139], v[56:59]
    v_mfma_f32_16x16x32_bf16 v[64:67], v[32:35], a[216:219], v[64:67]
    v_mfma_f32_16x16x32_bf16 v[72:75], v[32:35], v[152:155], v[72:75]
    v_mfma_f32_16x16x32_bf16 v[80:83], v[32:35], v[232:235], v[80:83]
    v_mfma_f32_16x16x32_bf16 v[52:55], v[36:39], a[56:59], v[52:55]
    v_mfma_f32_16x16x32_bf16 v[60:63], v[36:39], a[136:139], v[60:63]
    v_mfma_f32_16x16x32_bf16 v[68:71], v[36:39], a[216:219], v[68:71]
    v_mfma_f32_16x16x32_bf16 v[76:79], v[36:39], v[152:155], v[76:79]
    v_mfma_f32_16x16x32_bf16 v[84:87], v[36:39], v[232:235], v[84:87]
    ds_read_b128 v[32:35], v31 offset:32768
    ds_read_b128 v[36:39], v31 offset:33792
    s_waitcnt lgkmcnt(2)
    v_mfma_f32_16x16x32_bf16 v[48:51], v[40:43], a[60:63], v[48:51]
    v_mfma_f32_16x16x32_bf16 v[56:59], v[40:43], a[140:143], v[56:59]
    v_mfma_f32_16x16x32_bf16 v[64:67], v[40:43], a[220:223], v[64:67]
    v_mfma_f32_16x16x32_bf16 v[72:75], v[40:43], v[156:159], v[72:75]
    v_mfma_f32_16x16x32_bf16 v[80:83], v[40:43], v[236:239], v[80:83]
    v_mfma_f32_16x16x32_bf16 v[52:55], v[44:47], a[60:63], v[52:55]
    v_mfma_f32_16x16x32_bf16 v[60:63], v[44:47], a[140:143], v[60:63]
    v_mfma_f32_16x16x32_bf16 v[68:71], v[44:47], a[220:223], v[68:71]
    v_mfma_f32_16x16x32_bf16 v[76:79], v[44:47], v[156:159], v[76:79]
    v_mfma_f32_16x16x32_bf16 v[84:87], v[44:47], v[236:239], v[84:87]
    ds_read_b128 v[40:43], v31 offset:34816
    ds_read_b128 v[44:47], v31 offset:35840
    s_waitcnt lgkmcnt(2)
    v_mfma_f32_16x16x32_bf16 v[48:51], v[32:35], a[64:67], v[48:51]
    v_mfma_f32_16x16x32_bf16 v[56:59], v[32:35], a[144:147], v[56:59]
    v_mfma_f32_16x16x32_bf16 v[64:67], v[32:35], a[224:227], v[64:67]
    v_mfma_f32_16x16x32_bf16 v[72:75], v[32:35], v[160:163], v[72:75]
    v_mfma_f32_16x16x32_bf16 v[80:83], v[32:35], v[240:243], v[80:83]
    v_mfma_f32_16x16x32_bf16 v[52:55], v[36:39], a[64:67], v[52:55]
    v_mfma_f32_16x16x32_bf16 v[60:63], v[36:39], a[144:147], v[60:63]
    v_mfma_f32_16x16x32_bf16 v[68:71], v[36:39], a[224:227], v[68:71]
    v_mfma_f32_16x16x32_bf16 v[76:79], v[36:39], v[160:163], v[76:79]
    v_mfma_f32_16x16x32_bf16 v[84:87], v[36:39], v[240:243], v[84:87]
    ds_read_b128 v[32:35], v31 offset:36864
    ds_read_b128 v[36:39], v31 offset:37888
    s_waitcnt lgkmcnt(2)
    v_mfma_f32_16x16x32_bf16 v[48:51], v[40:43], a[68:71], v[48:51]
    v_mfma_f32_16x16x32_bf16 v[56:59], v[40:43], a[148:151], v[56:59]
    v_mfma_f32_16x16x32_bf16 v[64:67], v[40:43], a[228:231], v[64:67]
    v_mfma_f32_16x16x32_bf16 v[72:75], v[40:43], v[164:167], v[72:75]
    v_mfma_f32_16x16x32_bf16 v[80:83], v[40:43], v[244:247], v[80:83]
    v_mfma_f32_16x16x32_bf16 v[52:55], v[44:47], a[68:71], v[52:55]
    v_mfma_f32_16x16x32_bf16 v[60:63], v[44:47], a[148:151], v[60:63]
    v_mfma_f32_16x16x32_bf16 v[68:71], v[44:47], a[228:231], v[68:71]
    v_mfma_f32_16x16x32_bf16 v[76:79], v[44:47], v[164:167], v[76:79]
    v_mfma_f32_16x16x32_bf16 v[84:87], v[44:47], v[244:247], v[84:87]
    ds_read_b128 v[40:43], v31 offset:38912
    ds_read_b128 v[44:47], v31 offset:39936
    s_waitcnt lgkmcnt(2)
    v_mfma_f32_16x16x32_bf16 v[48:51], v[32:35], a[72:75], v[48:51]
    v_mfma_f32_16x16x32_bf16 v[56:59], v[32:35], a[152:155], v[56:59]
    v_mfma_f32_16x16x32_bf16 v[64:67], v[32:35], a[232:235], v[64:67]
    v_mfma_f32_16x16x32_bf16 v[72:75], v[32:35], v[168:171], v[72:75]
    v_mfma_f32_16x16x32_bf16 v[80:83], v[32:35], v[248:251], v[80:83]
    v_mfma_f32_16x16x32_bf16 v[52:55], v[36:39], a[72:75], v[52:55]
    v_mfma_f32_16x16x32_bf16 v[60:63], v[36:39], a[152:155], v[60:63]
    v_mfma_f32_16x16x32_bf16 v[68:71], v[36:39], a[232:235], v[68:71]
    v_mfma_f32_16x16x32_bf16 v[76:79], v[36:39], v[168:171], v[76:79]
    v_mfma_f32_16x16x32_bf16 v[84:87], v[36:39], v[248:251], v[84:87]
    s_waitcnt lgkmcnt(0)
    v_mfma_f32_16x16x32_bf16 v[48:51], v[40:43], a[76:79], v[48:51]
    v_mfma_f32_16x16x32_bf16 v[56:59], v[40:43], a[156:159], v[56:59]
    v_mfma_f32_16x16x32_bf16 v[64:67], v[40:43], a[236:239], v[64:67]
    v_mfma_f32_16x16x32_bf16 v[72:75], v[40:43], v[172:175], v[72:75]
    v_mfma_f32_16x16x32_bf16 v[80:83], v[40:43], v[252:255], v[80:83]
    v_mfma_f32_16x16x32_bf16 v[52:55], v[44:47], a[76:79], v[52:55]
    v_mfma_f32_16x16x32_bf16 v[60:63], v[44:47], a[156:159], v[60:63]
    v_mfma_f32_16x16x32_bf16 v[68:71], v[44:47], a[236:239], v[68:71]
    v_mfma_f32_16x16x32_bf16 v[76:79], v[44:47], v[172:175], v[76:79]
    v_mfma_f32_16x16x32_bf16 v[84:87], v[44:47], v[252:255], v[84:87]
    v_cvt_pk_bf16_f32 v48, v48, v49
    v_cvt_pk_bf16_f32 v49, v50, v51
    ds_write_b64 v10, v[48:49] offset:0
    s_nop 0
    v_cvt_pk_bf16_f32 v52, v52, v53
    v_cvt_pk_bf16_f32 v53, v54, v55
    ds_write_b64 v10, v[52:53] offset:768
    v_cvt_pk_bf16_f32 v56, v56, v57
    v_cvt_pk_bf16_f32 v57, v58, v59
    ds_write_b64 v11, v[56:57] offset:0
    v_cvt_pk_bf16_f32 v60, v60, v61
    v_cvt_pk_bf16_f32 v61, v62, v63
    ds_write_b64 v11, v[60:61] offset:768
    v_cvt_pk_bf16_f32 v64, v64, v65
    v_cvt_pk_bf16_f32 v65, v66, v67
    ds_write_b64 v12, v[64:65] offset:0
    v_cvt_pk_bf16_f32 v68, v68, v69
    v_cvt_pk_bf16_f32 v69, v70, v71
    ds_write_b64 v12, v[68:69] offset:768
    v_cvt_pk_bf16_f32 v72, v72, v73
    v_cvt_pk_bf16_f32 v73, v74, v75
    ds_write_b64 v13, v[72:73] offset:0
    v_cvt_pk_bf16_f32 v76, v76, v77
    v_cvt_pk_bf16_f32 v77, v78, v79
    ds_write_b64 v13, v[76:77] offset:768
    v_cvt_pk_bf16_f32 v80, v80, v81
    v_cvt_pk_bf16_f32 v81, v82, v83
    ds_write_b64 v14, v[80:81] offset:0
    v_cvt_pk_bf16_f32 v84, v84, v85
    v_cvt_pk_bf16_f32 v85, v86, v87
    ds_write_b64 v14, v[84:85] offset:768
    s_waitcnt lgkmcnt(0)
    ds_read_b128 v[88:91], v24 offset:0
    ds_read_b128 v[92:95], v24 offset:1024
    ds_read_b128 v[96:99], v24 offset:2048
    ds_read_b128 v[100:103], v24 offset:3072
    ds_read_b128 v[104:107], v24 offset:4096
    ds_read_b128 v[108:111], v24 offset:5120
    s_waitcnt lgkmcnt(5)
    buffer_store_dwordx4 v[88:91], v18, s[4:7], s37 offen sc1
    s_waitcnt lgkmcnt(4)
    buffer_store_dwordx4 v[92:95], v19, s[4:7], s37 offen sc1
    s_waitcnt lgkmcnt(3)
    buffer_store_dwordx4 v[96:99], v20, s[4:7], s37 offen sc1
    s_waitcnt lgkmcnt(2)
    buffer_store_dwordx4 v[100:103], v21, s[4:7], s37 offen sc1
    s_waitcnt lgkmcnt(1)
    buffer_store_dwordx4 v[104:107], v22, s[4:7], s37 offen sc1
    s_waitcnt lgkmcnt(0)
    buffer_store_dwordx4 v[108:111], v23, s[4:7], s37 offen sc1
    s_add_u32 s37, s37, 2048
    s_mov_b32 s31, s44
    s_mov_b32 s44, s45
    s_mov_b32 s45, s46
    s_mov_b32 s46, s31
    s_add_u32 s34, s34, 40960
    s_add_u32 s35, s35, 1
    s_branch AV_11
E_14:
AQE_2:
    s_mov_b32 s31, 0
    v_min_u32 v4, 0, v1
    v_lshlrev_b32 v4, 2, v4
    s_mov_b32 s30, 50000
WF_19:
    buffer_load_dword v5, v4, s[20:23], s31 offen sc1
    s_waitcnt vmcnt(0)
    v_cmp_ne_u32 vcc, 16, v5
    s_cbranch_vccz WE_20
    s_sleep 2
    s_sub_u32 s30, s30, 1
    s_cmp_lg_u32 s30, 0
    s_cbranch_scc1 WF_19
    s_endpgm
WE_20:
    s_cmp_lg_u32 s24, 0
    s_cbranch_scc1 NF_21
    s_lshl_b32 s39, s25, 2
    s_add_u32 s39, s39, 49152
    v_mov_b32 v4, 0
    v_mov_b32 v5, 1
    s_mov_b64 exec, 1
    buffer_store_dword v5, v4, s[4:7], s39 offen sc1
    s_mov_b64 exec, -1
NF_21:
    s_branch POOL0
R_STR:
    s_lshr_b32 s32, s25, 1
    s_lshl_b32 s32, s32, 2
    s_add_u32 s32, s32, s31
    s_sub_u32 s32, s32, 4
    s_lshl_b32 s32, s32, 1
    s_and_b32 s25, s25, 1
    s_add_u32 s25, s25, s32
    s_cmp_lt_u32 s25, 64
    s_cbranch_scc1 R_QKS
    s_sub_u32 s25, s25, 64
    s_branch R_VUS
R_QKS:
    s_lshr_b32 s32, s25, 1
    s_and_b32 s33, s25, 1
    s_mul_i32 s34, s33, 40960
    s_mov_b32 s40, s70
    s_mov_b32 s41, s71
    s_mov_b32 s42, 2621440
    s_mov_b32 s43, 0x00020000
    s_mov_b32 s8, s74
    s_mov_b32 s9, s75
    s_mov_b32 s10, 5242880
    s_mov_b32 s11, 0x00020000
    s_mov_b32 s12, s76
    s_mov_b32 s13, s77
    s_mov_b32 s14, 5242880
    s_mov_b32 s15, 0x00020000
    v_lshrrev_b32 v10, 4, v1
    v_mov_b32 v4, s24
    v_mul_u32_u24 v4, 4, v4
    v_add_u32 v10, v10, v4
    v_mul_u32_u24 v10, 8192, v10
    v_and_b32 v4, 15, v1
    v_lshrrev_b32 v5, 4, v1
    v_lshlrev_b32 v5, 1, v5
    v_xor_b32 v4, v4, v5
    v_lshlrev_b32 v4, 4, v4
    v_add_u32 v10, v10, v4
    v_mul_u32_u24 v11, 2176, v3
    v_and_b32 v4, 15, v1
    v_lshrrev_b32 v4, 2, v4
    v_lshlrev_b32 v4, 8, v4
    v_add_u32 v11, v11, v4
    v_mov_b32 v4, s24
    v_mul_u32_u24 v4, 2, v4
    v_add_u32 v4, 0, v4
    v_and_b32 v5, 15, v1
    v_lshrrev_b32 v5, 2, v5
    v_xor_b32 v4, v4, v5
    v_lshlrev_b32 v4, 5, v4
    v_add_u32 v11, v11, v4
    v_and_b32 v4, 3, v1
    v_lshlrev_b32 v4, 3, v4
    v_add_u32 v11, v11, v4
    v_add_u32 v13, 69632, v11
    v_mul_u32_u24 v12, 2176, v3
    v_and_b32 v4, 15, v1
    v_lshrrev_b32 v4, 2, v4
    v_lshlrev_b32 v4, 8, v4
    v_add_u32 v12, v12, v4
    v_mov_b32 v4, s24
    v_mul_u32_u24 v4, 2, v4
    v_add_u32 v4, 1, v4
    v_and_b32 v5, 15, v1
    v_lshrrev_b32 v5, 2, v5
    v_xor_b32 v4, v4, v5
    v_lshlrev_b32 v4, 5, v4
    v_add_u32 v12, v12, v4
    v_and_b32 v4, 3, v1
    v_lshlrev_b32 v4, 3, v4
    v_add_u32 v12, v12, v4
    v_add_u32 v14, 69632, v12
    s_lshl_b32 s28, s32, 8
    s_mul_i32 s26, s24, 1088
    s_add_u32 m0, s26, 0
    s_add_u32 s27, s28, 0
    buffer_load_dwordx4 v10, s[8:11], s27 offen lds
    s_add_u32 m0, s26, 4352
    s_add_u32 s27, s28, 131072
    buffer_load_dwordx4 v10, s[8:11], s27 offen lds
    s_add_u32 m0, s26, 8704
    s_add_u32 s27, s28, 262144
    buffer_load_dwordx4 v10, s[8:11], s27 offen lds
    s_add_u32 m0, s26, 13056
    s_add_u32 s27, s28, 393216
    buffer_load_dwordx4 v10, s[8:11], s27 offen lds
    s_add_u32 m0, s26, 17408
    s_add_u32 s27, s28, 524288
    buffer_load_dwordx4 v10, s[8:11], s27 offen lds
    s_add_u32 m0, s26, 21760
    s_add_u32 s27, s28, 655360
    buffer_load_dwordx4 v10, s[8:11], s27 offen lds
    s_add_u32 m0, s26, 26112
    s_add_u32 s27, s28, 786432
    buffer_load_dwordx4 v10, s[8:11], s27 offen lds
    s_add_u32 m0, s26, 30464
    s_add_u32 s27, s28, 917504
    buffer_load_dwordx4 v10, s[8:11], s27 offen lds
    s_add_u32 m0, s26, 34816
    s_add_u32 s27, s28, 0
    buffer_load_dwordx4 v10, s[12:15], s27 offen lds
    s_add_u32 m0, s26, 39168
    s_add_u32 s27, s28, 131072
    buffer_load_dwordx4 v10, s[12:15], s27 offen lds
    s_add_u32 m0, s26, 43520
    s_add_u32 s27, s28, 262144
    buffer_load_dwordx4 v10, s[12:15], s27 offen lds
    s_add_u32 m0, s26, 47872
    s_add_u32 s27, s28, 393216
    buffer_load_dwordx4 v10, s[12:15], s27 offen lds
    s_add_u32 m0, s26, 52224
    s_add_u32 s27, s28, 524288
    buffer_load_dwordx4 v10, s[12:15], s27 offen lds
    s_add_u32 m0, s26, 56576
    s_add_u32 s27, s28, 655360
    buffer_load_dwordx4 v10, s[12:15], s27 offen lds
    s_add_u32 m0, s26, 60928
    s_add_u32 s27, s28, 786432
    buffer_load_dwordx4 v10, s[12:15], s27 offen lds
    s_add_u32 m0, s26, 65280
    s_add_u32 s27, s28, 917504
    buffer_load_dwordx4 v10, s[12:15], s27 offen lds
    s_add_u32 m0, s26, 69632
    s_add_u32 s27, s28, 1048576
    buffer_load_dwordx4 v10, s[8:11], s27 offen lds
    s_add_u32 m0, s26, 73984
    s_add_u32 s27, s28, 1179648
    buffer_load_dwordx4 v10, s[8:11], s27 offen lds
    s_add_u32 m0, s26, 78336
    s_add_u32 s27, s28, 1310720
    buffer_load_dwordx4 v10, s[8:11], s27 offen lds
    s_add_u32 m0, s26, 82688
    s_add_u32 s27, s28, 1441792
    buffer_load_dwordx4 v10, s[8:11], s27 offen lds
    s_add_u32 m0, s26, 87040
    s_add_u32 s27, s28, 1572864
    buffer_load_dwordx4 v10, s[8:11], s27 offen lds
    s_add_u32 m0, s26, 91392
    s_add_u32 s27, s28, 1703936
    buffer_load_dwordx4 v10, s[8:11], s27 offen lds
    s_add_u32 m0, s26, 95744
    s_add_u32 s27, s28, 1835008
    buffer_load_dwordx4 v10, s[8:11], s27 offen lds
    s_add_u32 m0, s26, 100096
    s_add_u32 s27, s28, 1966080
    buffer_load_dwordx4 v10, s[8:11], s27 offen lds
    s_add_u32 m0, s26, 104448
    s_add_u32 s27, s28, 1048576
    buffer_load_dwordx4 v10, s[12:15], s27 offen lds
    s_add_u32 m0, s26, 108800
    s_add_u32 s27, s28, 1179648
    buffer_load_dwordx4 v10, s[12:15], s27 offen lds
    s_add_u32 m0, s26, 113152
    s_add_u32 s27, s28, 1310720
    buffer_load_dwordx4 v10, s[12:15], s27 offen lds
    s_add_u32 m0, s26, 117504
    s_add_u32 s27, s28, 1441792
    buffer_load_dwordx4 v10, s[12:15], s27 offen lds
    s_add_u32 m0, s26, 121856
    s_add_u32 s27, s28, 1572864
    buffer_load_dwordx4 v10, s[12:15], s27 offen lds
    s_add_u32 m0, s26, 126208
    s_add_u32 s27, s28, 1703936
    buffer_load_dwordx4 v10, s[12:15], s27 offen lds
    s_add_u32 m0, s26, 130560
    s_add_u32 s27, s28, 1835008
    buffer_load_dwordx4 v10, s[12:15], s27 offen lds
    s_add_u32 m0, s26, 134912
    s_add_u32 s27, s28, 1966080
    buffer_load_dwordx4 v10, s[12:15], s27 offen lds
    s_waitcnt vmcnt(16)
    s_barrier
    ds_read_b64_tr_b16 a[0:1], v11 offset:0
    ds_read_b64_tr_b16 a[2:3], v11 offset:1088
    ds_read_b64_tr_b16 a[4:5], v11 offset:8704
    ds_read_b64_tr_b16 a[6:7], v11 offset:9792
    ds_read_b64_tr_b16 a[8:9], v11 offset:17408
    ds_read_b64_tr_b16 a[10:11], v11 offset:18496
    ds_read_b64_tr_b16 a[12:13], v11 offset:26112
    ds_read_b64_tr_b16 a[14:15], v11 offset:27200
    ds_read_b64_tr_b16 a[80:81], v12 offset:0
    ds_read_b64_tr_b16 a[82:83], v12 offset:1088
    ds_read_b64_tr_b16 a[84:85], v12 offset:8704
    ds_read_b64_tr_b16 a[86:87], v12 offset:9792
    ds_read_b64_tr_b16 a[88:89], v12 offset:17408
    ds_read_b64_tr_b16 a[90:91], v12 offset:18496
    ds_read_b64_tr_b16 a[92:93], v12 offset:26112
    ds_read_b64_tr_b16 a[94:95], v12 offset:27200
    ds_read_b64_tr_b16 a[160:161], v11 offset:34816
    ds_read_b64_tr_b16 a[162:163], v11 offset:35904
    ds_read_b64_tr_b16 a[164:165], v11 offset:43520
    ds_read_b64_tr_b16 a[166:167], v11 offset:44608
    ds_read_b64_tr_b16 a[168:169], v11 offset:52224
    ds_read_b64_tr_b16 a[170:171], v11 offset:53312
    ds_read_b64_tr_b16 a[172:173], v11 offset:60928
    ds_read_b64_tr_b16 a[174:175], v11 offset:62016
    ds_read_b64_tr_b16 a[240:241], v12 offset:34816
    ds_read_b64_tr_b16 a[242:243], v12 offset:35904
    ds_read_b64_tr_b16 a[244:245], v12 offset:43520
    ds_read_b64_tr_b16 a[246:247], v12 offset:44608
    ds_read_b64_tr_b16 a[248:249], v12 offset:52224
    ds_read_b64_tr_b16 a[250:251], v12 offset:53312
    ds_read_b64_tr_b16 a[252:253], v12 offset:60928
    ds_read_b64_tr_b16 a[254:255], v12 offset:62016
    s_waitcnt lgkmcnt(0)
    s_barrier
    s_add_u32 m0, s26, 0
    s_add_u32 s27, s28, 2097152
    buffer_load_dwordx4 v10, s[8:11], s27 offen lds
    s_add_u32 m0, s26, 4352
    s_add_u32 s27, s28, 2228224
    buffer_load_dwordx4 v10, s[8:11], s27 offen lds
    s_add_u32 m0, s26, 8704
    s_add_u32 s27, s28, 2359296
    buffer_load_dwordx4 v10, s[8:11], s27 offen lds
    s_add_u32 m0, s26, 13056
    s_add_u32 s27, s28, 2490368
    buffer_load_dwordx4 v10, s[8:11], s27 offen lds
    s_add_u32 m0, s26, 17408
    s_add_u32 s27, s28, 2621440
    buffer_load_dwordx4 v10, s[8:11], s27 offen lds
    s_add_u32 m0, s26, 21760
    s_add_u32 s27, s28, 2752512
    buffer_load_dwordx4 v10, s[8:11], s27 offen lds
    s_add_u32 m0, s26, 26112
    s_add_u32 s27, s28, 2883584
    buffer_load_dwordx4 v10, s[8:11], s27 offen lds
    s_add_u32 m0, s26, 30464
    s_add_u32 s27, s28, 3014656
    buffer_load_dwordx4 v10, s[8:11], s27 offen lds
    s_add_u32 m0, s26, 34816
    s_add_u32 s27, s28, 2097152
    buffer_load_dwordx4 v10, s[12:15], s27 offen lds
    s_add_u32 m0, s26, 39168
    s_add_u32 s27, s28, 2228224
    buffer_load_dwordx4 v10, s[12:15], s27 offen lds
    s_add_u32 m0, s26, 43520
    s_add_u32 s27, s28, 2359296
    buffer_load_dwordx4 v10, s[12:15], s27 offen lds
    s_add_u32 m0, s26, 47872
    s_add_u32 s27, s28, 2490368
    buffer_load_dwordx4 v10, s[12:15], s27 offen lds
    s_add_u32 m0, s26, 52224
    s_add_u32 s27, s28, 2621440
    buffer_load_dwordx4 v10, s[12:15], s27 offen lds
    s_add_u32 m0, s26, 56576
    s_add_u32 s27, s28, 2752512
    buffer_load_dwordx4 v10, s[12:15], s27 offen lds
    s_add_u32 m0, s26, 60928
    s_add_u32 s27, s28, 2883584
    buffer_load_dwordx4 v10, s[12:15], s27 offen lds
    s_add_u32 m0, s26, 65280
    s_add_u32 s27, s28, 3014656
    buffer_load_dwordx4 v10, s[12:15], s27 offen lds
    s_waitcnt vmcnt(16)
    s_barrier
    ds_read_b64_tr_b16 a[16:17], v13 offset:0
    ds_read_b64_tr_b16 a[18:19], v13 offset:1088
    ds_read_b64_tr_b16 a[20:21], v13 offset:8704
    ds_read_b64_tr_b16 a[22:23], v13 offset:9792
    ds_read_b64_tr_b16 a[24:25], v13 offset:17408
    ds_read_b64_tr_b16 a[26:27], v13 offset:18496
    ds_read_b64_tr_b16 a[28:29], v13 offset:26112
    ds_read_b64_tr_b16 a[30:31], v13 offset:27200
    ds_read_b64_tr_b16 a[96:97], v14 offset:0
    ds_read_b64_tr_b16 a[98:99], v14 offset:1088
    ds_read_b64_tr_b16 a[100:101], v14 offset:8704
    ds_read_b64_tr_b16 a[102:103], v14 offset:9792
    ds_read_b64_tr_b16 a[104:105], v14 offset:17408
    ds_read_b64_tr_b16 a[106:107], v14 offset:18496
    ds_read_b64_tr_b16 a[108:109], v14 offset:26112
    ds_read_b64_tr_b16 a[110:111], v14 offset:27200
    ds_read_b64_tr_b16 a[176:177], v13 offset:34816
    ds_read_b64_tr_b16 a[178:179], v13 offset:35904
    ds_read_b64_tr_b16 a[180:181], v13 offset:43520
    ds_read_b64_tr_b16 a[182:183], v13 offset:44608
    ds_read_b64_tr_b16 a[184:185], v13 offset:52224
    ds_read_b64_tr_b16 a[186:187], v13 offset:53312
    ds_read_b64_tr_b16 a[188:189], v13 offset:60928
    ds_read_b64_tr_b16 a[190:191], v13 offset:62016
    ds_read_b64_tr_b16 v[192:193], v14 offset:34816
    ds_read_b64_tr_b16 v[194:195], v14 offset:35904
    ds_read_b64_tr_b16 v[196:197], v14 offset:43520
    ds_read_b64_tr_b16 v[198:199], v14 offset:44608
    ds_read_b64_tr_b16 v[200:201], v14 offset:52224
    ds_read_b64_tr_b16 v[202:203], v14 offset:53312
    ds_read_b64_tr_b16 v[204:205], v14 offset:60928
    ds_read_b64_tr_b16 v[206:207], v14 offset:62016
    s_waitcnt lgkmcnt(0)
    s_barrier
    s_add_u32 m0, s26, 69632
    s_add_u32 s27, s28, 3145728
    buffer_load_dwordx4 v10, s[8:11], s27 offen lds
    s_add_u32 m0, s26, 73984
    s_add_u32 s27, s28, 3276800
    buffer_load_dwordx4 v10, s[8:11], s27 offen lds
    s_add_u32 m0, s26, 78336
    s_add_u32 s27, s28, 3407872
    buffer_load_dwordx4 v10, s[8:11], s27 offen lds
    s_add_u32 m0, s26, 82688
    s_add_u32 s27, s28, 3538944
    buffer_load_dwordx4 v10, s[8:11], s27 offen lds
    s_add_u32 m0, s26, 87040
    s_add_u32 s27, s28, 3670016
    buffer_load_dwordx4 v10, s[8:11], s27 offen lds
    s_add_u32 m0, s26, 91392
    s_add_u32 s27, s28, 3801088
    buffer_load_dwordx4 v10, s[8:11], s27 offen lds
    s_add_u32 m0, s26, 95744
    s_add_u32 s27, s28, 3932160
    buffer_load_dwordx4 v10, s[8:11], s27 offen lds
    s_add_u32 m0, s26, 100096
    s_add_u32 s27, s28, 4063232
    buffer_load_dwordx4 v10, s[8:11], s27 offen lds
    s_add_u32 m0, s26, 104448
    s_add_u32 s27, s28, 3145728
    buffer_load_dwordx4 v10, s[12:15], s27 offen lds
    s_add_u32 m0, s26, 108800
    s_add_u32 s27, s28, 3276800
    buffer_load_dwordx4 v10, s[12:15], s27 offen lds
    s_add_u32 m0, s26, 113152
    s_add_u32 s27, s28, 3407872
    buffer_load_dwordx4 v10, s[12:15], s27 offen lds
    s_add_u32 m0, s26, 117504
    s_add_u32 s27, s28, 3538944
    buffer_load_dwordx4 v10, s[12:15], s27 offen lds
    s_add_u32 m0, s26, 121856
    s_add_u32 s27, s28, 3670016
    buffer_load_dwordx4 v10, s[12:15], s27 offen lds
    s_add_u32 m0, s26, 126208
    s_add_u32 s27, s28, 3801088
    buffer_load_dwordx4 v10, s[12:15], s27 offen lds
    s_add_u32 m0, s26, 130560
    s_add_u32 s27, s28, 3932160
    buffer_load_dwordx4 v10, s[12:15], s27 offen lds
    s_add_u32 m0, s26, 134912
    s_add_u32 s27, s28, 4063232
    buffer_load_dwordx4 v10, s[12:15], s27 offen lds
    s_waitcnt vmcnt(16)
    s_barrier
    ds_read_b64_tr_b16 a[32:33], v11 offset:0
    ds_read_b64_tr_b16 a[34:35], v11 offset:1088
    ds_read_b64_tr_b16 a[36:37], v11 offset:8704
    ds_read_b64_tr_b16 a[38:39], v11 offset:9792
    ds_read_b64_tr_b16 a[40:41], v11 offset:17408
    ds_read_b64_tr_b16 a[42:43], v11 offset:18496
    ds_read_b64_tr_b16 a[44:45], v11 offset:26112
    ds_read_b64_tr_b16 a[46:47], v11 offset:27200
    ds_read_b64_tr_b16 a[112:113], v12 offset:0
    ds_read_b64_tr_b16 a[114:115], v12 offset:1088
    ds_read_b64_tr_b16 a[116:117], v12 offset:8704
    ds_read_b64_tr_b16 a[118:119], v12 offset:9792
    ds_read_b64_tr_b16 a[120:121], v12 offset:17408
    ds_read_b64_tr_b16 a[122:123], v12 offset:18496
    ds_read_b64_tr_b16 a[124:125], v12 offset:26112
    ds_read_b64_tr_b16 a[126:127], v12 offset:27200
    ds_read_b64_tr_b16 a[192:193], v11 offset:34816
    ds_read_b64_tr_b16 a[194:195], v11 offset:35904
    ds_read_b64_tr_b16 a[196:197], v11 offset:43520
    ds_read_b64_tr_b16 a[198:199], v11 offset:44608
    ds_read_b64_tr_b16 a[200:201], v11 offset:52224
    ds_read_b64_tr_b16 a[202:203], v11 offset:53312
    ds_read_b64_tr_b16 a[204:205], v11 offset:60928
    ds_read_b64_tr_b16 a[206:207], v11 offset:62016
    ds_read_b64_tr_b16 v[208:209], v12 offset:34816
    ds_read_b64_tr_b16 v[210:211], v12 offset:35904
    ds_read_b64_tr_b16 v[212:213], v12 offset:43520
    ds_read_b64_tr_b16 v[214:215], v12 offset:44608
    ds_read_b64_tr_b16 v[216:217], v12 offset:52224
    ds_read_b64_tr_b16 v[218:219], v12 offset:53312
    ds_read_b64_tr_b16 v[220:221], v12 offset:60928
    ds_read_b64_tr_b16 v[222:223], v12 offset:62016
    s_waitcnt lgkmcnt(0)
    s_barrier
    s_add_u32 m0, s26, 0
    s_add_u32 s27, s28, 4194304
    buffer_load_dwordx4 v10, s[8:11], s27 offen lds
    s_add_u32 m0, s26, 4352
    s_add_u32 s27, s28, 4325376
    buffer_load_dwordx4 v10, s[8:11], s27 offen lds
    s_add_u32 m0, s26, 8704
    s_add_u32 s27, s28, 4456448
    buffer_load_dwordx4 v10, s[8:11], s27 offen lds
    s_add_u32 m0, s26, 13056
    s_add_u32 s27, s28, 4587520
    buffer_load_dwordx4 v10, s[8:11], s27 offen lds
    s_add_u32 m0, s26, 17408
    s_add_u32 s27, s28, 4718592
    buffer_load_dwordx4 v10, s[8:11], s27 offen lds
    s_add_u32 m0, s26, 21760
    s_add_u32 s27, s28, 4849664
    buffer_load_dwordx4 v10, s[8:11], s27 offen lds
    s_add_u32 m0, s26, 26112
    s_add_u32 s27, s28, 4980736
    buffer_load_dwordx4 v10, s[8:11], s27 offen lds
    s_add_u32 m0, s26, 30464
    s_add_u32 s27, s28, 5111808
    buffer_load_dwordx4 v10, s[8:11], s27 offen lds
    s_add_u32 m0, s26, 34816
    s_add_u32 s27, s28, 4194304
    buffer_load_dwordx4 v10, s[12:15], s27 offen lds
    s_add_u32 m0, s26, 39168
    s_add_u32 s27, s28, 4325376
    buffer_load_dwordx4 v10, s[12:15], s27 offen lds
    s_add_u32 m0, s26, 43520
    s_add_u32 s27, s28, 4456448
    buffer_load_dwordx4 v10, s[12:15], s27 offen lds
    s_add_u32 m0, s26, 47872
    s_add_u32 s27, s28, 4587520
    buffer_load_dwordx4 v10, s[12:15], s27 offen lds
    s_add_u32 m0, s26, 52224
    s_add_u32 s27, s28, 4718592
    buffer_load_dwordx4 v10, s[12:15], s27 offen lds
    s_add_u32 m0, s26, 56576
    s_add_u32 s27, s28, 4849664
    buffer_load_dwordx4 v10, s[12:15], s27 offen lds
    s_add_u32 m0, s26, 60928
    s_add_u32 s27, s28, 4980736
    buffer_load_dwordx4 v10, s[12:15], s27 offen lds
    s_add_u32 m0, s26, 65280
    s_add_u32 s27, s28, 5111808
    buffer_load_dwordx4 v10, s[12:15], s27 offen lds
    s_waitcnt vmcnt(16)
    s_barrier
    ds_read_b64_tr_b16 a[48:49], v13 offset:0
    ds_read_b64_tr_b16 a[50:51], v13 offset:1088
    ds_read_b64_tr_b16 a[52:53], v13 offset:8704
    ds_read_b64_tr_b16 a[54:55], v13 offset:9792
    ds_read_b64_tr_b16 a[56:57], v13 offset:17408
    ds_read_b64_tr_b16 a[58:59], v13 offset:18496
    ds_read_b64_tr_b16 a[60:61], v13 offset:26112
    ds_read_b64_tr_b16 a[62:63], v13 offset:27200
    ds_read_b64_tr_b16 a[128:129], v14 offset:0
    ds_read_b64_tr_b16 a[130:131], v14 offset:1088
    ds_read_b64_tr_b16 a[132:133], v14 offset:8704
    ds_read_b64_tr_b16 a[134:135], v14 offset:9792
    ds_read_b64_tr_b16 a[136:137], v14 offset:17408
    ds_read_b64_tr_b16 a[138:139], v14 offset:18496
    ds_read_b64_tr_b16 a[140:141], v14 offset:26112
    ds_read_b64_tr_b16 a[142:143], v14 offset:27200
    ds_read_b64_tr_b16 a[208:209], v13 offset:34816
    ds_read_b64_tr_b16 a[210:211], v13 offset:35904
    ds_read_b64_tr_b16 a[212:213], v13 offset:43520
    ds_read_b64_tr_b16 a[214:215], v13 offset:44608
    ds_read_b64_tr_b16 a[216:217], v13 offset:52224
    ds_read_b64_tr_b16 a[218:219], v13 offset:53312
    ds_read_b64_tr_b16 a[220:221], v13 offset:60928
    ds_read_b64_tr_b16 a[222:223], v13 offset:62016
    ds_read_b64_tr_b16 v[224:225], v14 offset:34816
    ds_read_b64_tr_b16 v[226:227], v14 offset:35904
    ds_read_b64_tr_b16 v[228:229], v14 offset:43520
    ds_read_b64_tr_b16 v[230:231], v14 offset:44608
    ds_read_b64_tr_b16 v[232:233], v14 offset:52224
    ds_read_b64_tr_b16 v[234:235], v14 offset:53312
    ds_read_b64_tr_b16 v[236:237], v14 offset:60928
    ds_read_b64_tr_b16 v[238:239], v14 offset:62016
    s_waitcnt lgkmcnt(0)
    s_barrier
    v_mul_u32_u24 v30, 1280, v2
    v_lshlrev_b32 v4, 4, v3
    v_add_u32 v30, v30, v4
    v_mov_b32 v4, s24
    v_mul_u32_u24 v4, 320, v4
    v_add_u32 v30, v30, v4
    s_mul_i32 s47, s24, 10240
    s_add_u32 s28, s47, 69632
    s_add_u32 m0, s28, 0
    s_add_u32 s27, s34, 0
    buffer_load_dwordx4 v30, s[40:43], s27 offen lds
    s_add_u32 m0, s28, 1024
    s_add_u32 s27, s34, 20480
    buffer_load_dwordx4 v30, s[40:43], s27 offen lds
    s_add_u32 m0, s28, 2048
    s_add_u32 s27, s34, 64
    buffer_load_dwordx4 v30, s[40:43], s27 offen lds
    s_add_u32 m0, s28, 3072
    s_add_u32 s27, s34, 20544
    buffer_load_dwordx4 v30, s[40:43], s27 offen lds
    s_add_u32 m0, s28, 4096
    s_add_u32 s27, s34, 128
    buffer_load_dwordx4 v30, s[40:43], s27 offen lds
    s_add_u32 m0, s28, 5120
    s_add_u32 s27, s34, 20608
    buffer_load_dwordx4 v30, s[40:43], s27 offen lds
    s_add_u32 m0, s28, 6144
    s_add_u32 s27, s34, 192
    buffer_load_dwordx4 v30, s[40:43], s27 offen lds
    s_add_u32 m0, s28, 7168
    s_add_u32 s27, s34, 20672
    buffer_load_dwordx4 v30, s[40:43], s27 offen lds
    s_add_u32 m0, s28, 8192
    s_add_u32 s27, s34, 256
    buffer_load_dwordx4 v30, s[40:43], s27 offen lds
    s_add_u32 m0, s28, 9216
    s_add_u32 s27, s34, 20736
    buffer_load_dwordx4 v30, s[40:43], s27 offen lds
    s_add_u32 s28, s47, 110592
    s_add_u32 s36, s34, 81920
    s_add_u32 m0, s28, 0
    s_add_u32 s27, s36, 0
    buffer_load_dwordx4 v30, s[40:43], s27 offen lds
    s_add_u32 m0, s28, 1024
    s_add_u32 s27, s36, 20480
    buffer_load_dwordx4 v30, s[40:43], s27 offen lds
    s_add_u32 m0, s28, 2048
    s_add_u32 s27, s36, 64
    buffer_load_dwordx4 v30, s[40:43], s27 offen lds
    s_add_u32 m0, s28, 3072
    s_add_u32 s27, s36, 20544
    buffer_load_dwordx4 v30, s[40:43], s27 offen lds
    s_add_u32 m0, s28, 4096
    s_add_u32 s27, s36, 128
    buffer_load_dwordx4 v30, s[40:43], s27 offen lds
    s_add_u32 m0, s28, 5120
    s_add_u32 s27, s36, 20608
    buffer_load_dwordx4 v30, s[40:43], s27 offen lds
    s_add_u32 m0, s28, 6144
    s_add_u32 s27, s36, 192
    buffer_load_dwordx4 v30, s[40:43], s27 offen lds
    s_add_u32 m0, s28, 7168
    s_add_u32 s27, s36, 20672
    buffer_load_dwordx4 v30, s[40:43], s27 offen lds
    s_add_u32 m0, s28, 8192
    s_add_u32 s27, s36, 256
    buffer_load_dwordx4 v30, s[40:43], s27 offen lds
    s_add_u32 m0, s28, 9216
    s_add_u32 s27, s36, 20736
    buffer_load_dwordx4 v30, s[40:43], s27 offen lds
    s_waitcnt vmcnt(20)
    s_barrier
    ds_read_b64_tr_b16 a[64:65], v11 offset:0
    ds_read_b64_tr_b16 a[66:67], v11 offset:1088
    ds_read_b64_tr_b16 a[68:69], v11 offset:8704
    ds_read_b64_tr_b16 a[70:71], v11 offset:9792
    ds_read_b64_tr_b16 a[72:73], v11 offset:17408
    ds_read_b64_tr_b16 a[74:75], v11 offset:18496
    ds_read_b64_tr_b16 a[76:77], v11 offset:26112
    ds_read_b64_tr_b16 a[78:79], v11 offset:27200
    ds_read_b64_tr_b16 a[144:145], v12 offset:0
    ds_read_b64_tr_b16 a[146:147], v12 offset:1088
    ds_read_b64_tr_b16 a[148:149], v12 offset:8704
    ds_read_b64_tr_b16 a[150:151], v12 offset:9792
    ds_read_b64_tr_b16 a[152:153], v12 offset:17408
    ds_read_b64_tr_b16 a[154:155], v12 offset:18496
    ds_read_b64_tr_b16 a[156:157], v12 offset:26112
    ds_read_b64_tr_b16 a[158:159], v12 offset:27200
    ds_read_b64_tr_b16 a[224:225], v11 offset:34816
    ds_read_b64_tr_b16 a[226:227], v11 offset:35904
    ds_read_b64_tr_b16 a[228:229], v11 offset:43520
    ds_read_b64_tr_b16 a[230:231], v11 offset:44608
    ds_read_b64_tr_b16 a[232:233], v11 offset:52224
    ds_read_b64_tr_b16 a[234:235], v11 offset:53312
    ds_read_b64_tr_b16 a[236:237], v11 offset:60928
    ds_read_b64_tr_b16 a[238:239], v11 offset:62016
    ds_read_b64_tr_b16 v[240:241], v12 offset:34816
    ds_read_b64_tr_b16 v[242:243], v12 offset:35904
    ds_read_b64_tr_b16 v[244:245], v12 offset:43520
    ds_read_b64_tr_b16 v[246:247], v12 offset:44608
    ds_read_b64_tr_b16 v[248:249], v12 offset:52224
    ds_read_b64_tr_b16 v[250:251], v12 offset:53312
    ds_read_b64_tr_b16 v[252:253], v12 offset:60928
    ds_read_b64_tr_b16 v[254:255], v12 offset:62016
    s_waitcnt lgkmcnt(0)
    s_barrier
    v_lshlrev_b32 v31, 4, v1
    v_add_u32 v31, 69632, v31
    v_lshlrev_b32 v29, 4, v1
    v_mov_b32 v4, s24
    v_lshlrev_b32 v4, 10, v4
    v_add_u32 v29, v29, v4
    s_lshl_b32 s37, s33, 5
    s_add_u32 s37, s37, s32
    s_lshl_b32 s38, s37, 2
    s_lshl_b32 s37, s37, 13
    s_sub_u32 s38, s38, 256
    s_add_u32 s38, s38, 0
    v_mov_b32 v4, 0
    buffer_load_dword v26, v4, s[20:23], 0 offen sc1
    s_mov_b32 s35, 0
    s_mov_b32 s44, 69632
    s_mov_b32 s45, 110592
    s_mov_b32 s46, 0
    s_waitcnt vmcnt(11)
    s_branch PW_27
QKS_22:
    s_cmp_eq_u32 s35, 1
    s_cbranch_scc1 FW_26
    s_cmp_eq_u32 s35, 32
    s_cbranch_scc1 FW_26
    s_cmp_eq_u32 s35, 31
    s_cbranch_scc1 LW_29
    s_waitcnt vmcnt(14)
    s_branch PW_27
LW_29:
    s_waitcnt vmcnt(4)
    s_branch PW_27
FW_26:
    s_waitcnt vmcnt(0)
PW_27:
    s_barrier
    s_cmp_eq_u32 s35, 0
    s_cbranch_scc1 NF_24
    s_cmp_lg_u32 s24, 0
    s_cbranch_scc1 NF_24
    s_cmp_lg_u32 s35, 1
    s_cbranch_scc1 F1_28
    v_cmp_ne_u32 vcc, 16, v26
    s_cbranch_vccz WI_30
    s_mov_b32 s31, 0
    v_min_u32 v4, 0, v1
    v_lshlrev_b32 v4, 2, v4
    s_mov_b32 s30, 50000
WF_31:
    buffer_load_dword v5, v4, s[20:23], s31 offen sc1
    s_waitcnt vmcnt(0)
    v_cmp_ne_u32 vcc, 16, v5
    s_cbranch_vccz WE_32
    s_sleep 2
    s_sub_u32 s30, s30, 1
    s_cmp_lg_u32 s30, 0
    s_cbranch_scc1 WF_31
    s_endpgm
WE_32:
WI_30:
    s_add_u32 s39, s38, 0
    v_mov_b32 v4, 0
    v_mov_b32 v5, 1
    s_mov_b64 exec, 1
    buffer_store_dword v5, v4, s[4:7], s39 offen sc1
    s_mov_b64 exec, -1
    s_branch NF_24
F1_28:
    s_add_u32 s39, s38, 4294967040
    v_mov_b32 v4, 0
    v_mov_b32 v5, 1
    s_mov_b64 exec, 1
    buffer_store_dword v5, v4, s[4:7], s39 offen sc1
    s_mov_b64 exec, -1
    s_cmp_lg_u32 s35, 32
    s_cbranch_scc1 NF_24
    s_add_u32 s39, s38, 0
    v_mov_b32 v4, 0
    v_mov_b32 v5, 1
    s_mov_b64 exec, 1
    buffer_store_dword v5, v4, s[4:7], s39 offen sc1
    s_mov_b64 exec, -1
NF_24:
    s_cmp_eq_u32 s35, 32
    s_cbranch_scc1 E_25
    v_lshlrev_b32 v31, 4, v1
    v_add_u32 v31, s44, v31
    s_cmp_ge_u32 s35, 30
    s_cbranch_scc1 SK_23
    s_add_u32 s36, s34, 163840
    s_add_u32 s28, s47, s46
    s_add_u32 m0, s28, 0
    s_add_u32 s27, s36, 0
    buffer_load_dwordx4 v30, s[40:43], s27 offen lds
    s_add_u32 m0, s28, 1024
    s_add_u32 s27, s36, 20480
    buffer_load_dwordx4 v30, s[40:43], s27 offen lds
    s_add_u32 m0, s28, 2048
    s_add_u32 s27, s36, 64
    buffer_load_dwordx4 v30, s[40:43], s27 offen lds
    s_add_u32 m0, s28, 3072
    s_add_u32 s27, s36, 20544
    buffer_load_dwordx4 v30, s[40:43], s27 offen lds
    s_add_u32 m0, s28, 4096
    s_add_u32 s27, s36, 128
    buffer_load_dwordx4 v30, s[40:43], s27 offen lds
    s_add_u32 m0, s28, 5120
    s_add_u32 s27, s36, 20608
    buffer_load_dwordx4 v30, s[40:43], s27 offen lds
    s_add_u32 m0, s28, 6144
    s_add_u32 s27, s36, 192
    buffer_load_dwordx4 v30, s[40:43], s27 offen lds
    s_add_u32 m0, s28, 7168
    s_add_u32 s27, s36, 20672
    buffer_load_dwordx4 v30, s[40:43], s27 offen lds
    s_add_u32 m0, s28, 8192
    s_add_u32 s27, s36, 256
    buffer_load_dwordx4 v30, s[40:43], s27 offen lds
    s_add_u32 m0, s28, 9216
    s_add_u32 s27, s36, 20736
    buffer_load_dwordx4 v30, s[40:43], s27 offen lds
SK_23:
    ds_read_b128 v[32:35], v31 offset:0
    ds_read_b128 v[36:39], v31 offset:1024
    ds_read_b128 v[40:43], v31 offset:2048
    ds_read_b128 v[44:47], v31 offset:3072
    s_waitcnt lgkmcnt(2)
    v_mfma_f32_16x16x32_bf16 v[48:51], a[0:3], v[32:35], 0
    v_mfma_f32_16x16x32_bf16 v[56:59], a[80:83], v[32:35], 0
    v_mfma_f32_16x16x32_bf16 v[64:67], a[160:163], v[32:35], 0
    v_mfma_f32_16x16x32_bf16 v[72:75], a[240:243], v[32:35], 0
    v_mfma_f32_16x16x32_bf16 v[52:55], a[0:3], v[36:39], 0
    v_mfma_f32_16x16x32_bf16 v[60:63], a[80:83], v[36:39], 0
    v_mfma_f32_16x16x32_bf16 v[68:71], a[160:163], v[36:39], 0
    v_mfma_f32_16x16x32_bf16 v[76:79], a[240:243], v[36:39], 0
    ds_read_b128 v[32:35], v31 offset:4096
    ds_read_b128 v[36:39], v31 offset:5120
    s_waitcnt lgkmcnt(2)
    v_mfma_f32_16x16x32_bf16 v[48:51], a[4:7], v[40:43], v[48:51]
    v_mfma_f32_16x16x32_bf16 v[56:59], a[84:87], v[40:43], v[56:59]
    v_mfma_f32_16x16x32_bf16 v[64:67], a[164:167], v[40:43], v[64:67]
    v_mfma_f32_16x16x32_bf16 v[72:75], a[244:247], v[40:43], v[72:75]
    v_mfma_f32_16x16x32_bf16 v[52:55], a[4:7], v[44:47], v[52:55]
    v_mfma_f32_16x16x32_bf16 v[60:63], a[84:87], v[44:47], v[60:63]
    v_mfma_f32_16x16x32_bf16 v[68:71], a[164:167], v[44:47], v[68:71]
    v_mfma_f32_16x16x32_bf16 v[76:79], a[244:247], v[44:47], v[76:79]
    ds_read_b128 v[40:43], v31 offset:6144
    ds_read_b128 v[44:47], v31 offset:7168
    s_waitcnt lgkmcnt(2)
    v_mfma_f32_16x16x32_bf16 v[48:51], a[8:11], v[32:35], v[48:51]
    v_mfma_f32_16x16x32_bf16 v[56:59], a[88:91], v[32:35], v[56:59]
    v_mfma_f32_16x16x32_bf16 v[64:67], a[168:171], v[32:35], v[64:67]
    v_mfma_f32_16x16x32_bf16 v[72:75], a[248:251], v[32:35], v[72:75]
    v_mfma_f32_16x16x32_bf16 v[52:55], a[8:11], v[36:39], v[52:55]
    v_mfma_f32_16x16x32_bf16 v[60:63], a[88:91], v[36:39], v[60:63]
    v_mfma_f32_16x16x32_bf16 v[68:71], a[168:171], v[36:39], v[68:71]
    v_mfma_f32_16x16x32_bf16 v[76:79], a[248:251], v[36:39], v[76:79]
    ds_read_b128 v[32:35], v31 offset:8192
    ds_read_b128 v[36:39], v31 offset:9216
    s_waitcnt lgkmcnt(2)
    v_mfma_f32_16x16x32_bf16 v[48:51], a[12:15], v[40:43], v[48:51]
    v_mfma_f32_16x16x32_bf16 v[56:59], a[92:95], v[40:43], v[56:59]
    v_mfma_f32_16x16x32_bf16 v[64:67], a[172:175], v[40:43], v[64:67]
    v_mfma_f32_16x16x32_bf16 v[72:75], a[252:255], v[40:43], v[72:75]
    v_mfma_f32_16x16x32_bf16 v[52:55], a[12:15], v[44:47], v[52:55]
    v_mfma_f32_16x16x32_bf16 v[60:63], a[92:95], v[44:47], v[60:63]
    v_mfma_f32_16x16x32_bf16 v[68:71], a[172:175], v[44:47], v[68:71]
    v_mfma_f32_16x16x32_bf16 v[76:79], a[252:255], v[44:47], v[76:79]
    ds_read_b128 v[40:43], v31 offset:10240
    ds_read_b128 v[44:47], v31 offset:11264
    s_waitcnt lgkmcnt(2)
    v_mfma_f32_16x16x32_bf16 v[48:51], a[16:19], v[32:35], v[48:51]
    v_mfma_f32_16x16x32_bf16 v[56:59], a[96:99], v[32:35], v[56:59]
    v_mfma_f32_16x16x32_bf16 v[64:67], a[176:179], v[32:35], v[64:67]
    v_mfma_f32_16x16x32_bf16 v[72:75], v[192:195], v[32:35], v[72:75]
    v_mfma_f32_16x16x32_bf16 v[52:55], a[16:19], v[36:39], v[52:55]
    v_mfma_f32_16x16x32_bf16 v[60:63], a[96:99], v[36:39], v[60:63]
    v_mfma_f32_16x16x32_bf16 v[68:71], a[176:179], v[36:39], v[68:71]
    v_mfma_f32_16x16x32_bf16 v[76:79], v[192:195], v[36:39], v[76:79]
    ds_read_b128 v[32:35], v31 offset:12288
    ds_read_b128 v[36:39], v31 offset:13312
    s_waitcnt lgkmcnt(2)
    v_mfma_f32_16x16x32_bf16 v[48:51], a[20:23], v[40:43], v[48:51]
    v_mfma_f32_16x16x32_bf16 v[56:59], a[100:103], v[40:43], v[56:59]
    v_mfma_f32_16x16x32_bf16 v[64:67], a[180:183], v[40:43], v[64:67]
    v_mfma_f32_16x16x32_bf16 v[72:75], v[196:199], v[40:43], v[72:75]
    v_mfma_f32_16x16x32_bf16 v[52:55], a[20:23], v[44:47], v[52:55]
    v_mfma_f32_16x16x32_bf16 v[60:63], a[100:103], v[44:47], v[60:63]
    v_mfma_f32_16x16x32_bf16 v[68:71], a[180:183], v[44:47], v[68:71]
    v_mfma_f32_16x16x32_bf16 v[76:79], v[196:199], v[44:47], v[76:79]
    ds_read_b128 v[40:43], v31 offset:14336
    ds_read_b128 v[44:47], v31 offset:15360
    s_waitcnt lgkmcnt(2)
    v_mfma_f32_16x16x32_bf16 v[48:51], a[24:27], v[32:35], v[48:51]
    v_mfma_f32_16x16x32_bf16 v[56:59], a[104:107], v[32:35], v[56:59]
    v_mfma_f32_16x16x32_bf16 v[64:67], a[184:187], v[32:35], v[64:67]
    v_mfma_f32_16x16x32_bf16 v[72:75], v[200:203], v[32:35], v[72:75]
    v_mfma_f32_16x16x32_bf16 v[52:55], a[24:27], v[36:39], v[52:55]
    v_mfma_f32_16x16x32_bf16 v[60:63], a[104:107], v[36:39], v[60:63]
    v_mfma_f32_16x16x32_bf16 v[68:71], a[184:187], v[36:39], v[68:71]
    v_mfma_f32_16x16x32_bf16 v[76:79], v[200:203], v[36:39], v[76:79]
    ds_read_b128 v[32:35], v31 offset:16384
    ds_read_b128 v[36:39], v31 offset:17408
    s_waitcnt lgkmcnt(2)
    v_mfma_f32_16x16x32_bf16 v[48:51], a[28:31], v[40:43], v[48:51]
    v_mfma_f32_16x16x32_bf16 v[56:59], a[108:111], v[40:43], v[56:59]
    v_mfma_f32_16x16x32_bf16 v[64:67], a[188:191], v[40:43], v[64:67]
    v_mfma_f32_16x16x32_bf16 v[72:75], v[204:207], v[40:43], v[72:75]
    v_mfma_f32_16x16x32_bf16 v[52:55], a[28:31], v[44:47], v[52:55]
    v_mfma_f32_16x16x32_bf16 v[60:63], a[108:111], v[44:47], v[60:63]
    v_mfma_f32_16x16x32_bf16 v[68:71], a[188:191], v[44:47], v[68:71]
    v_mfma_f32_16x16x32_bf16 v[76:79], v[204:207], v[44:47], v[76:79]
    ds_read_b128 v[40:43], v31 offset:18432
    ds_read_b128 v[44:47], v31 offset:19456
    s_waitcnt lgkmcnt(2)
    v_mfma_f32_16x16x32_bf16 v[48:51], a[32:35], v[32:35], v[48:51]
    v_mfma_f32_16x16x32_bf16 v[56:59], a[112:115], v[32:35], v[56:59]
    v_mfma_f32_16x16x32_bf16 v[64:67], a[192:195], v[32:35], v[64:67]
    v_mfma_f32_16x16x32_bf16 v[72:75], v[208:211], v[32:35], v[72:75]
    v_mfma_f32_16x16x32_bf16 v[52:55], a[32:35], v[36:39], v[52:55]
    v_mfma_f32_16x16x32_bf16 v[60:63], a[112:115], v[36:39], v[60:63]
    v_mfma_f32_16x16x32_bf16 v[68:71], a[192:195], v[36:39], v[68:71]
    v_mfma_f32_16x16x32_bf16 v[76:79], v[208:211], v[36:39], v[76:79]
    ds_read_b128 v[32:35], v31 offset:20480
    ds_read_b128 v[36:39], v31 offset:21504
    s_waitcnt lgkmcnt(2)
    v_mfma_f32_16x16x32_bf16 v[48:51], a[36:39], v[40:43], v[48:51]
    v_mfma_f32_16x16x32_bf16 v[56:59], a[116:119], v[40:43], v[56:59]
    v_mfma_f32_16x16x32_bf16 v[64:67], a[196:199], v[40:43], v[64:67]
    v_mfma_f32_16x16x32_bf16 v[72:75], v[212:215], v[40:43], v[72:75]
    v_mfma_f32_16x16x32_bf16 v[52:55], a[36:39], v[44:47], v[52:55]
    v_mfma_f32_16x16x32_bf16 v[60:63], a[116:119], v[44:47], v[60:63]
    v_mfma_f32_16x16x32_bf16 v[68:71], a[196:199], v[44:47], v[68:71]
    v_mfma_f32_16x16x32_bf16 v[76:79], v[212:215], v[44:47], v[76:79]
    ds_read_b128 v[40:43], v31 offset:22528
    ds_read_b128 v[44:47], v31 offset:23552
    s_waitcnt lgkmcnt(2)
    v_mfma_f32_16x16x32_bf16 v[48:51], a[40:43], v[32:35], v[48:51]
    v_mfma_f32_16x16x32_bf16 v[56:59], a[120:123], v[32:35], v[56:59]
    v_mfma_f32_16x16x32_bf16 v[64:67], a[200:203], v[32:35], v[64:67]
    v_mfma_f32_16x16x32_bf16 v[72:75], v[216:219], v[32:35], v[72:75]
    v_mfma_f32_16x16x32_bf16 v[52:55], a[40:43], v[36:39], v[52:55]
    v_mfma_f32_16x16x32_bf16 v[60:63], a[120:123], v[36:39], v[60:63]
    v_mfma_f32_16x16x32_bf16 v[68:71], a[200:203], v[36:39], v[68:71]
    v_mfma_f32_16x16x32_bf16 v[76:79], v[216:219], v[36:39], v[76:79]
    ds_read_b128 v[32:35], v31 offset:24576
    ds_read_b128 v[36:39], v31 offset:25600
    s_waitcnt lgkmcnt(2)
    v_mfma_f32_16x16x32_bf16 v[48:51], a[44:47], v[40:43], v[48:51]
    v_mfma_f32_16x16x32_bf16 v[56:59], a[124:127], v[40:43], v[56:59]
    v_mfma_f32_16x16x32_bf16 v[64:67], a[204:207], v[40:43], v[64:67]
    v_mfma_f32_16x16x32_bf16 v[72:75], v[220:223], v[40:43], v[72:75]
    v_mfma_f32_16x16x32_bf16 v[52:55], a[44:47], v[44:47], v[52:55]
    v_mfma_f32_16x16x32_bf16 v[60:63], a[124:127], v[44:47], v[60:63]
    v_mfma_f32_16x16x32_bf16 v[68:71], a[204:207], v[44:47], v[68:71]
    v_mfma_f32_16x16x32_bf16 v[76:79], v[220:223], v[44:47], v[76:79]
    ds_read_b128 v[40:43], v31 offset:26624
    ds_read_b128 v[44:47], v31 offset:27648
    s_waitcnt lgkmcnt(2)
    v_mfma_f32_16x16x32_bf16 v[48:51], a[48:51], v[32:35], v[48:51]
    v_mfma_f32_16x16x32_bf16 v[56:59], a[128:131], v[32:35], v[56:59]
    v_mfma_f32_16x16x32_bf16 v[64:67], a[208:211], v[32:35], v[64:67]
    v_mfma_f32_16x16x32_bf16 v[72:75], v[224:227], v[32:35], v[72:75]
    v_mfma_f32_16x16x32_bf16 v[52:55], a[48:51], v[36:39], v[52:55]
    v_mfma_f32_16x16x32_bf16 v[60:63], a[128:131], v[36:39], v[60:63]
    v_mfma_f32_16x16x32_bf16 v[68:71], a[208:211], v[36:39], v[68:71]
    v_mfma_f32_16x16x32_bf16 v[76:79], v[224:227], v[36:39], v[76:79]
    ds_read_b128 v[32:35], v31 offset:28672
    ds_read_b128 v[36:39], v31 offset:29696
    s_waitcnt lgkmcnt(2)
    v_mfma_f32_16x16x32_bf16 v[48:51], a[52:55], v[40:43], v[48:51]
    v_mfma_f32_16x16x32_bf16 v[56:59], a[132:135], v[40:43], v[56:59]
    v_mfma_f32_16x16x32_bf16 v[64:67], a[212:215], v[40:43], v[64:67]
    v_mfma_f32_16x16x32_bf16 v[72:75], v[228:231], v[40:43], v[72:75]
    v_mfma_f32_16x16x32_bf16 v[52:55], a[52:55], v[44:47], v[52:55]
    v_mfma_f32_16x16x32_bf16 v[60:63], a[132:135], v[44:47], v[60:63]
    v_mfma_f32_16x16x32_bf16 v[68:71], a[212:215], v[44:47], v[68:71]
    v_mfma_f32_16x16x32_bf16 v[76:79], v[228:231], v[44:47], v[76:79]
    ds_read_b128 v[40:43], v31 offset:30720
    ds_read_b128 v[44:47], v31 offset:31744
    s_waitcnt lgkmcnt(2)
    v_mfma_f32_16x16x32_bf16 v[48:51], a[56:59], v[32:35], v[48:51]
    v_mfma_f32_16x16x32_bf16 v[56:59], a[136:139], v[32:35], v[56:59]
    v_mfma_f32_16x16x32_bf16 v[64:67], a[216:219], v[32:35], v[64:67]
    v_mfma_f32_16x16x32_bf16 v[72:75], v[232:235], v[32:35], v[72:75]
    v_mfma_f32_16x16x32_bf16 v[52:55], a[56:59], v[36:39], v[52:55]
    v_mfma_f32_16x16x32_bf16 v[60:63], a[136:139], v[36:39], v[60:63]
    v_mfma_f32_16x16x32_bf16 v[68:71], a[216:219], v[36:39], v[68:71]
    v_mfma_f32_16x16x32_bf16 v[76:79], v[232:235], v[36:39], v[76:79]
    ds_read_b128 v[32:35], v31 offset:32768
    ds_read_b128 v[36:39], v31 offset:33792
    s_waitcnt lgkmcnt(2)
    v_mfma_f32_16x16x32_bf16 v[48:51], a[60:63], v[40:43], v[48:51]
    v_mfma_f32_16x16x32_bf16 v[56:59], a[140:143], v[40:43], v[56:59]
    v_mfma_f32_16x16x32_bf16 v[64:67], a[220:223], v[40:43], v[64:67]
    v_mfma_f32_16x16x32_bf16 v[72:75], v[236:239], v[40:43], v[72:75]
    v_mfma_f32_16x16x32_bf16 v[52:55], a[60:63], v[44:47], v[52:55]
    v_mfma_f32_16x16x32_bf16 v[60:63], a[140:143], v[44:47], v[60:63]
    v_mfma_f32_16x16x32_bf16 v[68:71], a[220:223], v[44:47], v[68:71]
    v_mfma_f32_16x16x32_bf16 v[76:79], v[236:239], v[44:47], v[76:79]
    ds_read_b128 v[40:43], v31 offset:34816
    ds_read_b128 v[44:47], v31 offset:35840
    s_waitcnt lgkmcnt(2)
    v_mfma_f32_16x16x32_bf16 v[48:51], a[64:67], v[32:35], v[48:51]
    v_mfma_f32_16x16x32_bf16 v[56:59], a[144:147], v[32:35], v[56:59]
    v_mfma_f32_16x16x32_bf16 v[64:67], a[224:227], v[32:35], v[64:67]
    v_mfma_f32_16x16x32_bf16 v[72:75], v[240:243], v[32:35], v[72:75]
    v_mfma_f32_16x16x32_bf16 v[52:55], a[64:67], v[36:39], v[52:55]
    v_mfma_f32_16x16x32_bf16 v[60:63], a[144:147], v[36:39], v[60:63]
    v_mfma_f32_16x16x32_bf16 v[68:71], a[224:227], v[36:39], v[68:71]
    v_mfma_f32_16x16x32_bf16 v[76:79], v[240:243], v[36:39], v[76:79]
    ds_read_b128 v[32:35], v31 offset:36864
    ds_read_b128 v[36:39], v31 offset:37888
    s_waitcnt lgkmcnt(2)
    v_mfma_f32_16x16x32_bf16 v[48:51], a[68:71], v[40:43], v[48:51]
    v_mfma_f32_16x16x32_bf16 v[56:59], a[148:151], v[40:43], v[56:59]
    v_mfma_f32_16x16x32_bf16 v[64:67], a[228:231], v[40:43], v[64:67]
    v_mfma_f32_16x16x32_bf16 v[72:75], v[244:247], v[40:43], v[72:75]
    v_mfma_f32_16x16x32_bf16 v[52:55], a[68:71], v[44:47], v[52:55]
    v_mfma_f32_16x16x32_bf16 v[60:63], a[148:151], v[44:47], v[60:63]
    v_mfma_f32_16x16x32_bf16 v[68:71], a[228:231], v[44:47], v[68:71]
    v_mfma_f32_16x16x32_bf16 v[76:79], v[244:247], v[44:47], v[76:79]
    ds_read_b128 v[40:43], v31 offset:38912
    ds_read_b128 v[44:47], v31 offset:39936
    s_waitcnt lgkmcnt(2)
    v_mfma_f32_16x16x32_bf16 v[48:51], a[72:75], v[32:35], v[48:51]
    v_mfma_f32_16x16x32_bf16 v[56:59], a[152:155], v[32:35], v[56:59]
    v_mfma_f32_16x16x32_bf16 v[64:67], a[232:235], v[32:35], v[64:67]
    v_mfma_f32_16x16x32_bf16 v[72:75], v[248:251], v[32:35], v[72:75]
    v_mfma_f32_16x16x32_bf16 v[52:55], a[72:75], v[36:39], v[52:55]
    v_mfma_f32_16x16x32_bf16 v[60:63], a[152:155], v[36:39], v[60:63]
    v_mfma_f32_16x16x32_bf16 v[68:71], a[232:235], v[36:39], v[68:71]
    v_mfma_f32_16x16x32_bf16 v[76:79], v[248:251], v[36:39], v[76:79]
    s_waitcnt lgkmcnt(0)
    v_mfma_f32_16x16x32_bf16 v[48:51], a[76:79], v[40:43], v[48:51]
    v_mfma_f32_16x16x32_bf16 v[56:59], a[156:159], v[40:43], v[56:59]
    v_mfma_f32_16x16x32_bf16 v[64:67], a[236:239], v[40:43], v[64:67]
    v_mfma_f32_16x16x32_bf16 v[72:75], v[252:255], v[40:43], v[72:75]
    v_mfma_f32_16x16x32_bf16 v[52:55], a[76:79], v[44:47], v[52:55]
    v_mfma_f32_16x16x32_bf16 v[60:63], a[156:159], v[44:47], v[60:63]
    v_mfma_f32_16x16x32_bf16 v[68:71], a[236:239], v[44:47], v[68:71]
    v_mfma_f32_16x16x32_bf16 v[76:79], v[252:255], v[44:47], v[76:79]
    s_add_u32 s39, s37, 25165824
    s_nop 0
    v_cvt_pk_bf16_f32 v80, v48, v56
    v_cvt_pk_bf16_f32 v81, v49, v57
    v_cvt_pk_bf16_f32 v82, v50, v58
    v_cvt_pk_bf16_f32 v83, v51, v59
    buffer_store_dwordx4 v[80:83], v29, s[4:7], s39 offen sc1
    v_cvt_pk_bf16_f32 v84, v52, v60
    v_cvt_pk_bf16_f32 v85, v53, v61
    v_cvt_pk_bf16_f32 v86, v54, v62
    v_cvt_pk_bf16_f32 v87, v55, v63
    s_add_u32 s39, s39, 4096
    buffer_store_dwordx4 v[84:87], v29, s[4:7], s39 offen sc1
    s_add_u32 s39, s37, 8388608
    v_cvt_pk_bf16_f32 v88, v64, v72
    v_cvt_pk_bf16_f32 v89, v65, v73
    v_cvt_pk_bf16_f32 v90, v66, v74
    v_cvt_pk_bf16_f32 v91, v67, v75
    buffer_store_dwordx4 v[88:91], v29, s[4:7], s39 offen sc1
    v_cvt_pk_bf16_f32 v92, v68, v76
    v_cvt_pk_bf16_f32 v93, v69, v77
    v_cvt_pk_bf16_f32 v94, v70, v78
    v_cvt_pk_bf16_f32 v95, v71, v79
    s_add_u32 s39, s39, 4096
    buffer_store_dwordx4 v[92:95], v29, s[4:7], s39 offen sc1
    s_add_u32 s37, s37, 524288
    s_add_u32 s38, s38, 256
    s_mov_b32 s31, s44
    s_mov_b32 s44, s45
    s_mov_b32 s45, s46
    s_mov_b32 s46, s31
    s_add_u32 s34, s34, 81920
    s_add_u32 s35, s35, 1
    s_branch QKS_22
E_25:
    s_branch POOL0
R_VUS:
    s_lshr_b32 s32, s25, 1
    s_and_b32 s33, s25, 1
    s_mul_i32 s34, s33, 40960
    s_mov_b32 s40, s70
    s_mov_b32 s41, s71
    s_mov_b32 s42, 2621440
    s_mov_b32 s43, 0x00020000
    s_mov_b32 s8, s78
    s_mov_b32 s9, s79
    s_mov_b32 s10, 5242880
    s_mov_b32 s11, 0x00020000
    s_mov_b32 s12, s80
    s_mov_b32 s13, s81
    s_mov_b32 s14, 5242880
    s_mov_b32 s15, 0x00020000
    v_lshrrev_b32 v10, 4, v1
    v_mov_b32 v4, s24
    v_mul_u32_u24 v4, 4, v4
    v_add_u32 v10, v10, v4
    v_mul_u32_u24 v10, 8192, v10
    v_and_b32 v4, 15, v1
    v_lshrrev_b32 v5, 4, v1
    v_lshlrev_b32 v5, 1, v5
    v_xor_b32 v4, v4, v5
    v_lshlrev_b32 v4, 4, v4
    v_add_u32 v10, v10, v4
    v_lshrrev_b32 v15, 4, v1
    v_mov_b32 v4, s24
    v_mul_u32_u24 v4, 4, v4
    v_add_u32 v15, v15, v4
    v_mul_u32_u24 v15, 1280, v15
    v_and_b32 v4, 15, v1
    v_lshrrev_b32 v5, 4, v1
    v_lshlrev_b32 v5, 1, v5
    v_xor_b32 v4, v4, v5
    v_lshlrev_b32 v4, 4, v4
    v_add_u32 v15, v15, v4
    v_mul_u32_u24 v11, 2176, v3
    v_and_b32 v4, 15, v1
    v_lshrrev_b32 v4, 2, v4
    v_lshlrev_b32 v4, 8, v4
    v_add_u32 v11, v11, v4
    v_mov_b32 v4, s24
    v_mul_u32_u24 v4, 2, v4
    v_add_u32 v4, 0, v4
    v_and_b32 v5, 15, v1
    v_lshrrev_b32 v5, 2, v5
    v_xor_b32 v4, v4, v5
    v_lshlrev_b32 v4, 5, v4
    v_add_u32 v11, v11, v4
    v_and_b32 v4, 3, v1
    v_lshlrev_b32 v4, 3, v4
    v_add_u32 v11, v11, v4
    v_mul_u32_u24 v16, 1088, v3
    v_and_b32 v4, 15, v1
    v_lshrrev_b32 v4, 2, v4
    v_lshlrev_b32 v4, 8, v4
    v_add_u32 v16, v16, v4
    v_mov_b32 v4, s24
    v_mul_u32_u24 v4, 2, v4
    v_add_u32 v4, 0, v4
    v_and_b32 v5, 15, v1
    v_lshrrev_b32 v5, 2, v5
    v_xor_b32 v4, v4, v5
    v_lshlrev_b32 v4, 5, v4
    v_add_u32 v16, v16, v4
    v_and_b32 v4, 3, v1
    v_lshlrev_b32 v4, 3, v4
    v_add_u32 v16, v16, v4
    v_mul_u32_u24 v12, 2176, v3
    v_and_b32 v4, 15, v1
    v_lshrrev_b32 v4, 2, v4
    v_lshlrev_b32 v4, 8, v4
    v_add_u32 v12, v12, v4
    v_mov_b32 v4, s24
    v_mul_u32_u24 v4, 2, v4
    v_add_u32 v4, 1, v4
    v_and_b32 v5, 15, v1
    v_lshrrev_b32 v5, 2, v5
    v_xor_b32 v4, v4, v5
    v_lshlrev_b32 v4, 5, v4
    v_add_u32 v12, v12, v4
    v_and_b32 v4, 3, v1
    v_lshlrev_b32 v4, 3, v4
    v_add_u32 v12, v12, v4
    v_mul_u32_u24 v17, 1088, v3
    v_and_b32 v4, 15, v1
    v_lshrrev_b32 v4, 2, v4
    v_lshlrev_b32 v4, 8, v4
    v_add_u32 v17, v17, v4
    v_mov_b32 v4, s24
    v_mul_u32_u24 v4, 2, v4
    v_add_u32 v4, 1, v4
    v_and_b32 v5, 15, v1
    v_lshrrev_b32 v5, 2, v5
    v_xor_b32 v4, v4, v5
    v_lshlrev_b32 v4, 5, v4
    v_add_u32 v17, v17, v4
    v_and_b32 v4, 3, v1
    v_lshlrev_b32 v4, 3, v4
    v_add_u32 v17, v17, v4
    v_add_u32 v20, 69632, v11
    v_add_u32 v21, 69632, v12
    v_add_u32 v25, 69632, v16
    v_add_u32 v26, 69632, v17
    v_add_u32 v27, 69632, v18
    v_add_u32 v28, 69632, v19
    s_lshl_b32 s28, s32, 8
    s_mul_i32 s29, s32, 163840
    s_mul_i32 s26, s24, 1088
    s_add_u32 m0, s26, 0
    s_add_u32 s27, s28, 0
    buffer_load_dwordx4 v10, s[8:11], s27 offen lds
    s_add_u32 m0, s26, 4352
    s_add_u32 s27, s28, 131072
    buffer_load_dwordx4 v10, s[8:11], s27 offen lds
    s_add_u32 m0, s26, 8704
    s_add_u32 s27, s28, 262144
    buffer_load_dwordx4 v10, s[8:11], s27 offen lds
    s_add_u32 m0, s26, 13056
    s_add_u32 s27, s28, 393216
    buffer_load_dwordx4 v10, s[8:11], s27 offen lds
    s_add_u32 m0, s26, 17408
    s_add_u32 s27, s28, 524288
    buffer_load_dwordx4 v10, s[8:11], s27 offen lds
    s_add_u32 m0, s26, 21760
    s_add_u32 s27, s28, 655360
    buffer_load_dwordx4 v10, s[8:11], s27 offen lds
    s_add_u32 m0, s26, 26112
    s_add_u32 s27, s28, 786432
    buffer_load_dwordx4 v10, s[8:11], s27 offen lds
    s_add_u32 m0, s26, 30464
    s_add_u32 s27, s28, 917504
    buffer_load_dwordx4 v10, s[8:11], s27 offen lds
    s_add_u32 m0, s26, 34816
    s_add_u32 s27, s28, 1048576
    buffer_load_dwordx4 v10, s[8:11], s27 offen lds
    s_add_u32 m0, s26, 39168
    s_add_u32 s27, s28, 1179648
    buffer_load_dwordx4 v10, s[8:11], s27 offen lds
    s_add_u32 m0, s26, 43520
    s_add_u32 s27, s28, 1310720
    buffer_load_dwordx4 v10, s[8:11], s27 offen lds
    s_add_u32 m0, s26, 47872
    s_add_u32 s27, s28, 1441792
    buffer_load_dwordx4 v10, s[8:11], s27 offen lds
    s_add_u32 m0, s26, 52224
    s_add_u32 s27, s28, 1572864
    buffer_load_dwordx4 v10, s[8:11], s27 offen lds
    s_add_u32 m0, s26, 56576
    s_add_u32 s27, s28, 1703936
    buffer_load_dwordx4 v10, s[8:11], s27 offen lds
    s_add_u32 m0, s26, 60928
    s_add_u32 s27, s28, 1835008
    buffer_load_dwordx4 v10, s[8:11], s27 offen lds
    s_add_u32 m0, s26, 65280
    s_add_u32 s27, s28, 1966080
    buffer_load_dwordx4 v10, s[8:11], s27 offen lds
    s_add_u32 m0, s26, 69632
    s_add_u32 s27, s28, 2097152
    buffer_load_dwordx4 v10, s[8:11], s27 offen lds
    s_add_u32 m0, s26, 73984
    s_add_u32 s27, s28, 2228224
    buffer_load_dwordx4 v10, s[8:11], s27 offen lds
    s_add_u32 m0, s26, 78336
    s_add_u32 s27, s28, 2359296
    buffer_load_dwordx4 v10, s[8:11], s27 offen lds
    s_add_u32 m0, s26, 82688
    s_add_u32 s27, s28, 2490368
    buffer_load_dwordx4 v10, s[8:11], s27 offen lds
    s_add_u32 m0, s26, 87040
    s_add_u32 s27, s28, 2621440
    buffer_load_dwordx4 v10, s[8:11], s27 offen lds
    s_add_u32 m0, s26, 91392
    s_add_u32 s27, s28, 2752512
    buffer_load_dwordx4 v10, s[8:11], s27 offen lds
    s_add_u32 m0, s26, 95744
    s_add_u32 s27, s28, 2883584
    buffer_load_dwordx4 v10, s[8:11], s27 offen lds
    s_add_u32 m0, s26, 100096
    s_add_u32 s27, s28, 3014656
    buffer_load_dwordx4 v10, s[8:11], s27 offen lds
    s_add_u32 m0, s26, 104448
    s_add_u32 s27, s28, 3145728
    buffer_load_dwordx4 v10, s[8:11], s27 offen lds
    s_add_u32 m0, s26, 108800
    s_add_u32 s27, s28, 3276800
    buffer_load_dwordx4 v10, s[8:11], s27 offen lds
    s_add_u32 m0, s26, 113152
    s_add_u32 s27, s28, 3407872
    buffer_load_dwordx4 v10, s[8:11], s27 offen lds
    s_add_u32 m0, s26, 117504
    s_add_u32 s27, s28, 3538944
    buffer_load_dwordx4 v10, s[8:11], s27 offen lds
    s_add_u32 m0, s26, 121856
    s_add_u32 s27, s28, 3670016
    buffer_load_dwordx4 v10, s[8:11], s27 offen lds
    s_add_u32 m0, s26, 126208
    s_add_u32 s27, s28, 3801088
    buffer_load_dwordx4 v10, s[8:11], s27 offen lds
    s_add_u32 m0, s26, 130560
    s_add_u32 s27, s28, 3932160
    buffer_load_dwordx4 v10, s[8:11], s27 offen lds
    s_add_u32 m0, s26, 134912
    s_add_u32 s27, s28, 4063232
    buffer_load_dwordx4 v10, s[8:11], s27 offen lds
    s_waitcnt vmcnt(16)
    s_barrier
    ds_read_b64_tr_b16 a[0:1], v11 offset:0
    ds_read_b64_tr_b16 a[2:3], v11 offset:1088
    ds_read_b64_tr_b16 a[4:5], v11 offset:8704
    ds_read_b64_tr_b16 a[6:7], v11 offset:9792
    ds_read_b64_tr_b16 a[8:9], v11 offset:17408
    ds_read_b64_tr_b16 a[10:11], v11 offset:18496
    ds_read_b64_tr_b16 a[12:13], v11 offset:26112
    ds_read_b64_tr_b16 a[14:15], v11 offset:27200
    ds_read_b64_tr_b16 a[16:17], v11 offset:34816
    ds_read_b64_tr_b16 a[18:19], v11 offset:35904
    ds_read_b64_tr_b16 a[20:21], v11 offset:43520
    ds_read_b64_tr_b16 a[22:23], v11 offset:44608
    ds_read_b64_tr_b16 a[24:25], v11 offset:52224
    ds_read_b64_tr_b16 a[26:27], v11 offset:53312
    ds_read_b64_tr_b16 a[28:29], v11 offset:60928
    ds_read_b64_tr_b16 a[30:31], v11 offset:62016
    ds_read_b64_tr_b16 a[80:81], v12 offset:0
    ds_read_b64_tr_b16 a[82:83], v12 offset:1088
    ds_read_b64_tr_b16 a[84:85], v12 offset:8704
    ds_read_b64_tr_b16 a[86:87], v12 offset:9792
    ds_read_b64_tr_b16 a[88:89], v12 offset:17408
    ds_read_b64_tr_b16 a[90:91], v12 offset:18496
    ds_read_b64_tr_b16 a[92:93], v12 offset:26112
    ds_read_b64_tr_b16 a[94:95], v12 offset:27200
    ds_read_b64_tr_b16 a[96:97], v12 offset:34816
    ds_read_b64_tr_b16 a[98:99], v12 offset:35904
    ds_read_b64_tr_b16 a[100:101], v12 offset:43520
    ds_read_b64_tr_b16 a[102:103], v12 offset:44608
    ds_read_b64_tr_b16 a[104:105], v12 offset:52224
    ds_read_b64_tr_b16 a[106:107], v12 offset:53312
    ds_read_b64_tr_b16 a[108:109], v12 offset:60928
    ds_read_b64_tr_b16 a[110:111], v12 offset:62016
    s_waitcnt lgkmcnt(0)
    s_barrier
    s_add_u32 m0, s26, 0
    s_add_u32 s27, s28, 4194304
    buffer_load_dwordx4 v10, s[8:11], s27 offen lds
    s_add_u32 m0, s26, 4352
    s_add_u32 s27, s28, 4325376
    buffer_load_dwordx4 v10, s[8:11], s27 offen lds
    s_add_u32 m0, s26, 8704
    s_add_u32 s27, s28, 4456448
    buffer_load_dwordx4 v10, s[8:11], s27 offen lds
    s_add_u32 m0, s26, 13056
    s_add_u32 s27, s28, 4587520
    buffer_load_dwordx4 v10, s[8:11], s27 offen lds
    s_add_u32 m0, s26, 17408
    s_add_u32 s27, s28, 4718592
    buffer_load_dwordx4 v10, s[8:11], s27 offen lds
    s_add_u32 m0, s26, 21760
    s_add_u32 s27, s28, 4849664
    buffer_load_dwordx4 v10, s[8:11], s27 offen lds
    s_add_u32 m0, s26, 26112
    s_add_u32 s27, s28, 4980736
    buffer_load_dwordx4 v10, s[8:11], s27 offen lds
    s_add_u32 m0, s26, 30464
    s_add_u32 s27, s28, 5111808
    buffer_load_dwordx4 v10, s[8:11], s27 offen lds
    s_add_u32 m0, s26, 34816
    s_add_u32 s27, s29, 0
    buffer_load_dwordx4 v15, s[12:15], s27 offen lds
    s_add_u32 m0, s26, 39168
    s_add_u32 s27, s29, 20480
    buffer_load_dwordx4 v15, s[12:15], s27 offen lds
    s_add_u32 m0, s26, 43520
    s_add_u32 s27, s29, 40960
    buffer_load_dwordx4 v15, s[12:15], s27 offen lds
    s_add_u32 m0, s26, 47872
    s_add_u32 s27, s29, 61440
    buffer_load_dwordx4 v15, s[12:15], s27 offen lds
    s_add_u32 m0, s26, 52224
    s_add_u32 s27, s29, 81920
    buffer_load_dwordx4 v15, s[12:15], s27 offen lds
    s_add_u32 m0, s26, 56576
    s_add_u32 s27, s29, 102400
    buffer_load_dwordx4 v15, s[12:15], s27 offen lds
    s_add_u32 m0, s26, 60928
    s_add_u32 s27, s29, 122880
    buffer_load_dwordx4 v15, s[12:15], s27 offen lds
    s_add_u32 m0, s26, 65280
    s_add_u32 s27, s29, 143360
    buffer_load_dwordx4 v15, s[12:15], s27 offen lds
    s_waitcnt vmcnt(16)
    s_barrier
    ds_read_b64_tr_b16 a[32:33], v20 offset:0
    ds_read_b64_tr_b16 a[34:35], v20 offset:1088
    ds_read_b64_tr_b16 a[36:37], v20 offset:8704
    ds_read_b64_tr_b16 a[38:39], v20 offset:9792
    ds_read_b64_tr_b16 a[40:41], v20 offset:17408
    ds_read_b64_tr_b16 a[42:43], v20 offset:18496
    ds_read_b64_tr_b16 a[44:45], v20 offset:26112
    ds_read_b64_tr_b16 a[46:47], v20 offset:27200
    ds_read_b64_tr_b16 a[48:49], v20 offset:34816
    ds_read_b64_tr_b16 a[50:51], v20 offset:35904
    ds_read_b64_tr_b16 a[52:53], v20 offset:43520
    ds_read_b64_tr_b16 a[54:55], v20 offset:44608
    ds_read_b64_tr_b16 a[56:57], v20 offset:52224
    ds_read_b64_tr_b16 a[58:59], v20 offset:53312
    ds_read_b64_tr_b16 a[60:61], v20 offset:60928
    ds_read_b64_tr_b16 a[62:63], v20 offset:62016
    ds_read_b64_tr_b16 a[112:113], v21 offset:0
    ds_read_b64_tr_b16 a[114:115], v21 offset:1088
    ds_read_b64_tr_b16 a[116:117], v21 offset:8704
    ds_read_b64_tr_b16 a[118:119], v21 offset:9792
    ds_read_b64_tr_b16 a[120:121], v21 offset:17408
    ds_read_b64_tr_b16 a[122:123], v21 offset:18496
    ds_read_b64_tr_b16 a[124:125], v21 offset:26112
    ds_read_b64_tr_b16 a[126:127], v21 offset:27200
    ds_read_b64_tr_b16 a[128:129], v21 offset:34816
    ds_read_b64_tr_b16 a[130:131], v21 offset:35904
    ds_read_b64_tr_b16 a[132:133], v21 offset:43520
    ds_read_b64_tr_b16 a[134:135], v21 offset:44608
    ds_read_b64_tr_b16 a[136:137], v21 offset:52224
    ds_read_b64_tr_b16 a[138:139], v21 offset:53312
    ds_read_b64_tr_b16 a[140:141], v21 offset:60928
    ds_read_b64_tr_b16 a[142:143], v21 offset:62016
    s_waitcnt lgkmcnt(0)
    s_barrier
    s_add_u32 m0, s26, 69632
    s_add_u32 s27, s29, 256
    buffer_load_dwordx4 v15, s[12:15], s27 offen lds
    s_add_u32 m0, s26, 73984
    s_add_u32 s27, s29, 20736
    buffer_load_dwordx4 v15, s[12:15], s27 offen lds
    s_add_u32 m0, s26, 78336
    s_add_u32 s27, s29, 41216
    buffer_load_dwordx4 v15, s[12:15], s27 offen lds
    s_add_u32 m0, s26, 82688
    s_add_u32 s27, s29, 61696
    buffer_load_dwordx4 v15, s[12:15], s27 offen lds
    s_add_u32 m0, s26, 87040
    s_add_u32 s27, s29, 82176
    buffer_load_dwordx4 v15, s[12:15], s27 offen lds
    s_add_u32 m0, s26, 91392
    s_add_u32 s27, s29, 102656
    buffer_load_dwordx4 v15, s[12:15], s27 offen lds
    s_add_u32 m0, s26, 95744
    s_add_u32 s27, s29, 123136
    buffer_load_dwordx4 v15, s[12:15], s27 offen lds
    s_add_u32 m0, s26, 100096
    s_add_u32 s27, s29, 143616
    buffer_load_dwordx4 v15, s[12:15], s27 offen lds
    s_add_u32 m0, s26, 104448
    s_add_u32 s27, s29, 512
    buffer_load_dwordx4 v15, s[12:15], s27 offen lds
    s_add_u32 m0, s26, 108800
    s_add_u32 s27, s29, 20992
    buffer_load_dwordx4 v15, s[12:15], s27 offen lds
    s_add_u32 m0, s26, 113152
    s_add_u32 s27, s29, 41472
    buffer_load_dwordx4 v15, s[12:15], s27 offen lds
    s_add_u32 m0, s26, 117504
    s_add_u32 s27, s29, 61952
    buffer_load_dwordx4 v15, s[12:15], s27 offen lds
    s_add_u32 m0, s26, 121856
    s_add_u32 s27, s29, 82432
    buffer_load_dwordx4 v15, s[12:15], s27 offen lds
    s_add_u32 m0, s26, 126208
    s_add_u32 s27, s29, 102912
    buffer_load_dwordx4 v15, s[12:15], s27 offen lds
    s_add_u32 m0, s26, 130560
    s_add_u32 s27, s29, 123392
    buffer_load_dwordx4 v15, s[12:15], s27 offen lds
    s_add_u32 m0, s26, 134912
    s_add_u32 s27, s29, 143872
    buffer_load_dwordx4 v15, s[12:15], s27 offen lds
    s_waitcnt vmcnt(16)
    s_barrier
    ds_read_b64_tr_b16 a[64:65], v11 offset:0
    ds_read_b64_tr_b16 a[66:67], v11 offset:1088
    ds_read_b64_tr_b16 a[68:69], v11 offset:8704
    ds_read_b64_tr_b16 a[70:71], v11 offset:9792
    ds_read_b64_tr_b16 a[72:73], v11 offset:17408
    ds_read_b64_tr_b16 a[74:75], v11 offset:18496
    ds_read_b64_tr_b16 a[76:77], v11 offset:26112
    ds_read_b64_tr_b16 a[78:79], v11 offset:27200
    ds_read_b64_tr_b16 a[144:145], v12 offset:0
    ds_read_b64_tr_b16 a[146:147], v12 offset:1088
    ds_read_b64_tr_b16 a[148:149], v12 offset:8704
    ds_read_b64_tr_b16 a[150:151], v12 offset:9792
    ds_read_b64_tr_b16 a[152:153], v12 offset:17408
    ds_read_b64_tr_b16 a[154:155], v12 offset:18496
    ds_read_b64_tr_b16 a[156:157], v12 offset:26112
    ds_read_b64_tr_b16 a[158:159], v12 offset:27200
    ds_read_b64_tr_b16 a[160:161], v16 offset:34816
    ds_read_b64_tr_b16 a[162:163], v16 offset:39168
    ds_read_b64_tr_b16 a[164:165], v16 offset:43520
    ds_read_b64_tr_b16 a[166:167], v16 offset:47872
    ds_read_b64_tr_b16 a[168:169], v16 offset:52224
    ds_read_b64_tr_b16 a[170:171], v16 offset:56576
    ds_read_b64_tr_b16 a[172:173], v16 offset:60928
    ds_read_b64_tr_b16 a[174:175], v16 offset:65280
    ds_read_b64_tr_b16 a[176:177], v17 offset:34816
    ds_read_b64_tr_b16 a[178:179], v17 offset:39168
    ds_read_b64_tr_b16 a[180:181], v17 offset:43520
    ds_read_b64_tr_b16 a[182:183], v17 offset:47872
    ds_read_b64_tr_b16 a[184:185], v17 offset:52224
    ds_read_b64_tr_b16 a[186:187], v17 offset:56576
    ds_read_b64_tr_b16 a[188:189], v17 offset:60928
    ds_read_b64_tr_b16 a[190:191], v17 offset:65280
    s_waitcnt lgkmcnt(0)
    s_barrier
    s_add_u32 m0, s26, 0
    s_add_u32 s27, s29, 768
    buffer_load_dwordx4 v15, s[12:15], s27 offen lds
    s_add_u32 m0, s26, 4352
    s_add_u32 s27, s29, 21248
    buffer_load_dwordx4 v15, s[12:15], s27 offen lds
    s_add_u32 m0, s26, 8704
    s_add_u32 s27, s29, 41728
    buffer_load_dwordx4 v15, s[12:15], s27 offen lds
    s_add_u32 m0, s26, 13056
    s_add_u32 s27, s29, 62208
    buffer_load_dwordx4 v15, s[12:15], s27 offen lds
    s_add_u32 m0, s26, 17408
    s_add_u32 s27, s29, 82688
    buffer_load_dwordx4 v15, s[12:15], s27 offen lds
    s_add_u32 m0, s26, 21760
    s_add_u32 s27, s29, 103168
    buffer_load_dwordx4 v15, s[12:15], s27 offen lds
    s_add_u32 m0, s26, 26112
    s_add_u32 s27, s29, 123648
    buffer_load_dwordx4 v15, s[12:15], s27 offen lds
    s_add_u32 m0, s26, 30464
    s_add_u32 s27, s29, 144128
    buffer_load_dwordx4 v15, s[12:15], s27 offen lds
    s_add_u32 m0, s26, 34816
    s_add_u32 s27, s29, 1024
    buffer_load_dwordx4 v15, s[12:15], s27 offen lds
    s_add_u32 m0, s26, 39168
    s_add_u32 s27, s29, 21504
    buffer_load_dwordx4 v15, s[12:15], s27 offen lds
    s_add_u32 m0, s26, 43520
    s_add_u32 s27, s29, 41984
    buffer_load_dwordx4 v15, s[12:15], s27 offen lds
    s_add_u32 m0, s26, 47872
    s_add_u32 s27, s29, 62464
    buffer_load_dwordx4 v15, s[12:15], s27 offen lds
    s_add_u32 m0, s26, 52224
    s_add_u32 s27, s29, 82944
    buffer_load_dwordx4 v15, s[12:15], s27 offen lds
    s_add_u32 m0, s26, 56576
    s_add_u32 s27, s29, 103424
    buffer_load_dwordx4 v15, s[12:15], s27 offen lds
    s_add_u32 m0, s26, 60928
    s_add_u32 s27, s29, 123904
    buffer_load_dwordx4 v15, s[12:15], s27 offen lds
    s_add_u32 m0, s26, 65280
    s_add_u32 s27, s29, 144384
    buffer_load_dwordx4 v15, s[12:15], s27 offen lds
    s_waitcnt vmcnt(16)
    s_barrier
    ds_read_b64_tr_b16 a[192:193], v25 offset:0
    ds_read_b64_tr_b16 a[194:195], v25 offset:4352
    ds_read_b64_tr_b16 a[196:197], v25 offset:8704
    ds_read_b64_tr_b16 a[198:199], v25 offset:13056
    ds_read_b64_tr_b16 a[200:201], v25 offset:17408
    ds_read_b64_tr_b16 a[202:203], v25 offset:21760
    ds_read_b64_tr_b16 a[204:205], v25 offset:26112
    ds_read_b64_tr_b16 a[206:207], v25 offset:30464
    ds_read_b64_tr_b16 a[208:209], v26 offset:0
    ds_read_b64_tr_b16 a[210:211], v26 offset:4352
    ds_read_b64_tr_b16 a[212:213], v26 offset:8704
    ds_read_b64_tr_b16 a[214:215], v26 offset:13056
    ds_read_b64_tr_b16 a[216:217], v26 offset:17408
    ds_read_b64_tr_b16 a[218:219], v26 offset:21760
    ds_read_b64_tr_b16 a[220:221], v26 offset:26112
    ds_read_b64_tr_b16 a[222:223], v26 offset:30464
    ds_read_b64_tr_b16 a[224:225], v25 offset:34816
    ds_read_b64_tr_b16 a[226:227], v25 offset:39168
    ds_read_b64_tr_b16 a[228:229], v25 offset:43520
    ds_read_b64_tr_b16 a[230:231], v25 offset:47872
    ds_read_b64_tr_b16 a[232:233], v25 offset:52224
    ds_read_b64_tr_b16 a[234:235], v25 offset:56576
    ds_read_b64_tr_b16 a[236:237], v25 offset:60928
    ds_read_b64_tr_b16 a[238:239], v25 offset:65280
    ds_read_b64_tr_b16 a[240:241], v26 offset:34816
    ds_read_b64_tr_b16 a[242:243], v26 offset:39168
    ds_read_b64_tr_b16 a[244:245], v26 offset:43520
    ds_read_b64_tr_b16 a[246:247], v26 offset:47872
    ds_read_b64_tr_b16 a[248:249], v26 offset:52224
    ds_read_b64_tr_b16 a[250:251], v26 offset:56576
    ds_read_b64_tr_b16 a[252:253], v26 offset:60928
    ds_read_b64_tr_b16 a[254:255], v26 offset:65280
    s_waitcnt lgkmcnt(0)
    s_barrier
    v_mul_u32_u24 v30, 1280, v2
    v_lshlrev_b32 v4, 4, v3
    v_add_u32 v30, v30, v4
    v_mov_b32 v4, s24
    v_mul_u32_u24 v4, 320, v4
    v_add_u32 v30, v30, v4
    s_mul_i32 s47, s24, 10240
    s_add_u32 s28, s47, 69632
    s_add_u32 m0, s28, 0
    s_add_u32 s27, s34, 0
    buffer_load_dwordx4 v30, s[40:43], s27 offen lds
    s_add_u32 m0, s28, 1024
    s_add_u32 s27, s34, 20480
    buffer_load_dwordx4 v30, s[40:43], s27 offen lds
    s_add_u32 m0, s28, 2048
    s_add_u32 s27, s34, 64
    buffer_load_dwordx4 v30, s[40:43], s27 offen lds
    s_add_u32 m0, s28, 3072
    s_add_u32 s27, s34, 20544
    buffer_load_dwordx4 v30, s[40:43], s27 offen lds
    s_add_u32 m0, s28, 4096
    s_add_u32 s27, s34, 128
    buffer_load_dwordx4 v30, s[40:43], s27 offen lds
    s_add_u32 m0, s28, 5120
    s_add_u32 s27, s34, 20608
    buffer_load_dwordx4 v30, s[40:43], s27 offen lds
    s_add_u32 m0, s28, 6144
    s_add_u32 s27, s34, 192
    buffer_load_dwordx4 v30, s[40:43], s27 offen lds
    s_add_u32 m0, s28, 7168
    s_add_u32 s27, s34, 20672
    buffer_load_dwordx4 v30, s[40:43], s27 offen lds
    s_add_u32 m0, s28, 8192
    s_add_u32 s27, s34, 256
    buffer_load_dwordx4 v30, s[40:43], s27 offen lds
    s_add_u32 m0, s28, 9216
    s_add_u32 s27, s34, 20736
    buffer_load_dwordx4 v30, s[40:43], s27 offen lds
    s_add_u32 s28, s47, 110592
    s_add_u32 s36, s34, 81920
    s_add_u32 m0, s28, 0
    s_add_u32 s27, s36, 0
    buffer_load_dwordx4 v30, s[40:43], s27 offen lds
    s_add_u32 m0, s28, 1024
    s_add_u32 s27, s36, 20480
    buffer_load_dwordx4 v30, s[40:43], s27 offen lds
    s_add_u32 m0, s28, 2048
    s_add_u32 s27, s36, 64
    buffer_load_dwordx4 v30, s[40:43], s27 offen lds
    s_add_u32 m0, s28, 3072
    s_add_u32 s27, s36, 20544
    buffer_load_dwordx4 v30, s[40:43], s27 offen lds
    s_add_u32 m0, s28, 4096
    s_add_u32 s27, s36, 128
    buffer_load_dwordx4 v30, s[40:43], s27 offen lds
    s_add_u32 m0, s28, 5120
    s_add_u32 s27, s36, 20608
    buffer_load_dwordx4 v30, s[40:43], s27 offen lds
    s_add_u32 m0, s28, 6144
    s_add_u32 s27, s36, 192
    buffer_load_dwordx4 v30, s[40:43], s27 offen lds
    s_add_u32 m0, s28, 7168
    s_add_u32 s27, s36, 20672
    buffer_load_dwordx4 v30, s[40:43], s27 offen lds
    s_add_u32 m0, s28, 8192
    s_add_u32 s27, s36, 256
    buffer_load_dwordx4 v30, s[40:43], s27 offen lds
    s_add_u32 m0, s28, 9216
    s_add_u32 s27, s36, 20736
    buffer_load_dwordx4 v30, s[40:43], s27 offen lds
    s_waitcnt vmcnt(20)
    s_barrier
    ds_read_b64_tr_b16 v[192:193], v16 offset:0
    ds_read_b64_tr_b16 v[194:195], v16 offset:4352
    ds_read_b64_tr_b16 v[196:197], v16 offset:8704
    ds_read_b64_tr_b16 v[198:199], v16 offset:13056
    ds_read_b64_tr_b16 v[200:201], v16 offset:17408
    ds_read_b64_tr_b16 v[202:203], v16 offset:21760
    ds_read_b64_tr_b16 v[204:205], v16 offset:26112
    ds_read_b64_tr_b16 v[206:207], v16 offset:30464
    ds_read_b64_tr_b16 v[208:209], v17 offset:0
    ds_read_b64_tr_b16 v[210:211], v17 offset:4352
    ds_read_b64_tr_b16 v[212:213], v17 offset:8704
    ds_read_b64_tr_b16 v[214:215], v17 offset:13056
    ds_read_b64_tr_b16 v[216:217], v17 offset:17408
    ds_read_b64_tr_b16 v[218:219], v17 offset:21760
    ds_read_b64_tr_b16 v[220:221], v17 offset:26112
    ds_read_b64_tr_b16 v[222:223], v17 offset:30464
    ds_read_b64_tr_b16 v[224:225], v16 offset:34816
    ds_read_b64_tr_b16 v[226:227], v16 offset:39168
    ds_read_b64_tr_b16 v[228:229], v16 offset:43520
    ds_read_b64_tr_b16 v[230:231], v16 offset:47872
    ds_read_b64_tr_b16 v[232:233], v16 offset:52224
    ds_read_b64_tr_b16 v[234:235], v16 offset:56576
    ds_read_b64_tr_b16 v[236:237], v16 offset:60928
    ds_read_b64_tr_b16 v[238:239], v16 offset:65280
    ds_read_b64_tr_b16 v[240:241], v17 offset:34816
    ds_read_b64_tr_b16 v[242:243], v17 offset:39168
    ds_read_b64_tr_b16 v[244:245], v17 offset:43520
    ds_read_b64_tr_b16 v[246:247], v17 offset:47872
    ds_read_b64_tr_b16 v[248:249], v17 offset:52224
    ds_read_b64_tr_b16 v[250:251], v17 offset:56576
    ds_read_b64_tr_b16 v[252:253], v17 offset:60928
    ds_read_b64_tr_b16 v[254:255], v17 offset:65280
    s_waitcnt lgkmcnt(0)
    s_barrier
    v_lshlrev_b32 v31, 4, v1
    v_add_u32 v31, 69632, v31
    v_lshlrev_b32 v29, 4, v1
    v_mov_b32 v4, s24
    v_lshlrev_b32 v4, 16, v4
    v_add_u32 v29, v29, v4
    v_lshlrev_b32 v28, 4, v1
    v_mov_b32 v4, s24
    v_lshlrev_b32 v4, 10, v4
    v_add_u32 v28, v28, v4
    v_add_u32 v28, 151552, v28
    v_lshlrev_b32 v27, 4, v1
    v_add_u32 v27, 151552, v27
    s_mul_i32 s37, s33, 1310720
    s_lshl_b32 s38, s32, 10
    s_add_u32 s37, s37, s38
    s_add_u32 s37, s37, 92274688
    s_lshl_b32 s38, s33, 5
    s_add_u32 s38, s38, s32
    s_lshl_b32 s38, s38, 2
    s_sub_u32 s38, s38, 256
    v_mov_b32 v4, 0
    buffer_load_dword v26, v4, s[20:23], 0 offen sc1
    s_mov_b32 s35, 0
    s_mov_b32 s44, 69632
    s_mov_b32 s45, 110592
    s_mov_b32 s46, 0
    s_waitcnt vmcnt(11)
    s_branch PW_38
VUS_33:
    s_cmp_eq_u32 s35, 1
    s_cbranch_scc1 FW_37
    s_cmp_eq_u32 s35, 32
    s_cbranch_scc1 FW_37
    s_cmp_eq_u32 s35, 31
    s_cbranch_scc1 LW_40
    s_waitcnt vmcnt(20)
    s_branch PW_38
LW_40:
    s_waitcnt vmcnt(10)
    s_branch PW_38
FW_37:
    s_waitcnt vmcnt(0)
PW_38:
    s_barrier
    s_cmp_eq_u32 s35, 0
    s_cbranch_scc1 NF_35
    s_cmp_lg_u32 s24, 0
    s_cbranch_scc1 NF_35
    s_cmp_lg_u32 s35, 1
    s_cbranch_scc1 F1_39
    v_cmp_ne_u32 vcc, 16, v26
    s_cbranch_vccz WI_41
    s_mov_b32 s31, 0
    v_min_u32 v4, 0, v1
    v_lshlrev_b32 v4, 2, v4
    s_mov_b32 s30, 50000
WF_42:
    buffer_load_dword v5, v4, s[20:23], s31 offen sc1
    s_waitcnt vmcnt(0)
    v_cmp_ne_u32 vcc, 16, v5
    s_cbranch_vccz WE_43
    s_sleep 2
    s_sub_u32 s30, s30, 1
    s_cmp_lg_u32 s30, 0
    s_cbranch_scc1 WF_42
    s_endpgm
WE_43:
WI_41:
    s_add_u32 s39, s38, 8192
    v_mov_b32 v4, 0
    v_mov_b32 v5, 1
    s_mov_b64 exec, 1
    buffer_store_dword v5, v4, s[4:7], s39 offen sc1
    s_mov_b64 exec, -1
    s_branch NF_35
F1_39:
    s_add_u32 s39, s38, 7936
    v_mov_b32 v4, 0
    v_mov_b32 v5, 1
    s_mov_b64 exec, 1
    buffer_store_dword v5, v4, s[4:7], s39 offen sc1
    s_mov_b64 exec, -1
    s_cmp_lg_u32 s35, 32
    s_cbranch_scc1 NF_35
    s_add_u32 s39, s38, 8192
    v_mov_b32 v4, 0
    v_mov_b32 v5, 1
    s_mov_b64 exec, 1
    buffer_store_dword v5, v4, s[4:7], s39 offen sc1
    s_mov_b64 exec, -1
NF_35:
    s_cmp_eq_u32 s35, 32
    s_cbranch_scc1 E_36
    v_lshlrev_b32 v31, 4, v1
    v_add_u32 v31, s44, v31
    s_cmp_ge_u32 s35, 30
    s_cbranch_scc1 SK_34
    s_add_u32 s36, s34, 163840
    s_add_u32 s28, s47, s46
    s_add_u32 m0, s28, 0
    s_add_u32 s27, s36, 0
    buffer_load_dwordx4 v30, s[40:43], s27 offen lds
    s_add_u32 m0, s28, 1024
    s_add_u32 s27, s36, 20480
    buffer_load_dwordx4 v30, s[40:43], s27 offen lds
    s_add_u32 m0, s28, 2048
    s_add_u32 s27, s36, 64
    buffer_load_dwordx4 v30, s[40:43], s27 offen lds
    s_add_u32 m0, s28, 3072
    s_add_u32 s27, s36, 20544
    buffer_load_dwordx4 v30, s[40:43], s27 offen lds
    s_add_u32 m0, s28, 4096
    s_add_u32 s27, s36, 128
    buffer_load_dwordx4 v30, s[40:43], s27 offen lds
    s_add_u32 m0, s28, 5120
    s_add_u32 s27, s36, 20608
    buffer_load_dwordx4 v30, s[40:43], s27 offen lds
    s_add_u32 m0, s28, 6144
    s_add_u32 s27, s36, 192
    buffer_load_dwordx4 v30, s[40:43], s27 offen lds
    s_add_u32 m0, s28, 7168
    s_add_u32 s27, s36, 20672
    buffer_load_dwordx4 v30, s[40:43], s27 offen lds
    s_add_u32 m0, s28, 8192
    s_add_u32 s27, s36, 256
    buffer_load_dwordx4 v30, s[40:43], s27 offen lds
    s_add_u32 m0, s28, 9216
    s_add_u32 s27, s36, 20736
    buffer_load_dwordx4 v30, s[40:43], s27 offen lds
SK_34:
    ds_read_b128 v[72:75], v31 offset:0
    ds_read_b128 v[76:79], v31 offset:1024
    ds_read_b128 v[80:83], v31 offset:2048
    ds_read_b128 v[84:87], v31 offset:3072
    ds_read_b128 v[88:91], v31 offset:4096
    ds_read_b128 v[92:95], v31 offset:5120
    ds_read_b128 v[96:99], v31 offset:6144
    ds_read_b128 v[100:103], v31 offset:7168
    s_waitcnt lgkmcnt(6)
    v_mfma_f32_16x16x32_bf16 v[48:51], a[0:3], v[72:75], 0
    v_mfma_f32_16x16x32_bf16 v[56:59], a[80:83], v[72:75], 0
    v_mfma_f32_16x16x32_bf16 v[52:55], a[0:3], v[76:79], 0
    v_mfma_f32_16x16x32_bf16 v[60:63], a[80:83], v[76:79], 0
    ds_read_b128 v[72:75], v31 offset:8192
    ds_read_b128 v[76:79], v31 offset:9216
    s_waitcnt lgkmcnt(6)
    v_mfma_f32_16x16x32_bf16 v[48:51], a[4:7], v[80:83], v[48:51]
    v_mfma_f32_16x16x32_bf16 v[56:59], a[84:87], v[80:83], v[56:59]
    v_mfma_f32_16x16x32_bf16 v[52:55], a[4:7], v[84:87], v[52:55]
    v_mfma_f32_16x16x32_bf16 v[60:63], a[84:87], v[84:87], v[60:63]
    ds_read_b128 v[80:83], v31 offset:10240
    ds_read_b128 v[84:87], v31 offset:11264
    s_waitcnt lgkmcnt(6)
    v_mfma_f32_16x16x32_bf16 v[48:51], a[8:11], v[88:91], v[48:51]
    v_mfma_f32_16x16x32_bf16 v[56:59], a[88:91], v[88:91], v[56:59]
    v_mfma_f32_16x16x32_bf16 v[52:55], a[8:11], v[92:95], v[52:55]
    v_mfma_f32_16x16x32_bf16 v[60:63], a[88:91], v[92:95], v[60:63]
    ds_read_b128 v[88:91], v31 offset:12288
    ds_read_b128 v[92:95], v31 offset:13312
    s_waitcnt lgkmcnt(6)
    v_mfma_f32_16x16x32_bf16 v[48:51], a[12:15], v[96:99], v[48:51]
    v_mfma_f32_16x16x32_bf16 v[56:59], a[92:95], v[96:99], v[56:59]
    v_mfma_f32_16x16x32_bf16 v[52:55], a[12:15], v[100:103], v[52:55]
    v_mfma_f32_16x16x32_bf16 v[60:63], a[92:95], v[100:103], v[60:63]
    ds_read_b128 v[96:99], v31 offset:14336
    ds_read_b128 v[100:103], v31 offset:15360
    s_waitcnt lgkmcnt(6)
    v_mfma_f32_16x16x32_bf16 v[48:51], a[16:19], v[72:75], v[48:51]
    v_mfma_f32_16x16x32_bf16 v[56:59], a[96:99], v[72:75], v[56:59]
    v_mfma_f32_16x16x32_bf16 v[52:55], a[16:19], v[76:79], v[52:55]
    v_mfma_f32_16x16x32_bf16 v[60:63], a[96:99], v[76:79], v[60:63]
    ds_read_b128 v[72:75], v31 offset:16384
    ds_read_b128 v[76:79], v31 offset:17408
    s_waitcnt lgkmcnt(6)
    v_mfma_f32_16x16x32_bf16 v[48:51], a[20:23], v[80:83], v[48:51]
    v_mfma_f32_16x16x32_bf16 v[56:59], a[100:103], v[80:83], v[56:59]
    v_mfma_f32_16x16x32_bf16 v[52:55], a[20:23], v[84:87], v[52:55]
    v_mfma_f32_16x16x32_bf16 v[60:63], a[100:103], v[84:87], v[60:63]
    ds_read_b128 v[80:83], v31 offset:18432
    ds_read_b128 v[84:87], v31 offset:19456
    s_waitcnt lgkmcnt(6)
    v_mfma_f32_16x16x32_bf16 v[48:51], a[24:27], v[88:91], v[48:51]
    v_mfma_f32_16x16x32_bf16 v[56:59], a[104:107], v[88:91], v[56:59]
    v_mfma_f32_16x16x32_bf16 v[52:55], a[24:27], v[92:95], v[52:55]
    v_mfma_f32_16x16x32_bf16 v[60:63], a[104:107], v[92:95], v[60:63]
    ds_read_b128 v[88:91], v31 offset:20480
    ds_read_b128 v[92:95], v31 offset:21504
    s_waitcnt lgkmcnt(6)
    v_mfma_f32_16x16x32_bf16 v[48:51], a[28:31], v[96:99], v[48:51]
    v_mfma_f32_16x16x32_bf16 v[56:59], a[108:111], v[96:99], v[56:59]
    v_mfma_f32_16x16x32_bf16 v[52:55], a[28:31], v[100:103], v[52:55]
    v_mfma_f32_16x16x32_bf16 v[60:63], a[108:111], v[100:103], v[60:63]
    ds_read_b128 v[96:99], v31 offset:22528
    ds_read_b128 v[100:103], v31 offset:23552
    s_waitcnt lgkmcnt(6)
    v_mfma_f32_16x16x32_bf16 v[48:51], a[32:35], v[72:75], v[48:51]
    v_mfma_f32_16x16x32_bf16 v[56:59], a[112:115], v[72:75], v[56:59]
    v_mfma_f32_16x16x32_bf16 v[52:55], a[32:35], v[76:79], v[52:55]
    v_mfma_f32_16x16x32_bf16 v[60:63], a[112:115], v[76:79], v[60:63]
    ds_read_b128 v[72:75], v31 offset:24576
    ds_read_b128 v[76:79], v31 offset:25600
    s_waitcnt lgkmcnt(6)
    v_mfma_f32_16x16x32_bf16 v[48:51], a[36:39], v[80:83], v[48:51]
    v_mfma_f32_16x16x32_bf16 v[56:59], a[116:119], v[80:83], v[56:59]
    v_mfma_f32_16x16x32_bf16 v[52:55], a[36:39], v[84:87], v[52:55]
    v_mfma_f32_16x16x32_bf16 v[60:63], a[116:119], v[84:87], v[60:63]
    ds_read_b128 v[80:83], v31 offset:26624
    ds_read_b128 v[84:87], v31 offset:27648
    s_waitcnt lgkmcnt(6)
    v_mfma_f32_16x16x32_bf16 v[48:51], a[40:43], v[88:91], v[48:51]
    v_mfma_f32_16x16x32_bf16 v[56:59], a[120:123], v[88:91], v[56:59]
    v_mfma_f32_16x16x32_bf16 v[52:55], a[40:43], v[92:95], v[52:55]
    v_mfma_f32_16x16x32_bf16 v[60:63], a[120:123], v[92:95], v[60:63]
    ds_read_b128 v[88:91], v31 offset:28672
    ds_read_b128 v[92:95], v31 offset:29696
    s_waitcnt lgkmcnt(6)
    v_mfma_f32_16x16x32_bf16 v[48:51], a[44:47], v[96:99], v[48:51]
    v_mfma_f32_16x16x32_bf16 v[56:59], a[124:127], v[96:99], v[56:59]
    v_mfma_f32_16x16x32_bf16 v[52:55], a[44:47], v[100:103], v[52:55]
    v_mfma_f32_16x16x32_bf16 v[60:63], a[124:127], v[100:103], v[60:63]
    ds_read_b128 v[96:99], v31 offset:30720
    ds_read_b128 v[100:103], v31 offset:31744
    s_waitcnt lgkmcnt(6)
    v_mfma_f32_16x16x32_bf16 v[48:51], a[48:51], v[72:75], v[48:51]
    v_mfma_f32_16x16x32_bf16 v[56:59], a[128:131], v[72:75], v[56:59]
    v_mfma_f32_16x16x32_bf16 v[52:55], a[48:51], v[76:79], v[52:55]
    v_mfma_f32_16x16x32_bf16 v[60:63], a[128:131], v[76:79], v[60:63]
    ds_read_b128 v[72:75], v31 offset:32768
    ds_read_b128 v[76:79], v31 offset:33792
    s_waitcnt lgkmcnt(6)
    v_mfma_f32_16x16x32_bf16 v[48:51], a[52:55], v[80:83], v[48:51]
    v_mfma_f32_16x16x32_bf16 v[56:59], a[132:135], v[80:83], v[56:59]
    v_mfma_f32_16x16x32_bf16 v[52:55], a[52:55], v[84:87], v[52:55]
    v_mfma_f32_16x16x32_bf16 v[60:63], a[132:135], v[84:87], v[60:63]
    ds_read_b128 v[80:83], v31 offset:34816
    ds_read_b128 v[84:87], v31 offset:35840
    s_waitcnt lgkmcnt(6)
    v_mfma_f32_16x16x32_bf16 v[48:51], a[56:59], v[88:91], v[48:51]
    v_mfma_f32_16x16x32_bf16 v[56:59], a[136:139], v[88:91], v[56:59]
    v_mfma_f32_16x16x32_bf16 v[52:55], a[56:59], v[92:95], v[52:55]
    v_mfma_f32_16x16x32_bf16 v[60:63], a[136:139], v[92:95], v[60:63]
    ds_read_b128 v[88:91], v31 offset:36864
    ds_read_b128 v[92:95], v31 offset:37888
    s_waitcnt lgkmcnt(6)
    v_mfma_f32_16x16x32_bf16 v[48:51], a[60:63], v[96:99], v[48:51]
    v_mfma_f32_16x16x32_bf16 v[56:59], a[140:143], v[96:99], v[56:59]
    v_mfma_f32_16x16x32_bf16 v[52:55], a[60:63], v[100:103], v[52:55]
    v_mfma_f32_16x16x32_bf16 v[60:63], a[140:143], v[100:103], v[60:63]
    ds_read_b128 v[96:99], v31 offset:38912
    ds_read_b128 v[100:103], v31 offset:39936
    s_waitcnt lgkmcnt(6)
    v_mfma_f32_16x16x32_bf16 v[48:51], a[64:67], v[72:75], v[48:51]
    v_mfma_f32_16x16x32_bf16 v[56:59], a[144:147], v[72:75], v[56:59]
    v_mfma_f32_16x16x32_bf16 v[52:55], a[64:67], v[76:79], v[52:55]
    v_mfma_f32_16x16x32_bf16 v[60:63], a[144:147], v[76:79], v[60:63]
    s_waitcnt lgkmcnt(4)
    v_mfma_f32_16x16x32_bf16 v[48:51], a[68:71], v[80:83], v[48:51]
    v_mfma_f32_16x16x32_bf16 v[56:59], a[148:151], v[80:83], v[56:59]
    v_mfma_f32_16x16x32_bf16 v[52:55], a[68:71], v[84:87], v[52:55]
    v_mfma_f32_16x16x32_bf16 v[60:63], a[148:151], v[84:87], v[60:63]
    s_waitcnt lgkmcnt(2)
    v_mfma_f32_16x16x32_bf16 v[48:51], a[72:75], v[88:91], v[48:51]
    v_mfma_f32_16x16x32_bf16 v[56:59], a[152:155], v[88:91], v[56:59]
    v_mfma_f32_16x16x32_bf16 v[52:55], a[72:75], v[92:95], v[52:55]
    v_mfma_f32_16x16x32_bf16 v[60:63], a[152:155], v[92:95], v[60:63]
    s_waitcnt lgkmcnt(0)
    v_mfma_f32_16x16x32_bf16 v[48:51], a[76:79], v[96:99], v[48:51]
    v_mfma_f32_16x16x32_bf16 v[56:59], a[156:159], v[96:99], v[56:59]
    v_mfma_f32_16x16x32_bf16 v[52:55], a[76:79], v[100:103], v[52:55]
    v_mfma_f32_16x16x32_bf16 v[60:63], a[156:159], v[100:103], v[60:63]
    s_nop 4
    v_cvt_pk_bf16_f32 v64, v48, v49
    v_cvt_pk_bf16_f32 v65, v50, v51
    v_cvt_pk_bf16_f32 v66, v56, v57
    v_cvt_pk_bf16_f32 v67, v58, v59
    ds_write_b128 v28, v[64:67] offset:0
    v_cvt_pk_bf16_f32 v68, v52, v53
    v_cvt_pk_bf16_f32 v69, v54, v55
    v_cvt_pk_bf16_f32 v70, v60, v61
    v_cvt_pk_bf16_f32 v71, v62, v63
    ds_write_b128 v28, v[68:71] offset:4096
    s_waitcnt lgkmcnt(0)
    s_barrier
    ds_read_b128 v[72:75], v27 offset:0
    ds_read_b128 v[76:79], v27 offset:1024
    ds_read_b128 v[80:83], v27 offset:2048
    ds_read_b128 v[84:87], v27 offset:3072
    ds_read_b128 v[88:91], v27 offset:4096
    ds_read_b128 v[92:95], v27 offset:5120
    ds_read_b128 v[96:99], v27 offset:6144
    ds_read_b128 v[100:103], v27 offset:7168
    s_waitcnt lgkmcnt(0)
    v_mfma_f32_16x16x32_bf16 v[104:107], v[72:75], a[160:163], 0
    v_mfma_f32_16x16x32_bf16 v[108:111], v[88:91], a[160:163], 0
    v_mfma_f32_16x16x32_bf16 v[112:115], v[72:75], a[176:179], 0
    v_mfma_f32_16x16x32_bf16 v[116:119], v[88:91], a[176:179], 0
    v_mfma_f32_16x16x32_bf16 v[104:107], v[76:79], a[164:167], v[104:107]
    v_mfma_f32_16x16x32_bf16 v[108:111], v[92:95], a[164:167], v[108:111]
    v_mfma_f32_16x16x32_bf16 v[112:115], v[76:79], a[180:183], v[112:115]
    v_mfma_f32_16x16x32_bf16 v[116:119], v[92:95], a[180:183], v[116:119]
    v_mfma_f32_16x16x32_bf16 v[104:107], v[80:83], a[168:171], v[104:107]
    v_mfma_f32_16x16x32_bf16 v[108:111], v[96:99], a[168:171], v[108:111]
    v_mfma_f32_16x16x32_bf16 v[112:115], v[80:83], a[184:187], v[112:115]
    v_mfma_f32_16x16x32_bf16 v[116:119], v[96:99], a[184:187], v[116:119]
    v_mfma_f32_16x16x32_bf16 v[104:107], v[84:87], a[172:175], v[104:107]
    v_mfma_f32_16x16x32_bf16 v[108:111], v[100:103], a[172:175], v[108:111]
    v_mfma_f32_16x16x32_bf16 v[112:115], v[84:87], a[188:191], v[112:115]
    v_mfma_f32_16x16x32_bf16 v[116:119], v[100:103], a[188:191], v[116:119]
    v_mfma_f32_16x16x32_bf16 v[120:123], v[72:75], a[192:195], 0
    v_mfma_f32_16x16x32_bf16 v[124:127], v[88:91], a[192:195], 0
    v_mfma_f32_16x16x32_bf16 v[128:131], v[72:75], a[208:211], 0
    v_mfma_f32_16x16x32_bf16 v[132:135], v[88:91], a[208:211], 0
    v_mfma_f32_16x16x32_bf16 v[120:123], v[76:79], a[196:199], v[120:123]
    v_cvt_pk_bf16_f32 v32, v104, v105
    v_mfma_f32_16x16x32_bf16 v[124:127], v[92:95], a[196:199], v[124:127]
    v_cvt_pk_bf16_f32 v33, v106, v107
    v_mfma_f32_16x16x32_bf16 v[128:131], v[76:79], a[212:215], v[128:131]
    v_cvt_pk_bf16_f32 v34, v108, v109
    v_mfma_f32_16x16x32_bf16 v[132:135], v[92:95], a[212:215], v[132:135]
    v_cvt_pk_bf16_f32 v35, v110, v111
    v_mfma_f32_16x16x32_bf16 v[120:123], v[80:83], a[200:203], v[120:123]
    s_add_u32 s39, s37, 0
    buffer_store_dwordx4 v[32:35], v29, s[4:7], s39 offen sc1
    v_mfma_f32_16x16x32_bf16 v[124:127], v[96:99], a[200:203], v[124:127]
    v_cvt_pk_bf16_f32 v36, v112, v113
    v_mfma_f32_16x16x32_bf16 v[128:131], v[80:83], a[216:219], v[128:131]
    v_cvt_pk_bf16_f32 v37, v114, v115
    v_mfma_f32_16x16x32_bf16 v[132:135], v[96:99], a[216:219], v[132:135]
    v_cvt_pk_bf16_f32 v38, v116, v117
    v_mfma_f32_16x16x32_bf16 v[120:123], v[84:87], a[204:207], v[120:123]
    v_cvt_pk_bf16_f32 v39, v118, v119
    v_mfma_f32_16x16x32_bf16 v[124:127], v[100:103], a[204:207], v[124:127]
    s_add_u32 s39, s37, 32768
    buffer_store_dwordx4 v[36:39], v29, s[4:7], s39 offen sc1
    v_mfma_f32_16x16x32_bf16 v[128:131], v[84:87], a[220:223], v[128:131]
    v_mfma_f32_16x16x32_bf16 v[132:135], v[100:103], a[220:223], v[132:135]
    v_mfma_f32_16x16x32_bf16 v[136:139], v[72:75], a[224:227], 0
    v_mfma_f32_16x16x32_bf16 v[140:143], v[88:91], a[224:227], 0
    v_mfma_f32_16x16x32_bf16 v[144:147], v[72:75], a[240:243], 0
    v_mfma_f32_16x16x32_bf16 v[148:151], v[88:91], a[240:243], 0
    v_mfma_f32_16x16x32_bf16 v[136:139], v[76:79], a[228:231], v[136:139]
    v_cvt_pk_bf16_f32 v40, v120, v121
    v_mfma_f32_16x16x32_bf16 v[140:143], v[92:95], a[228:231], v[140:143]
    v_cvt_pk_bf16_f32 v41, v122, v123
    v_mfma_f32_16x16x32_bf16 v[144:147], v[76:79], a[244:247], v[144:147]
    v_cvt_pk_bf16_f32 v42, v124, v125
    v_mfma_f32_16x16x32_bf16 v[148:151], v[92:95], a[244:247], v[148:151]
    v_cvt_pk_bf16_f32 v43, v126, v127
    v_mfma_f32_16x16x32_bf16 v[136:139], v[80:83], a[232:235], v[136:139]
    s_add_u32 s39, s37, 262144
    buffer_store_dwordx4 v[40:43], v29, s[4:7], s39 offen sc1
    v_mfma_f32_16x16x32_bf16 v[140:143], v[96:99], a[232:235], v[140:143]
    v_cvt_pk_bf16_f32 v44, v128, v129
    v_mfma_f32_16x16x32_bf16 v[144:147], v[80:83], a[248:251], v[144:147]
    v_cvt_pk_bf16_f32 v45, v130, v131
    v_mfma_f32_16x16x32_bf16 v[148:151], v[96:99], a[248:251], v[148:151]
    v_cvt_pk_bf16_f32 v46, v132, v133
    v_mfma_f32_16x16x32_bf16 v[136:139], v[84:87], a[236:239], v[136:139]
    v_cvt_pk_bf16_f32 v47, v134, v135
    v_mfma_f32_16x16x32_bf16 v[140:143], v[100:103], a[236:239], v[140:143]
    s_add_u32 s39, s37, 294912
    buffer_store_dwordx4 v[44:47], v29, s[4:7], s39 offen sc1
    v_mfma_f32_16x16x32_bf16 v[144:147], v[84:87], a[252:255], v[144:147]
    v_mfma_f32_16x16x32_bf16 v[148:151], v[100:103], a[252:255], v[148:151]
    v_mfma_f32_16x16x32_bf16 v[152:155], v[72:75], v[192:195], 0
    v_mfma_f32_16x16x32_bf16 v[156:159], v[88:91], v[192:195], 0
    v_mfma_f32_16x16x32_bf16 v[160:163], v[72:75], v[208:211], 0
    v_mfma_f32_16x16x32_bf16 v[164:167], v[88:91], v[208:211], 0
    v_mfma_f32_16x16x32_bf16 v[152:155], v[76:79], v[196:199], v[152:155]
    v_cvt_pk_bf16_f32 v32, v136, v137
    v_mfma_f32_16x16x32_bf16 v[156:159], v[92:95], v[196:199], v[156:159]
    v_cvt_pk_bf16_f32 v33, v138, v139
    v_mfma_f32_16x16x32_bf16 v[160:163], v[76:79], v[212:215], v[160:163]
    v_cvt_pk_bf16_f32 v34, v140, v141
    v_mfma_f32_16x16x32_bf16 v[164:167], v[92:95], v[212:215], v[164:167]
    v_cvt_pk_bf16_f32 v35, v142, v143
    v_mfma_f32_16x16x32_bf16 v[152:155], v[80:83], v[200:203], v[152:155]
    s_add_u32 s39, s37, 524288
    buffer_store_dwordx4 v[32:35], v29, s[4:7], s39 offen sc1
    v_mfma_f32_16x16x32_bf16 v[156:159], v[96:99], v[200:203], v[156:159]
    v_cvt_pk_bf16_f32 v36, v144, v145
    v_mfma_f32_16x16x32_bf16 v[160:163], v[80:83], v[216:219], v[160:163]
    v_cvt_pk_bf16_f32 v37, v146, v147
    v_mfma_f32_16x16x32_bf16 v[164:167], v[96:99], v[216:219], v[164:167]
    v_cvt_pk_bf16_f32 v38, v148, v149
    v_mfma_f32_16x16x32_bf16 v[152:155], v[84:87], v[204:207], v[152:155]
    v_cvt_pk_bf16_f32 v39, v150, v151
    v_mfma_f32_16x16x32_bf16 v[156:159], v[100:103], v[204:207], v[156:159]
    s_add_u32 s39, s37, 557056
    buffer_store_dwordx4 v[36:39], v29, s[4:7], s39 offen sc1
    v_mfma_f32_16x16x32_bf16 v[160:163], v[84:87], v[220:223], v[160:163]
    v_mfma_f32_16x16x32_bf16 v[164:167], v[100:103], v[220:223], v[164:167]
    v_mfma_f32_16x16x32_bf16 v[168:171], v[72:75], v[224:227], 0
    v_mfma_f32_16x16x32_bf16 v[172:175], v[88:91], v[224:227], 0
    v_mfma_f32_16x16x32_bf16 v[176:179], v[72:75], v[240:243], 0
    v_mfma_f32_16x16x32_bf16 v[180:183], v[88:91], v[240:243], 0
    v_mfma_f32_16x16x32_bf16 v[168:171], v[76:79], v[228:231], v[168:171]
    v_cvt_pk_bf16_f32 v40, v152, v153
    v_mfma_f32_16x16x32_bf16 v[172:175], v[92:95], v[228:231], v[172:175]
    v_cvt_pk_bf16_f32 v41, v154, v155
    v_mfma_f32_16x16x32_bf16 v[176:179], v[76:79], v[244:247], v[176:179]
    v_cvt_pk_bf16_f32 v42, v156, v157
    v_mfma_f32_16x16x32_bf16 v[180:183], v[92:95], v[244:247], v[180:183]
    v_cvt_pk_bf16_f32 v43, v158, v159
    v_mfma_f32_16x16x32_bf16 v[168:171], v[80:83], v[232:235], v[168:171]
    s_add_u32 s39, s37, 786432
    buffer_store_dwordx4 v[40:43], v29, s[4:7], s39 offen sc1
    v_mfma_f32_16x16x32_bf16 v[172:175], v[96:99], v[232:235], v[172:175]
    v_cvt_pk_bf16_f32 v44, v160, v161
    v_mfma_f32_16x16x32_bf16 v[176:179], v[80:83], v[248:251], v[176:179]
    v_cvt_pk_bf16_f32 v45, v162, v163
    v_mfma_f32_16x16x32_bf16 v[180:183], v[96:99], v[248:251], v[180:183]
    v_cvt_pk_bf16_f32 v46, v164, v165
    v_mfma_f32_16x16x32_bf16 v[168:171], v[84:87], v[236:239], v[168:171]
    v_cvt_pk_bf16_f32 v47, v166, v167
    v_mfma_f32_16x16x32_bf16 v[172:175], v[100:103], v[236:239], v[172:175]
    s_add_u32 s39, s37, 819200
    buffer_store_dwordx4 v[44:47], v29, s[4:7], s39 offen sc1
    v_mfma_f32_16x16x32_bf16 v[176:179], v[84:87], v[252:255], v[176:179]
    v_mfma_f32_16x16x32_bf16 v[180:183], v[100:103], v[252:255], v[180:183]
    s_nop 1
    v_cvt_pk_bf16_f32 v32, v168, v169
    v_cvt_pk_bf16_f32 v33, v170, v171
    v_cvt_pk_bf16_f32 v34, v172, v173
    v_cvt_pk_bf16_f32 v35, v174, v175
    s_add_u32 s39, s37, 1048576
    buffer_store_dwordx4 v[32:35], v29, s[4:7], s39 offen sc1
    v_cvt_pk_bf16_f32 v36, v176, v177
    v_cvt_pk_bf16_f32 v37, v178, v179
    v_cvt_pk_bf16_f32 v38, v180, v181
    v_cvt_pk_bf16_f32 v39, v182, v183
    s_add_u32 s39, s37, 1081344
    buffer_store_dwordx4 v[36:39], v29, s[4:7], s39 offen sc1
    s_add_u32 s37, s37, 2621440
    s_add_u32 s38, s38, 256
    s_mov_b32 s31, s44
    s_mov_b32 s44, s45
    s_mov_b32 s45, s46
    s_mov_b32 s46, s31
    s_add_u32 s34, s34, 81920
    s_add_u32 s35, s35, 1
    s_branch VUS_33
E_36:
    s_branch POOL0
R_MISC:
    s_lshl_b32 s31, s25, 12
    v_lshlrev_b32 v12, 4, v0
    v_mov_b32 v8, 0
    v_mov_b32 v9, 0
    v_mov_b32 v10, 0
    v_mov_b32 v11, 0
    buffer_store_dwordx4 v[8:11], v12, s[4:7], s31 offen sc1
    v_mov_b32 v16, -1
    v_mov_b32 v17, -1
    v_mov_b32 v18, -1
    v_mov_b32 v19, -1
MFILL:
    s_sub_u32 s47, 0, s88
    s_and_b32 s47, s47, 0x1fffff
    s_add_u32 s46, s47, 2097152
    s_mul_i32 s31, s25, 114688
    s_add_u32 s31, s31, s46
    s_add_u32 s47, s46, 8192
    s_add_u32 s33, s31, 0
    buffer_store_dwordx4 v[16:19], v12, s[4:7], s33 offen sc1
    s_add_u32 s33, s31, 4096
    buffer_store_dwordx4 v[16:19], v12, s[4:7], s33 offen sc1
    s_add_u32 s33, s31, 8192
    buffer_store_dwordx4 v[16:19], v12, s[4:7], s33 offen sc1
    s_add_u32 s33, s31, 12288
    buffer_store_dwordx4 v[16:19], v12, s[4:7], s33 offen sc1
    s_add_u32 s33, s31, 16384
    buffer_store_dwordx4 v[16:19], v12, s[4:7], s33 offen sc1
    s_add_u32 s33, s31, 20480
    buffer_store_dwordx4 v[16:19], v12, s[4:7], s33 offen sc1
    s_add_u32 s33, s31, 24576
    buffer_store_dwordx4 v[16:19], v12, s[4:7], s33 offen sc1
    s_add_u32 s33, s31, 28672
    buffer_store_dwordx4 v[16:19], v12, s[4:7], s33 offen sc1
    s_add_u32 s33, s31, 32768
    buffer_store_dwordx4 v[16:19], v12, s[4:7], s33 offen sc1
    s_add_u32 s33, s31, 36864
    buffer_store_dwordx4 v[16:19], v12, s[4:7], s33 offen sc1
    s_add_u32 s33, s31, 40960
    buffer_store_dwordx4 v[16:19], v12, s[4:7], s33 offen sc1
    s_add_u32 s33, s31, 45056
    buffer_store_dwordx4 v[16:19], v12, s[4:7], s33 offen sc1
    s_add_u32 s33, s31, 49152
    buffer_store_dwordx4 v[16:19], v12, s[4:7], s33 offen sc1
    s_add_u32 s33, s31, 53248
    buffer_store_dwordx4 v[16:19], v12, s[4:7], s33 offen sc1
    s_add_u32 s33, s31, 57344
    buffer_store_dwordx4 v[16:19], v12, s[4:7], s33 offen sc1
    s_add_u32 s33, s31, 61440
    buffer_store_dwordx4 v[16:19], v12, s[4:7], s33 offen sc1
    s_add_u32 s33, s31, 65536
    buffer_store_dwordx4 v[16:19], v12, s[4:7], s33 offen sc1
    s_add_u32 s33, s31, 69632
    buffer_store_dwordx4 v[16:19], v12, s[4:7], s33 offen sc1
    s_add_u32 s33, s31, 73728
    buffer_store_dwordx4 v[16:19], v12, s[4:7], s33 offen sc1
    s_add_u32 s33, s31, 77824
    buffer_store_dwordx4 v[16:19], v12, s[4:7], s33 offen sc1
    s_add_u32 s33, s31, 81920
    buffer_store_dwordx4 v[16:19], v12, s[4:7], s33 offen sc1
    s_add_u32 s33, s31, 86016
    buffer_store_dwordx4 v[16:19], v12, s[4:7], s33 offen sc1
    s_add_u32 s33, s31, 90112
    buffer_store_dwordx4 v[16:19], v12, s[4:7], s33 offen sc1
    s_add_u32 s33, s31, 94208
    buffer_store_dwordx4 v[16:19], v12, s[4:7], s33 offen sc1
    s_add_u32 s33, s31, 98304
    buffer_store_dwordx4 v[16:19], v12, s[4:7], s33 offen sc1
    s_add_u32 s33, s31, 102400
    buffer_store_dwordx4 v[16:19], v12, s[4:7], s33 offen sc1
    s_add_u32 s33, s31, 106496
    buffer_store_dwordx4 v[16:19], v12, s[4:7], s33 offen sc1
    s_add_u32 s33, s31, 110592
    buffer_store_dwordx4 v[16:19], v12, s[4:7], s33 offen sc1
    s_cmp_eq_u32 s25, 14
    s_cselect_b32 s31, 1638400, 0
    s_add_u32 s46, s46, s31
    s_add_u32 s47, s47, s31
    s_cmp_eq_u32 s25, 14
    s_cbranch_scc1 MM0
    s_cmp_lg_u32 s25, 0
    s_cbranch_scc1 MSIG
MM0:
    s_waitcnt vmcnt(0)
    s_barrier
    s_mov_b32 s8, s72
    s_mov_b32 s9, s73
    s_mov_b32 s10, 10240
    s_mov_b32 s11, 0x00020000
    v_add_u32 v13, 0, v0
    v_lshrrev_b32 v13, 4, v13
    v_and_b32 v14, 15, v0
    v_and_b32 v14, 7, v14
    v_mul_u32_u24 v14, 1280, v14
    v_lshlrev_b32 v4, 5, v13
    v_add_u32 v14, v14, v4
    v_and_b32 v4, 15, v0
    v_lshrrev_b32 v4, 3, v4
    v_lshlrev_b32 v4, 2, v4
    v_add_u32 v14, v14, v4
    v_cmp_gt_u32 vcc, 40, v13
    s_and_saveexec_b64 s[34:35], vcc
    buffer_load_dword v20, v14, s[8:11], 0 offen offset:0
    buffer_load_dword v21, v14, s[8:11], 0 offen offset:8
    buffer_load_dword v22, v14, s[8:11], 0 offen offset:16
    buffer_load_dword v23, v14, s[8:11], 0 offen offset:24
    v_add_u32 v14, 0, v0
    v_lshlrev_b32 v14, 4, v14
    v_add_u32 v15, 0, v0
    v_lshlrev_b32 v15, 4, v15
    v_lshrrev_b32 v4, 5, v13
    v_lshlrev_b32 v4, 13, v4
    v_add_u32 v15, v15, v4
    s_waitcnt vmcnt(0)
    v_min_u32 v20, -2, v20
    v_min_u32 v21, -2, v21
    v_min_u32 v22, -2, v22
    v_min_u32 v23, -2, v23
    buffer_store_dwordx4 v[20:23], v15, s[4:7], s46 offen sc1
    buffer_store_dwordx4 v[20:23], v15, s[4:7], s47 offen sc1
    s_mov_b64 exec, -1
    v_add_u32 v13, 256, v0
    v_lshrrev_b32 v13, 4, v13
    v_and_b32 v14, 15, v0
    v_and_b32 v14, 7, v14
    v_mul_u32_u24 v14, 1280, v14
    v_lshlrev_b32 v4, 5, v13
    v_add_u32 v14, v14, v4
    v_and_b32 v4, 15, v0
    v_lshrrev_b32 v4, 3, v4
    v_lshlrev_b32 v4, 2, v4
    v_add_u32 v14, v14, v4
    v_cmp_gt_u32 vcc, 40, v13
    s_and_saveexec_b64 s[34:35], vcc
    buffer_load_dword v20, v14, s[8:11], 0 offen offset:0
    buffer_load_dword v21, v14, s[8:11], 0 offen offset:8
    buffer_load_dword v22, v14, s[8:11], 0 offen offset:16
    buffer_load_dword v23, v14, s[8:11], 0 offen offset:24
    v_add_u32 v14, 256, v0
    v_lshlrev_b32 v14, 4, v14
    v_add_u32 v15, 256, v0
    v_lshlrev_b32 v15, 4, v15
    v_lshrrev_b32 v4, 5, v13
    v_lshlrev_b32 v4, 13, v4
    v_add_u32 v15, v15, v4
    s_waitcnt vmcnt(0)
    v_min_u32 v20, -2, v20
    v_min_u32 v21, -2, v21
    v_min_u32 v22, -2, v22
    v_min_u32 v23, -2, v23
    buffer_store_dwordx4 v[20:23], v15, s[4:7], s46 offen sc1
    buffer_store_dwordx4 v[20:23], v15, s[4:7], s47 offen sc1
    s_mov_b64 exec, -1
    v_add_u32 v13, 512, v0
    v_lshrrev_b32 v13, 4, v13
    v_and_b32 v14, 15, v0
    v_and_b32 v14, 7, v14
    v_mul_u32_u24 v14, 1280, v14
    v_lshlrev_b32 v4, 5, v13
    v_add_u32 v14, v14, v4
    v_and_b32 v4, 15, v0
    v_lshrrev_b32 v4, 3, v4
    v_lshlrev_b32 v4, 2, v4
    v_add_u32 v14, v14, v4
    v_cmp_gt_u32 vcc, 40, v13
    s_and_saveexec_b64 s[34:35], vcc
    buffer_load_dword v20, v14, s[8:11], 0 offen offset:0
    buffer_load_dword v21, v14, s[8:11], 0 offen offset:8
    buffer_load_dword v22, v14, s[8:11], 0 offen offset:16
    buffer_load_dword v23, v14, s[8:11], 0 offen offset:24
    v_add_u32 v14, 512, v0
    v_lshlrev_b32 v14, 4, v14
    v_add_u32 v15, 512, v0
    v_lshlrev_b32 v15, 4, v15
    v_lshrrev_b32 v4, 5, v13
    v_lshlrev_b32 v4, 13, v4
    v_add_u32 v15, v15, v4
    s_waitcnt vmcnt(0)
    v_min_u32 v20, -2, v20
    v_min_u32 v21, -2, v21
    v_min_u32 v22, -2, v22
    v_min_u32 v23, -2, v23
    buffer_store_dwordx4 v[20:23], v15, s[4:7], s46 offen sc1
    buffer_store_dwordx4 v[20:23], v15, s[4:7], s47 offen sc1
    s_mov_b64 exec, -1
MSIG:
    s_waitcnt vmcnt(0)
    s_barrier
    s_cmp_lg_u32 s24, 0
    s_cbranch_scc1 NI_44
    v_mov_b32 v4, 0
    v_mov_b32 v5, 1
    s_mov_b64 exec, 1
    buffer_atomic_add v5, v4, s[20:23], 0 offen
    s_mov_b64 exec, -1
NI_44:
    s_branch R_AQ
POOL0:
    s_mov_b32 s31, 0
    v_min_u32 v4, 0, v1
    v_lshlrev_b32 v4, 2, v4
    s_mov_b32 s30, 50000
WF_45:
    buffer_load_dword v5, v4, s[20:23], s31 offen sc1
    s_waitcnt vmcnt(0)
    v_cmp_ne_u32 vcc, 16, v5
    s_cbranch_vccz WE_46
    s_sleep 2
    s_sub_u32 s30, s30, 1
    s_cmp_lg_u32 s30, 0
    s_cbranch_scc1 WF_45
    s_endpgm
WE_46:
POOL:
    s_waitcnt vmcnt(0) lgkmcnt(0)
    s_barrier
    s_cmp_lg_u32 s24, 0
    s_cbranch_scc1 PL1
    v_mov_b32 v4, 64
    v_mov_b32 v5, 1
    s_mov_b64 exec, 1
    buffer_atomic_add v5, v4, s[20:23], 0 offen sc0
    v_mov_b32 v4, 0
    s_waitcnt vmcnt(0)
    ds_write_b32 v4, v5
    s_mov_b64 exec, -1
    s_waitcnt lgkmcnt(0)
PL1:
    s_barrier
    v_mov_b32 v4, 0
    ds_read_b32 v5, v4
    s_waitcnt lgkmcnt(0)
    v_readfirstlane_b32 s25, v5
    s_cmp_lt_u32 s25, 24
    s_cbranch_scc1 T_ATTN
    s_sub_u32 s25, s25, 24
    s_cmp_ge_u32 s25, 522
    s_cbranch_scc1 PQ2
    s_mul_i32 s31, s25, 3641
    s_lshr_b32 s31, s31, 16
    s_mul_i32 s32, s31, 18
    s_sub_u32 s32, s25, s32
    s_cmp_ge_u32 s32, 8
    s_cbranch_scc1 PQ1
    s_mul_i32 s25, s31, 8
    s_add_u32 s25, s25, s32
    s_add_u32 s25, s25, 24
    s_branch T_ATTN
PQ1:
    s_mul_i32 s25, s31, 10
    s_add_u32 s25, s25, s32
    s_sub_u32 s25, s25, 8
    s_branch PQT
PQ2:
    s_sub_u32 s25, s25, 232
    s_cmp_lt_u32 s25, 380
    s_cbranch_scc1 PQT
    s_sub_u32 s25, s25, 380
    s_cmp_lt_u32 s25, 40
    s_cbranch_scc1 T_OP
    s_add_u32 s25, s25, 340
    s_cmp_ge_u32 s25, 630
    s_cbranch_scc1 T_H
PQT:
    s_mul_i32 s32, s25, 6554
    s_lshr_b32 s32, s32, 16
    s_mul_i32 s33, s32, 10
    s_sub_u32 s33, s25, s33
    s_lshl_b32 s33, s33, 2
    s_add_u32 s33, s33, s24
    s_lshl_b32 s34, s32, 7
    s_add_u32 s31, s34, 8192
    v_min_u32 v4, 31, v1
    v_lshlrev_b32 v4, 2, v4
    s_mov_b32 s30, 50000
WF_47:
    buffer_load_dword v5, v4, s[4:7], s31 offen sc1
    s_waitcnt vmcnt(0)
    v_cmp_ne_u32 vcc, 1, v5
    s_cbranch_vccz WE_48
    s_sleep 16
    s_sub_u32 s30, s30, 1
    s_cmp_lg_u32 s30, 0
    s_cbranch_scc1 WF_47
    s_endpgm
WE_48:
    s_barrier
    v_lshlrev_b32 v10, 4, v1
    s_mul_i32 s35, s32, 40
    s_add_u32 s35, s35, s33
    s_lshl_b32 s36, s35, 15
    s_add_u32 s36, s36, 92274688
    s_lshl_b32 s31, s34, 1
    s_lshl_b32 s37, s33, 2
    s_add_u32 s31, s31, s37
    s_add_u32 s31, s31, 24576
    s_add_u32 s37, s34, 40960
    v_lshlrev_b32 v12, 2, v1
    v_add_u32 v12, s37, v12
    v_mov_b32 v13, s31
    v_cmp_gt_u32 vcc, 32, v1
    s_nop 1
    v_cndmask_b32 v12, v13, v12, vcc
    buffer_load_dword v13, v12, s[4:7], 0 offen sc1
    buffer_load_dwordx4 a[0:3], v10, s[4:7], s36 offen offset:0 sc1
    buffer_load_dwordx4 a[4:7], v10, s[4:7], s36 offen offset:1024 sc1
    buffer_load_dwordx4 a[8:11], v10, s[4:7], s36 offen offset:2048 sc1
    buffer_load_dwordx4 a[12:15], v10, s[4:7], s36 offen offset:3072 sc1
    s_add_u32 s36, s36, 4096
    buffer_load_dwordx4 a[16:19], v10, s[4:7], s36 offen offset:0 sc1
    buffer_load_dwordx4 a[20:23], v10, s[4:7], s36 offen offset:1024 sc1
    buffer_load_dwordx4 a[24:27], v10, s[4:7], s36 offen offset:2048 sc1
    buffer_load_dwordx4 a[28:31], v10, s[4:7], s36 offen offset:3072 sc1
    s_add_u32 s36, s36, 4096
    buffer_load_dwordx4 a[32:35], v10, s[4:7], s36 offen offset:0 sc1
    buffer_load_dwordx4 a[36:39], v10, s[4:7], s36 offen offset:1024 sc1
    buffer_load_dwordx4 a[40:43], v10, s[4:7], s36 offen offset:2048 sc1
    buffer_load_dwordx4 a[44:47], v10, s[4:7], s36 offen offset:3072 sc1
    s_add_u32 s36, s36, 4096
    buffer_load_dwordx4 a[48:51], v10, s[4:7], s36 offen offset:0 sc1
    buffer_load_dwordx4 a[52:55], v10, s[4:7], s36 offen offset:1024 sc1
    buffer_load_dwordx4 a[56:59], v10, s[4:7], s36 offen offset:2048 sc1
    buffer_load_dwordx4 a[60:63], v10, s[4:7], s36 offen offset:3072 sc1
    s_add_u32 s36, s36, 4096
    buffer_load_dwordx4 a[64:67], v10, s[4:7], s36 offen offset:0 sc1
    buffer_load_dwordx4 a[68:71], v10, s[4:7], s36 offen offset:1024 sc1
    buffer_load_dwordx4 a[72:75], v10, s[4:7], s36 offen offset:2048 sc1
    buffer_load_dwordx4 a[76:79], v10, s[4:7], s36 offen offset:3072 sc1
    s_add_u32 s36, s36, 4096
    buffer_load_dwordx4 a[80:83], v10, s[4:7], s36 offen offset:0 sc1
    buffer_load_dwordx4 a[84:87], v10, s[4:7], s36 offen offset:1024 sc1
    buffer_load_dwordx4 a[88:91], v10, s[4:7], s36 offen offset:2048 sc1
    buffer_load_dwordx4 a[92:95], v10, s[4:7], s36 offen offset:3072 sc1
    s_add_u32 s36, s36, 4096
    buffer_load_dwordx4 a[96:99], v10, s[4:7], s36 offen offset:0 sc1
    buffer_load_dwordx4 a[100:103], v10, s[4:7], s36 offen offset:1024 sc1
    buffer_load_dwordx4 a[104:107], v10, s[4:7], s36 offen offset:2048 sc1
    buffer_load_dwordx4 a[108:111], v10, s[4:7], s36 offen offset:3072 sc1
    s_add_u32 s36, s36, 4096
    buffer_load_dwordx4 a[112:115], v10, s[4:7], s36 offen offset:0 sc1
    buffer_load_dwordx4 a[116:119], v10, s[4:7], s36 offen offset:1024 sc1
    buffer_load_dwordx4 a[120:123], v10, s[4:7], s36 offen offset:2048 sc1
    buffer_load_dwordx4 a[124:127], v10, s[4:7], s36 offen offset:3072 sc1
    s_add_u32 s36, s36, 4096
    s_waitcnt vmcnt(32)
    v_cmp_ne_u32 vcc, 1, v13
    s_cbranch_vccz TE_50
    s_mov_b32 s30, 50000
TW_49:
    buffer_load_dword v13, v12, s[4:7], 0 offen sc1
    s_waitcnt vmcnt(0)
    v_cmp_ne_u32 vcc, 1, v13
    s_cbranch_vccz TE_50
    s_sleep 64
    s_sub_u32 s30, s30, 1
    s_cmp_lg_u32 s30, 0
    s_cbranch_scc1 TW_49
    s_endpgm
TE_50:
    s_mul_i32 s38, s32, 81920
    s_mul_i32 s26, s24, 20480
    s_add_u32 s38, s38, s26
    s_add_u32 s38, s38, 46137344
    s_add_u32 m0, s26, 0
    s_add_u32 s27, s38, 0
    buffer_load_dwordx4 v10, s[4:7], s27 offen sc1 lds
    s_add_u32 m0, s26, 1024
    s_add_u32 s27, s38, 1024
    buffer_load_dwordx4 v10, s[4:7], s27 offen sc1 lds
    s_add_u32 m0, s26, 2048
    s_add_u32 s27, s38, 2048
    buffer_load_dwordx4 v10, s[4:7], s27 offen sc1 lds
    s_add_u32 m0, s26, 3072
    s_add_u32 s27, s38, 3072
    buffer_load_dwordx4 v10, s[4:7], s27 offen sc1 lds
    s_add_u32 m0, s26, 4096
    s_add_u32 s27, s38, 4096
    buffer_load_dwordx4 v10, s[4:7], s27 offen sc1 lds
    s_add_u32 m0, s26, 5120
    s_add_u32 s27, s38, 5120
    buffer_load_dwordx4 v10, s[4:7], s27 offen sc1 lds
    s_add_u32 m0, s26, 6144
    s_add_u32 s27, s38, 6144
    buffer_load_dwordx4 v10, s[4:7], s27 offen sc1 lds
    s_add_u32 m0, s26, 7168
    s_add_u32 s27, s38, 7168
    buffer_load_dwordx4 v10, s[4:7], s27 offen sc1 lds
    s_add_u32 m0, s26, 8192
    s_add_u32 s27, s38, 8192
    buffer_load_dwordx4 v10, s[4:7], s27 offen sc1 lds
    s_add_u32 m0, s26, 9216
    s_add_u32 s27, s38, 9216
    buffer_load_dwordx4 v10, s[4:7], s27 offen sc1 lds
    s_add_u32 m0, s26, 10240
    s_add_u32 s27, s38, 10240
    buffer_load_dwordx4 v10, s[4:7], s27 offen sc1 lds
    s_add_u32 m0, s26, 11264
    s_add_u32 s27, s38, 11264
    buffer_load_dwordx4 v10, s[4:7], s27 offen sc1 lds
    s_add_u32 m0, s26, 12288
    s_add_u32 s27, s38, 12288
    buffer_load_dwordx4 v10, s[4:7], s27 offen sc1 lds
    s_add_u32 m0, s26, 13312
    s_add_u32 s27, s38, 13312
    buffer_load_dwordx4 v10, s[4:7], s27 offen sc1 lds
    s_add_u32 m0, s26, 14336
    s_add_u32 s27, s38, 14336
    buffer_load_dwordx4 v10, s[4:7], s27 offen sc1 lds
    s_add_u32 m0, s26, 15360
    s_add_u32 s27, s38, 15360
    buffer_load_dwordx4 v10, s[4:7], s27 offen sc1 lds
    s_add_u32 m0, s26, 16384
    s_add_u32 s27, s38, 16384
    buffer_load_dwordx4 v10, s[4:7], s27 offen sc1 lds
    s_add_u32 m0, s26, 17408
    s_add_u32 s27, s38, 17408
    buffer_load_dwordx4 v10, s[4:7], s27 offen sc1 lds
    s_add_u32 m0, s26, 18432
    s_add_u32 s27, s38, 18432
    buffer_load_dwordx4 v10, s[4:7], s27 offen sc1 lds
    s_add_u32 m0, s26, 19456
    s_add_u32 s27, s38, 19456
    buffer_load_dwordx4 v10, s[4:7], s27 offen sc1 lds
    s_lshl_b32 s38, s35, 13
    s_add_u32 s38, s38, 69206016
    buffer_load_dwordx4 a[128:131], v10, s[4:7], s38 offen offset:0 sc1
    buffer_load_dwordx4 a[132:135], v10, s[4:7], s38 offen offset:1024 sc1
    buffer_load_dwordx4 a[136:139], v10, s[4:7], s38 offen offset:2048 sc1
    buffer_load_dwordx4 a[140:143], v10, s[4:7], s38 offen offset:3072 sc1
    s_add_u32 s38, s38, 4096
    buffer_load_dwordx4 a[144:147], v10, s[4:7], s38 offen offset:0 sc1
    buffer_load_dwordx4 a[148:151], v10, s[4:7], s38 offen offset:1024 sc1
    buffer_load_dwordx4 a[152:155], v10, s[4:7], s38 offen offset:2048 sc1
    buffer_load_dwordx4 a[156:159], v10, s[4:7], s38 offen offset:3072 sc1
    v_add_u32 v11, 0x10000, v10
    s_waitcnt vmcnt(0)
    s_barrier
    ds_read_b128 v[16:19], v10 offset:0
    ds_read_b128 v[20:23], v10 offset:1024
    ds_read_b128 v[24:27], v10 offset:2048
    ds_read_b128 v[28:31], v10 offset:3072
    ds_read_b128 v[32:35], v10 offset:4096
    ds_read_b128 v[36:39], v10 offset:5120
    ds_read_b128 v[40:43], v10 offset:6144
    ds_read_b128 v[44:47], v10 offset:7168
    s_waitcnt lgkmcnt(6)
    v_mfma_f32_16x16x32_bf16 v[48:51], a[0:3], v[16:19], 0
    v_mfma_f32_16x16x32_bf16 v[52:55], a[0:3], v[20:23], 0
    ds_read_b128 v[16:19], v10 offset:8192
    ds_read_b128 v[20:23], v10 offset:9216
    s_waitcnt lgkmcnt(6)
    v_mfma_f32_16x16x32_bf16 v[56:59], a[4:7], v[24:27], 0
    v_mfma_f32_16x16x32_bf16 v[60:63], a[4:7], v[28:31], 0
    ds_read_b128 v[24:27], v10 offset:10240
    ds_read_b128 v[28:31], v10 offset:11264
    s_waitcnt lgkmcnt(6)
    v_mfma_f32_16x16x32_bf16 v[48:51], a[8:11], v[32:35], v[48:51]
    v_mfma_f32_16x16x32_bf16 v[52:55], a[8:11], v[36:39], v[52:55]
    ds_read_b128 v[32:35], v10 offset:12288
    ds_read_b128 v[36:39], v10 offset:13312
    s_waitcnt lgkmcnt(6)
    v_mfma_f32_16x16x32_bf16 v[56:59], a[12:15], v[40:43], v[56:59]
    v_mfma_f32_16x16x32_bf16 v[60:63], a[12:15], v[44:47], v[60:63]
    ds_read_b128 v[40:43], v10 offset:14336
    ds_read_b128 v[44:47], v10 offset:15360
    s_waitcnt lgkmcnt(6)
    v_mfma_f32_16x16x32_bf16 v[48:51], a[16:19], v[16:19], v[48:51]
    v_mfma_f32_16x16x32_bf16 v[52:55], a[16:19], v[20:23], v[52:55]
    ds_read_b128 v[16:19], v10 offset:16384
    ds_read_b128 v[20:23], v10 offset:17408
    s_waitcnt lgkmcnt(6)
    v_mfma_f32_16x16x32_bf16 v[56:59], a[20:23], v[24:27], v[56:59]
    v_mfma_f32_16x16x32_bf16 v[60:63], a[20:23], v[28:31], v[60:63]
    ds_read_b128 v[24:27], v10 offset:18432
    ds_read_b128 v[28:31], v10 offset:19456
    s_waitcnt lgkmcnt(6)
    v_mfma_f32_16x16x32_bf16 v[48:51], a[24:27], v[32:35], v[48:51]
    v_mfma_f32_16x16x32_bf16 v[52:55], a[24:27], v[36:39], v[52:55]
    ds_read_b128 v[32:35], v10 offset:20480
    ds_read_b128 v[36:39], v10 offset:21504
    s_waitcnt lgkmcnt(6)
    v_mfma_f32_16x16x32_bf16 v[56:59], a[28:31], v[40:43], v[56:59]
    v_mfma_f32_16x16x32_bf16 v[60:63], a[28:31], v[44:47], v[60:63]
    ds_read_b128 v[40:43], v10 offset:22528
    ds_read_b128 v[44:47], v10 offset:23552
    s_waitcnt lgkmcnt(6)
    v_mfma_f32_16x16x32_bf16 v[48:51], a[32:35], v[16:19], v[48:51]
    v_mfma_f32_16x16x32_bf16 v[52:55], a[32:35], v[20:23], v[52:55]
    ds_read_b128 v[16:19], v10 offset:24576
    ds_read_b128 v[20:23], v10 offset:25600
    s_waitcnt lgkmcnt(6)
    v_mfma_f32_16x16x32_bf16 v[56:59], a[36:39], v[24:27], v[56:59]
    v_mfma_f32_16x16x32_bf16 v[60:63], a[36:39], v[28:31], v[60:63]
    ds_read_b128 v[24:27], v10 offset:26624
    ds_read_b128 v[28:31], v10 offset:27648
    s_waitcnt lgkmcnt(6)
    v_mfma_f32_16x16x32_bf16 v[48:51], a[40:43], v[32:35], v[48:51]
    v_mfma_f32_16x16x32_bf16 v[52:55], a[40:43], v[36:39], v[52:55]
    ds_read_b128 v[32:35], v10 offset:28672
    ds_read_b128 v[36:39], v10 offset:29696
    s_waitcnt lgkmcnt(6)
    v_mfma_f32_16x16x32_bf16 v[56:59], a[44:47], v[40:43], v[56:59]
    v_mfma_f32_16x16x32_bf16 v[60:63], a[44:47], v[44:47], v[60:63]
    ds_read_b128 v[40:43], v10 offset:30720
    ds_read_b128 v[44:47], v10 offset:31744
    s_waitcnt lgkmcnt(6)
    v_mfma_f32_16x16x32_bf16 v[48:51], a[48:51], v[16:19], v[48:51]
    v_mfma_f32_16x16x32_bf16 v[52:55], a[48:51], v[20:23], v[52:55]
    ds_read_b128 v[16:19], v10 offset:32768
    ds_read_b128 v[20:23], v10 offset:33792
    s_waitcnt lgkmcnt(6)
    v_mfma_f32_16x16x32_bf16 v[56:59], a[52:55], v[24:27], v[56:59]
    v_mfma_f32_16x16x32_bf16 v[60:63], a[52:55], v[28:31], v[60:63]
    ds_read_b128 v[24:27], v10 offset:34816
    ds_read_b128 v[28:31], v10 offset:35840
    s_waitcnt lgkmcnt(6)
    v_mfma_f32_16x16x32_bf16 v[48:51], a[56:59], v[32:35], v[48:51]
    v_mfma_f32_16x16x32_bf16 v[52:55], a[56:59], v[36:39], v[52:55]
    ds_read_b128 v[32:35], v10 offset:36864
    ds_read_b128 v[36:39], v10 offset:37888
    s_waitcnt lgkmcnt(6)
    v_mfma_f32_16x16x32_bf16 v[56:59], a[60:63], v[40:43], v[56:59]
    v_mfma_f32_16x16x32_bf16 v[60:63], a[60:63], v[44:47], v[60:63]
    ds_read_b128 v[40:43], v10 offset:38912
    ds_read_b128 v[44:47], v10 offset:39936
    s_waitcnt lgkmcnt(6)
    v_mfma_f32_16x16x32_bf16 v[48:51], a[64:67], v[16:19], v[48:51]
    v_mfma_f32_16x16x32_bf16 v[52:55], a[64:67], v[20:23], v[52:55]
    ds_read_b128 v[16:19], v10 offset:40960
    ds_read_b128 v[20:23], v10 offset:41984
    s_waitcnt lgkmcnt(6)
    v_mfma_f32_16x16x32_bf16 v[56:59], a[68:71], v[24:27], v[56:59]
    v_mfma_f32_16x16x32_bf16 v[60:63], a[68:71], v[28:31], v[60:63]
    ds_read_b128 v[24:27], v10 offset:43008
    ds_read_b128 v[28:31], v10 offset:44032
    s_waitcnt lgkmcnt(6)
    v_mfma_f32_16x16x32_bf16 v[48:51], a[72:75], v[32:35], v[48:51]
    v_mfma_f32_16x16x32_bf16 v[52:55], a[72:75], v[36:39], v[52:55]
    ds_read_b128 v[32:35], v10 offset:45056
    ds_read_b128 v[36:39], v10 offset:46080
    s_waitcnt lgkmcnt(6)
    v_mfma_f32_16x16x32_bf16 v[56:59], a[76:79], v[40:43], v[56:59]
    v_mfma_f32_16x16x32_bf16 v[60:63], a[76:79], v[44:47], v[60:63]
    ds_read_b128 v[40:43], v10 offset:47104
    ds_read_b128 v[44:47], v10 offset:48128
    s_waitcnt lgkmcnt(6)
    v_mfma_f32_16x16x32_bf16 v[48:51], a[80:83], v[16:19], v[48:51]
    v_mfma_f32_16x16x32_bf16 v[52:55], a[80:83], v[20:23], v[52:55]
    ds_read_b128 v[16:19], v10 offset:49152
    ds_read_b128 v[20:23], v10 offset:50176
    s_waitcnt lgkmcnt(6)
    v_mfma_f32_16x16x32_bf16 v[56:59], a[84:87], v[24:27], v[56:59]
    v_mfma_f32_16x16x32_bf16 v[60:63], a[84:87], v[28:31], v[60:63]
    ds_read_b128 v[24:27], v10 offset:51200
    ds_read_b128 v[28:31], v10 offset:52224
    s_waitcnt lgkmcnt(6)
    v_mfma_f32_16x16x32_bf16 v[48:51], a[88:91], v[32:35], v[48:51]
    v_mfma_f32_16x16x32_bf16 v[52:55], a[88:91], v[36:39], v[52:55]
    ds_read_b128 v[32:35], v10 offset:53248
    ds_read_b128 v[36:39], v10 offset:54272
    s_waitcnt lgkmcnt(6)
    v_mfma_f32_16x16x32_bf16 v[56:59], a[92:95], v[40:43], v[56:59]
    v_mfma_f32_16x16x32_bf16 v[60:63], a[92:95], v[44:47], v[60:63]
    ds_read_b128 v[40:43], v10 offset:55296
    ds_read_b128 v[44:47], v10 offset:56320
    s_waitcnt lgkmcnt(6)
    v_mfma_f32_16x16x32_bf16 v[48:51], a[96:99], v[16:19], v[48:51]
    v_mfma_f32_16x16x32_bf16 v[52:55], a[96:99], v[20:23], v[52:55]
    ds_read_b128 v[16:19], v10 offset:57344
    ds_read_b128 v[20:23], v10 offset:58368
    s_waitcnt lgkmcnt(6)
    v_mfma_f32_16x16x32_bf16 v[56:59], a[100:103], v[24:27], v[56:59]
    v_mfma_f32_16x16x32_bf16 v[60:63], a[100:103], v[28:31], v[60:63]
    ds_read_b128 v[24:27], v10 offset:59392
    ds_read_b128 v[28:31], v10 offset:60416
    s_waitcnt lgkmcnt(6)
    v_mfma_f32_16x16x32_bf16 v[48:51], a[104:107], v[32:35], v[48:51]
    v_mfma_f32_16x16x32_bf16 v[52:55], a[104:107], v[36:39], v[52:55]
    ds_read_b128 v[32:35], v10 offset:61440
    ds_read_b128 v[36:39], v10 offset:62464
    s_waitcnt lgkmcnt(6)
    v_mfma_f32_16x16x32_bf16 v[56:59], a[108:111], v[40:43], v[56:59]
    v_mfma_f32_16x16x32_bf16 v[60:63], a[108:111], v[44:47], v[60:63]
    ds_read_b128 v[40:43], v10 offset:63488
    ds_read_b128 v[44:47], v10 offset:64512
    s_waitcnt lgkmcnt(6)
    v_mfma_f32_16x16x32_bf16 v[48:51], a[112:115], v[16:19], v[48:51]
    v_mfma_f32_16x16x32_bf16 v[52:55], a[112:115], v[20:23], v[52:55]
    ds_read_b128 v[16:19], v11 offset:0
    ds_read_b128 v[20:23], v11 offset:1024
    s_waitcnt lgkmcnt(6)
    v_mfma_f32_16x16x32_bf16 v[56:59], a[116:119], v[24:27], v[56:59]
    v_mfma_f32_16x16x32_bf16 v[60:63], a[116:119], v[28:31], v[60:63]
    ds_read_b128 v[24:27], v11 offset:2048
    ds_read_b128 v[28:31], v11 offset:3072
    s_waitcnt lgkmcnt(6)
    v_mfma_f32_16x16x32_bf16 v[48:51], a[120:123], v[32:35], v[48:51]
    v_mfma_f32_16x16x32_bf16 v[52:55], a[120:123], v[36:39], v[52:55]
    ds_read_b128 v[32:35], v11 offset:4096
    ds_read_b128 v[36:39], v11 offset:5120
    s_waitcnt lgkmcnt(6)
    v_mfma_f32_16x16x32_bf16 v[56:59], a[124:127], v[40:43], v[56:59]
    v_mfma_f32_16x16x32_bf16 v[60:63], a[124:127], v[44:47], v[60:63]
    ds_read_b128 v[40:43], v11 offset:6144
    ds_read_b128 v[44:47], v11 offset:7168
    s_waitcnt lgkmcnt(6)
    v_mfma_f32_16x16x32_bf16 v[48:51], a[128:131], v[16:19], v[48:51]
    v_mfma_f32_16x16x32_bf16 v[52:55], a[128:131], v[20:23], v[52:55]
    ds_read_b128 v[16:19], v11 offset:8192
    ds_read_b128 v[20:23], v11 offset:9216
    s_waitcnt lgkmcnt(6)
    v_mfma_f32_16x16x32_bf16 v[56:59], a[132:135], v[24:27], v[56:59]
    v_mfma_f32_16x16x32_bf16 v[60:63], a[132:135], v[28:31], v[60:63]
    ds_read_b128 v[24:27], v11 offset:10240
    ds_read_b128 v[28:31], v11 offset:11264
    s_waitcnt lgkmcnt(6)
    v_mfma_f32_16x16x32_bf16 v[48:51], a[136:139], v[32:35], v[48:51]
    v_mfma_f32_16x16x32_bf16 v[52:55], a[136:139], v[36:39], v[52:55]
    ds_read_b128 v[32:35], v11 offset:12288
    ds_read_b128 v[36:39], v11 offset:13312
    s_waitcnt lgkmcnt(6)
    v_mfma_f32_16x16x32_bf16 v[56:59], a[140:143], v[40:43], v[56:59]
    v_mfma_f32_16x16x32_bf16 v[60:63], a[140:143], v[44:47], v[60:63]
    ds_read_b128 v[40:43], v11 offset:14336
    ds_read_b128 v[44:47], v11 offset:15360
    s_waitcnt lgkmcnt(6)
    v_mfma_f32_16x16x32_bf16 v[48:51], a[144:147], v[16:19], v[48:51]
    v_mfma_f32_16x16x32_bf16 v[52:55], a[144:147], v[20:23], v[52:55]
    s_waitcnt lgkmcnt(4)
    v_mfma_f32_16x16x32_bf16 v[56:59], a[148:151], v[24:27], v[56:59]
    v_mfma_f32_16x16x32_bf16 v[60:63], a[148:151], v[28:31], v[60:63]
    s_waitcnt lgkmcnt(2)
    v_mfma_f32_16x16x32_bf16 v[48:51], a[152:155], v[32:35], v[48:51]
    v_mfma_f32_16x16x32_bf16 v[52:55], a[152:155], v[36:39], v[52:55]
    s_waitcnt lgkmcnt(0)
    v_mfma_f32_16x16x32_bf16 v[56:59], a[156:159], v[40:43], v[56:59]
    v_mfma_f32_16x16x32_bf16 v[60:63], a[156:159], v[44:47], v[60:63]
    s_nop 6
    v_add_f32 v48, v48, v56
    v_add_f32 v49, v49, v57
    v_add_f32 v50, v50, v58
    v_add_f32 v51, v51, v59
    v_add_f32 v52, v52, v60
    v_add_f32 v53, v53, v61
    v_add_f32 v54, v54, v62
    v_add_f32 v55, v55, v63
    v_cvt_pk_bf16_f32 v16, v48, v49
    v_cvt_pk_bf16_f32 v17, v50, v51
    v_cvt_pk_bf16_f32 v18, v52, v53
    v_cvt_pk_bf16_f32 v19, v54, v55
    s_nop 0
    v_permlane16_swap_b32 v16, v18
    v_permlane16_swap_b32 v17, v19
    v_and_b32 v12, 1, v3
    v_lshlrev_b32 v12, 4, v12
    v_add_u32 v12, v2, v12
    v_mul_u32_u24 v12, 144, v12
    v_lshrrev_b32 v4, 1, v3
    v_lshlrev_b32 v4, 4, v4
    v_add_u32 v12, v12, v4
    v_mov_b32 v4, s24
    v_lshlrev_b32 v4, 5, v4
    v_add_u32 v12, v12, v4
    v_add_u32 v12, 81920, v12
    ds_write_b128 v12, v[16:19]
    v_lshrrev_b32 v13, 3, v1
    v_mov_b32 v4, s24
    v_lshlrev_b32 v4, 3, v4
    v_add_u32 v13, v13, v4
    v_mul_u32_u24 v13, 144, v13
    v_and_b32 v4, 7, v1
    v_lshlrev_b32 v4, 4, v4
    v_add_u32 v13, v13, v4
    v_add_u32 v13, 81920, v13
    v_lshrrev_b32 v12, 3, v1
    v_mov_b32 v4, s24
    v_lshlrev_b32 v4, 3, v4
    v_add_u32 v12, v12, v4
    v_mul_u32_u24 v12, 2560, v12
    v_and_b32 v4, 7, v1
    v_lshlrev_b32 v4, 4, v4
    v_add_u32 v12, v12, v4
    s_mul_i32 s36, s32, 81920
    s_lshr_b32 s37, s33, 2
    s_lshl_b32 s37, s37, 7
    s_add_u32 s36, s36, s37
    s_add_u32 s36, s36, 1280
    s_waitcnt lgkmcnt(0)
    s_barrier
    ds_read_b128 v[16:19], v13
    s_waitcnt lgkmcnt(0)
    buffer_store_dwordx4 v[16:19], v12, s[16:19], s36 offen
    s_branch POOL
T_ATTN:
    s_and_b32 s32, s25, 31
    s_lshr_b32 s33, s25, 5
    s_mov_b32 s31, 49152
    v_min_u32 v4, 23, v1
    v_lshlrev_b32 v4, 2, v4
    s_mov_b32 s30, 50000
WF_51:
    buffer_load_dword v5, v4, s[4:7], s31 offen sc1
    s_waitcnt vmcnt(0)
    v_cmp_ne_u32 vcc, 1, v5
    s_cbranch_vccz WE_52
    s_sleep 16
    s_sub_u32 s30, s30, 1
    s_cmp_lg_u32 s30, 0
    s_cbranch_scc1 WF_51
    s_endpgm
WE_52:
    s_barrier
    v_lshlrev_b32 v10, 4, v1
    v_and_b32 v11, 31, v1
    v_lshlrev_b32 v11, 4, v11
    v_add_u32 v11, 1024, v11
    s_mul_i32 s34, s32, 98304
    s_mul_i32 s26, s24, 24576
    s_add_u32 s34, s34, s26
    s_add_u32 s34, s34, 56623104
    s_add_u32 m0, s26, 0
    s_add_u32 s27, s34, 0
    buffer_load_dwordx4 v10, s[4:7], s27 offen sc1 lds
    s_add_u32 m0, s26, 1024
    s_add_u32 s27, s34, 1024
    buffer_load_dwordx4 v10, s[4:7], s27 offen sc1 lds
    s_add_u32 m0, s26, 2048
    s_add_u32 s27, s34, 2048
    buffer_load_dwordx4 v10, s[4:7], s27 offen sc1 lds
    s_add_u32 m0, s26, 3072
    s_add_u32 s27, s34, 3072
    buffer_load_dwordx4 v10, s[4:7], s27 offen sc1 lds
    s_add_u32 m0, s26, 4096
    s_add_u32 s27, s34, 4096
    buffer_load_dwordx4 v10, s[4:7], s27 offen sc1 lds
    s_add_u32 m0, s26, 5120
    s_add_u32 s27, s34, 5120
    buffer_load_dwordx4 v10, s[4:7], s27 offen sc1 lds
    s_add_u32 m0, s26, 6144
    s_add_u32 s27, s34, 6144
    buffer_load_dwordx4 v10, s[4:7], s27 offen sc1 lds
    s_add_u32 m0, s26, 7168
    s_add_u32 s27, s34, 7168
    buffer_load_dwordx4 v10, s[4:7], s27 offen sc1 lds
    s_add_u32 m0, s26, 8192
    s_add_u32 s27, s34, 8192
    buffer_load_dwordx4 v10, s[4:7], s27 offen sc1 lds
    s_add_u32 m0, s26, 9216
    s_add_u32 s27, s34, 9216
    buffer_load_dwordx4 v10, s[4:7], s27 offen sc1 lds
    s_add_u32 m0, s26, 10240
    s_add_u32 s27, s34, 10240
    buffer_load_dwordx4 v10, s[4:7], s27 offen sc1 lds
    s_add_u32 m0, s26, 11264
    s_add_u32 s27, s34, 11264
    buffer_load_dwordx4 v10, s[4:7], s27 offen sc1 lds
    s_add_u32 m0, s26, 12288
    s_add_u32 s27, s34, 12288
    buffer_load_dwordx4 v10, s[4:7], s27 offen sc1 lds
    s_add_u32 m0, s26, 13312
    s_add_u32 s27, s34, 13312
    buffer_load_dwordx4 v10, s[4:7], s27 offen sc1 lds
    s_add_u32 m0, s26, 14336
    s_add_u32 s27, s34, 14336
    buffer_load_dwordx4 v10, s[4:7], s27 offen sc1 lds
    s_add_u32 m0, s26, 15360
    s_add_u32 s27, s34, 15360
    buffer_load_dwordx4 v10, s[4:7], s27 offen sc1 lds
    s_add_u32 m0, s26, 16384
    s_add_u32 s27, s34, 16384
    buffer_load_dwordx4 v10, s[4:7], s27 offen sc1 lds
    s_add_u32 m0, s26, 17408
    s_add_u32 s27, s34, 17408
    buffer_load_dwordx4 v10, s[4:7], s27 offen sc1 lds
    s_add_u32 m0, s26, 18432
    s_add_u32 s27, s34, 18432
    buffer_load_dwordx4 v10, s[4:7], s27 offen sc1 lds
    s_add_u32 m0, s26, 19456
    s_add_u32 s27, s34, 19456
    buffer_load_dwordx4 v10, s[4:7], s27 offen sc1 lds
    s_add_u32 m0, s26, 20480
    s_add_u32 s27, s34, 20480
    buffer_load_dwordx4 v10, s[4:7], s27 offen sc1 lds
    s_add_u32 m0, s26, 21504
    s_add_u32 s27, s34, 21504
    buffer_load_dwordx4 v10, s[4:7], s27 offen sc1 lds
    s_add_u32 m0, s26, 22528
    s_add_u32 s27, s34, 22528
    buffer_load_dwordx4 v10, s[4:7], s27 offen sc1 lds
    s_add_u32 m0, s26, 23552
    s_add_u32 s27, s34, 23552
    buffer_load_dwordx4 v10, s[4:7], s27 offen sc1 lds
    s_mul_i32 s34, s32, 98304
    s_lshl_b32 s35, s33, 3
    s_lshl_b32 s36, s24, 1
    s_add_u32 s35, s35, s36
    s_mul_i32 s36, s35, 1536
    s_add_u32 s34, s34, s36
    s_add_u32 s34, s34, 52428800
    buffer_load_dwordx4 v[16:19], v10, s[4:7], s34 offen offset:0 sc1
    buffer_load_dwordx4 v[20:23], v11, s[4:7], s34 offen offset:0 sc1
    buffer_load_dwordx4 v[24:27], v10, s[4:7], s34 offen offset:1536 sc1
    buffer_load_dwordx4 v[28:31], v11, s[4:7], s34 offen offset:1536 sc1
    s_lshl_b32 s37, s32, 17
    s_lshl_b32 s38, s24, 13
    s_add_u32 s37, s37, s38
    s_add_u32 s37, s37, 60817408
    s_add_u32 s38, s38, 98304
    s_add_u32 m0, s38, 0
    s_add_u32 s27, s37, 0
    buffer_load_dwordx4 v10, s[4:7], s27 offen sc1 lds
    s_add_u32 m0, s38, 1024
    s_add_u32 s27, s37, 1024
    buffer_load_dwordx4 v10, s[4:7], s27 offen sc1 lds
    s_add_u32 m0, s38, 2048
    s_add_u32 s27, s37, 2048
    buffer_load_dwordx4 v10, s[4:7], s27 offen sc1 lds
    s_add_u32 m0, s38, 3072
    s_add_u32 s27, s37, 3072
    buffer_load_dwordx4 v10, s[4:7], s27 offen sc1 lds
    s_add_u32 m0, s38, 4096
    s_add_u32 s27, s37, 4096
    buffer_load_dwordx4 v10, s[4:7], s27 offen sc1 lds
    s_add_u32 m0, s38, 5120
    s_add_u32 s27, s37, 5120
    buffer_load_dwordx4 v10, s[4:7], s27 offen sc1 lds
    s_add_u32 m0, s38, 6144
    s_add_u32 s27, s37, 6144
    buffer_load_dwordx4 v10, s[4:7], s27 offen sc1 lds
    s_add_u32 m0, s38, 7168
    s_add_u32 s27, s37, 7168
    buffer_load_dwordx4 v10, s[4:7], s27 offen sc1 lds
    s_add_u32 s37, s37, 32768
    s_xor_b32 s38, s38, 229376
    s_add_u32 m0, s38, 0
    s_add_u32 s27, s37, 0
    buffer_load_dwordx4 v10, s[4:7], s27 offen sc1 lds
    s_add_u32 m0, s38, 1024
    s_add_u32 s27, s37, 1024
    buffer_load_dwordx4 v10, s[4:7], s27 offen sc1 lds
    s_add_u32 m0, s38, 2048
    s_add_u32 s27, s37, 2048
    buffer_load_dwordx4 v10, s[4:7], s27 offen sc1 lds
    s_add_u32 m0, s38, 3072
    s_add_u32 s27, s37, 3072
    buffer_load_dwordx4 v10, s[4:7], s27 offen sc1 lds
    s_add_u32 m0, s38, 4096
    s_add_u32 s27, s37, 4096
    buffer_load_dwordx4 v10, s[4:7], s27 offen sc1 lds
    s_add_u32 m0, s38, 5120
    s_add_u32 s27, s37, 5120
    buffer_load_dwordx4 v10, s[4:7], s27 offen sc1 lds
    s_add_u32 m0, s38, 6144
    s_add_u32 s27, s37, 6144
    buffer_load_dwordx4 v10, s[4:7], s27 offen sc1 lds
    s_add_u32 m0, s38, 7168
    s_add_u32 s27, s37, 7168
    buffer_load_dwordx4 v10, s[4:7], s27 offen sc1 lds
    s_add_u32 s37, s37, 32768
    s_xor_b32 s38, s38, 229376
    s_waitcnt vmcnt(16)
    s_mov_b32 exec_lo, 0
    v_mov_b32 v20, 0
    v_mov_b32 v21, 0
    v_mov_b32 v22, 0
    v_mov_b32 v23, 0
    v_mov_b32 v28, 0
    v_mov_b32 v29, 0
    v_mov_b32 v30, 0
    v_mov_b32 v31, 0
    s_mov_b32 exec_lo, -1
    s_barrier
    v_mov_b32 v12, v10
    v_mov_b32 v13, v11
    v_mov_b32 v14, 0xff800000
    v_mov_b32 v15, 0xff800000
    ds_read_b128 v[32:35], v12 offset:0
    ds_read_b128 v[36:39], v13 offset:0
    ds_read_b128 v[40:43], v12 offset:1536
    ds_read_b128 v[44:47], v13 offset:1536
    s_waitcnt lgkmcnt(2)
    v_mfma_f32_32x32x16_bf16 v[48:63], v[32:35], v[16:19], 0
    v_mfma_f32_32x32x16_bf16 v[48:63], v[36:39], v[20:23], v[48:63]
    v_mfma_f32_32x32x16_bf16 v[64:79], v[32:35], v[24:27], 0
    v_mfma_f32_32x32x16_bf16 v[64:79], v[36:39], v[28:31], v[64:79]
    s_mov_b32 s35, 0
P1_53:
    ds_read_b128 v[32:35], v12 offset:3072
    ds_read_b128 v[36:39], v13 offset:3072
    s_waitcnt lgkmcnt(2)
    v_mfma_f32_32x32x16_bf16 v[96:111], v[40:43], v[16:19], 0
    v_mfma_f32_32x32x16_bf16 v[96:111], v[44:47], v[20:23], v[96:111]
    s_nop 3
    v_max3_f32 v14, v14, v48, v49
    v_max3_f32 v14, v14, v50, v51
    v_max3_f32 v14, v14, v52, v53
    v_max3_f32 v14, v14, v54, v55
    v_mfma_f32_32x32x16_bf16 v[112:127], v[40:43], v[24:27], 0
    v_max3_f32 v14, v14, v56, v57
    v_max3_f32 v14, v14, v58, v59
    v_max3_f32 v14, v14, v60, v61
    v_max3_f32 v14, v14, v62, v63
    v_max3_f32 v15, v15, v64, v65
    v_max3_f32 v15, v15, v66, v67
    v_max3_f32 v15, v15, v68, v69
    v_max3_f32 v15, v15, v70, v71
    v_mfma_f32_32x32x16_bf16 v[112:127], v[44:47], v[28:31], v[112:127]
    v_max3_f32 v15, v15, v72, v73
    v_max3_f32 v15, v15, v74, v75
    v_max3_f32 v15, v15, v76, v77
    v_max3_f32 v15, v15, v78, v79
    ds_read_b128 v[40:43], v12 offset:4608
    ds_read_b128 v[44:47], v13 offset:4608
    s_waitcnt lgkmcnt(2)
    v_mfma_f32_32x32x16_bf16 v[48:63], v[32:35], v[16:19], 0
    v_mfma_f32_32x32x16_bf16 v[48:63], v[36:39], v[20:23], v[48:63]
    v_max3_f32 v14, v14, v96, v97
    v_max3_f32 v14, v14, v98, v99
    v_max3_f32 v14, v14, v100, v101
    v_max3_f32 v14, v14, v102, v103
    v_mfma_f32_32x32x16_bf16 v[64:79], v[32:35], v[24:27], 0
    v_max3_f32 v14, v14, v104, v105
    v_max3_f32 v14, v14, v106, v107
    v_max3_f32 v14, v14, v108, v109
    v_max3_f32 v14, v14, v110, v111
    v_max3_f32 v15, v15, v112, v113
    v_max3_f32 v15, v15, v114, v115
    v_max3_f32 v15, v15, v116, v117
    v_max3_f32 v15, v15, v118, v119
    v_mfma_f32_32x32x16_bf16 v[64:79], v[36:39], v[28:31], v[64:79]
    v_max3_f32 v15, v15, v120, v121
    v_max3_f32 v15, v15, v122, v123
    v_max3_f32 v15, v15, v124, v125
    v_max3_f32 v15, v15, v126, v127
    v_add_u32 v12, 3072, v12
    v_add_u32 v13, 3072, v13
    s_add_u32 s35, s35, 1
    s_cmp_lt_u32 s35, 32
    s_cbranch_scc1 P1_53
    s_waitcnt lgkmcnt(0)
    v_mov_b32 v4, v14
    s_nop 1
    v_permlane32_swap_b32 v4, v14
    v_max_f32 v4, v4, v14
    v_sub_f32 v4, 0, v4
    v_mov_b32 v128, v4
    v_mov_b32 v129, v4
    v_mov_b32 v130, v4
    v_mov_b32 v131, v4
    v_mov_b32 v132, v4
    v_mov_b32 v133, v4
    v_mov_b32 v134, v4
    v_mov_b32 v135, v4
    v_mov_b32 v136, v4
    v_mov_b32 v137, v4
    v_mov_b32 v138, v4
    v_mov_b32 v139, v4
    v_mov_b32 v140, v4
    v_mov_b32 v141, v4
    v_mov_b32 v142, v4
    v_mov_b32 v143, v4
    v_mov_b32 v96, 0
    v_mov_b32 v97, 0
    v_mov_b32 v98, 0
    v_mov_b32 v99, 0
    v_mov_b32 v100, 0
    v_mov_b32 v101, 0
    v_mov_b32 v102, 0
    v_mov_b32 v103, 0
    v_mov_b32 v104, 0
    v_mov_b32 v105, 0
    v_mov_b32 v106, 0
    v_mov_b32 v107, 0
    v_mov_b32 v108, 0
    v_mov_b32 v109, 0
    v_mov_b32 v110, 0
    v_mov_b32 v111, 0
    v_mov_b32 v4, v15
    s_nop 1
    v_permlane32_swap_b32 v4, v15
    v_max_f32 v4, v4, v15
    v_sub_f32 v4, 0, v4
    v_mov_b32 v144, v4
    v_mov_b32 v145, v4
    v_mov_b32 v146, v4
    v_mov_b32 v147, v4
    v_mov_b32 v148, v4
    v_mov_b32 v149, v4
    v_mov_b32 v150, v4
    v_mov_b32 v151, v4
    v_mov_b32 v152, v4
    v_mov_b32 v153, v4
    v_mov_b32 v154, v4
    v_mov_b32 v155, v4
    v_mov_b32 v156, v4
    v_mov_b32 v157, v4
    v_mov_b32 v158, v4
    v_mov_b32 v159, v4
    v_mov_b32 v112, 0
    v_mov_b32 v113, 0
    v_mov_b32 v114, 0
    v_mov_b32 v115, 0
    v_mov_b32 v116, 0
    v_mov_b32 v117, 0
    v_mov_b32 v118, 0
    v_mov_b32 v119, 0
    v_mov_b32 v120, 0
    v_mov_b32 v121, 0
    v_mov_b32 v122, 0
    v_mov_b32 v123, 0
    v_mov_b32 v124, 0
    v_mov_b32 v125, 0
    v_mov_b32 v126, 0
    v_mov_b32 v127, 0
    v_mov_b32 v88, 0
    v_mov_b32 v89, 0
    v_mov_b32 v90, 0
    v_mov_b32 v91, 0
    v_mov_b32 v92, 0
    v_mov_b32 v93, 0
    v_mov_b32 v94, 0
    v_mov_b32 v95, 0
    v_mov_b32 v12, v10
    v_mov_b32 v13, v11
    v_add_u32 v14, 98304, v10
    s_waitcnt vmcnt(0)
    s_barrier
    ds_read_b128 v[32:35], v12 offset:0
    ds_read_b128 v[36:39], v13 offset:0
    ds_read_b128 v[40:43], v14 offset:0
    ds_read_b128 v[44:47], v14 offset:1024
    s_waitcnt lgkmcnt(0)
    v_mfma_f32_32x32x16_bf16 v[48:63], v[32:35], v[16:19], v[128:143]
    v_mfma_f32_32x32x16_bf16 v[48:63], v[36:39], v[20:23], v[48:63]
    s_mov_b32 s35, 0
    s_mov_b32 s36, 0
P2_54:
    v_mfma_f32_32x32x16_bf16 v[64:79], v[32:35], v[24:27], v[144:159]
    s_nop 8
    v_exp_f32 v48, v48
    v_exp_f32 v49, v49
    v_exp_f32 v50, v50
    v_mfma_f32_32x32x16_bf16 v[64:79], v[36:39], v[28:31], v[64:79]
    v_exp_f32 v51, v51
    v_cvt_pk_bf16_f32 v80, v48, v49
    v_exp_f32 v52, v52
    ds_read_b128 v[32:35], v12 offset:1536
    ds_read_b128 v[36:39], v13 offset:1536
    v_exp_f32 v53, v53
    v_cvt_pk_bf16_f32 v81, v50, v51
    v_exp_f32 v54, v54
    v_mfma_f32_32x32x16_bf16 v[112:127], v[40:43], v[88:91], v[112:127]
    v_exp_f32 v55, v55
    v_cvt_pk_bf16_f32 v82, v52, v53
    v_exp_f32 v56, v56
    v_exp_f32 v57, v57
    v_cvt_pk_bf16_f32 v83, v54, v55
    v_mfma_f32_32x32x16_bf16 v[112:127], v[44:47], v[92:95], v[112:127]
    v_exp_f32 v58, v58
    v_exp_f32 v59, v59
    v_cvt_pk_bf16_f32 v84, v56, v57
    v_exp_f32 v60, v60
    s_and_b32 s39, s35, 3
    s_cmp_lg_u32 s39, 0
    s_cbranch_scc1 NS_55
    s_cmp_eq_u32 s35, 0
    s_cbranch_scc1 NS_55
    s_waitcnt vmcnt(0)
    s_barrier
    s_cmp_ge_u32 s35, 12
    s_cbranch_scc1 NS_55
    s_add_u32 m0, s38, 0
    s_add_u32 s27, s37, 0
    buffer_load_dwordx4 v10, s[4:7], s27 offen sc1 lds
    s_add_u32 m0, s38, 1024
    s_add_u32 s27, s37, 1024
    buffer_load_dwordx4 v10, s[4:7], s27 offen sc1 lds
    s_add_u32 m0, s38, 2048
    s_add_u32 s27, s37, 2048
    buffer_load_dwordx4 v10, s[4:7], s27 offen sc1 lds
    s_add_u32 m0, s38, 3072
    s_add_u32 s27, s37, 3072
    buffer_load_dwordx4 v10, s[4:7], s27 offen sc1 lds
    s_add_u32 m0, s38, 4096
    s_add_u32 s27, s37, 4096
    buffer_load_dwordx4 v10, s[4:7], s27 offen sc1 lds
    s_add_u32 m0, s38, 5120
    s_add_u32 s27, s37, 5120
    buffer_load_dwordx4 v10, s[4:7], s27 offen sc1 lds
    s_add_u32 m0, s38, 6144
    s_add_u32 s27, s37, 6144
    buffer_load_dwordx4 v10, s[4:7], s27 offen sc1 lds
    s_add_u32 m0, s38, 7168
    s_add_u32 s27, s37, 7168
    buffer_load_dwordx4 v10, s[4:7], s27 offen sc1 lds
    s_add_u32 s37, s37, 32768
    s_xor_b32 s38, s38, 229376
NS_55:
    ds_read_b128 v[40:43], v14 offset:0
    ds_read_b128 v[44:47], v14 offset:1024
    v_exp_f32 v61, v61
    v_cvt_pk_bf16_f32 v85, v58, v59
    v_exp_f32 v62, v62
    v_exp_f32 v63, v63
    v_cvt_pk_bf16_f32 v86, v60, v61
    v_cvt_pk_bf16_f32 v87, v62, v63
    s_waitcnt lgkmcnt(2)
    v_mfma_f32_32x32x16_bf16 v[48:63], v[32:35], v[16:19], v[128:143]
    v_exp_f32 v64, v64
    v_exp_f32 v65, v65
    v_exp_f32 v66, v66
    v_mfma_f32_32x32x16_bf16 v[48:63], v[36:39], v[20:23], v[48:63]
    v_exp_f32 v67, v67
    v_cvt_pk_bf16_f32 v88, v64, v65
    v_exp_f32 v68, v68
    v_exp_f32 v69, v69
    v_cvt_pk_bf16_f32 v89, v66, v67
    v_exp_f32 v70, v70
    s_waitcnt lgkmcnt(0)
    v_mfma_f32_32x32x16_bf16 v[96:111], v[40:43], v[80:83], v[96:111]
    v_exp_f32 v71, v71
    v_cvt_pk_bf16_f32 v90, v68, v69
    v_exp_f32 v72, v72
    v_exp_f32 v73, v73
    v_cvt_pk_bf16_f32 v91, v70, v71
    v_mfma_f32_32x32x16_bf16 v[96:111], v[44:47], v[84:87], v[96:111]
    v_exp_f32 v74, v74
    v_exp_f32 v75, v75
    v_cvt_pk_bf16_f32 v92, v72, v73
    v_exp_f32 v76, v76
    v_exp_f32 v77, v77
    v_cvt_pk_bf16_f32 v93, v74, v75
    v_exp_f32 v78, v78
    v_exp_f32 v79, v79
    v_cvt_pk_bf16_f32 v94, v76, v77
    v_cvt_pk_bf16_f32 v95, v78, v79
    v_mfma_f32_32x32x16_bf16 v[64:79], v[32:35], v[24:27], v[144:159]
    v_exp_f32 v48, v48
    v_exp_f32 v49, v49
    v_exp_f32 v50, v50
    v_mfma_f32_32x32x16_bf16 v[64:79], v[36:39], v[28:31], v[64:79]
    v_exp_f32 v51, v51
    v_cvt_pk_bf16_f32 v80, v48, v49
    v_exp_f32 v52, v52
    ds_read_b128 v[32:35], v12 offset:3072
    ds_read_b128 v[36:39], v13 offset:3072
    v_exp_f32 v53, v53
    v_cvt_pk_bf16_f32 v81, v50, v51
    v_exp_f32 v54, v54
    v_mfma_f32_32x32x16_bf16 v[112:127], v[40:43], v[88:91], v[112:127]
    v_exp_f32 v55, v55
    v_cvt_pk_bf16_f32 v82, v52, v53
    v_exp_f32 v56, v56
    v_exp_f32 v57, v57
    v_cvt_pk_bf16_f32 v83, v54, v55
    v_mfma_f32_32x32x16_bf16 v[112:127], v[44:47], v[92:95], v[112:127]
    v_exp_f32 v58, v58
    v_exp_f32 v59, v59
    v_cvt_pk_bf16_f32 v84, v56, v57
    v_exp_f32 v60, v60
    ds_read_b128 v[40:43], v14 offset:2048
    ds_read_b128 v[44:47], v14 offset:3072
    v_exp_f32 v61, v61
    v_cvt_pk_bf16_f32 v85, v58, v59
    v_exp_f32 v62, v62
    v_exp_f32 v63, v63
    v_cvt_pk_bf16_f32 v86, v60, v61
    v_cvt_pk_bf16_f32 v87, v62, v63
    s_waitcnt lgkmcnt(2)
    v_mfma_f32_32x32x16_bf16 v[48:63], v[32:35], v[16:19], v[128:143]
    v_exp_f32 v64, v64
    v_exp_f32 v65, v65
    v_exp_f32 v66, v66
    v_mfma_f32_32x32x16_bf16 v[48:63], v[36:39], v[20:23], v[48:63]
    v_exp_f32 v67, v67
    v_cvt_pk_bf16_f32 v88, v64, v65
    v_exp_f32 v68, v68
    v_exp_f32 v69, v69
    v_cvt_pk_bf16_f32 v89, v66, v67
    v_exp_f32 v70, v70
    s_waitcnt lgkmcnt(0)
    v_mfma_f32_32x32x16_bf16 v[96:111], v[40:43], v[80:83], v[96:111]
    v_exp_f32 v71, v71
    v_cvt_pk_bf16_f32 v90, v68, v69
    v_exp_f32 v72, v72
    v_exp_f32 v73, v73
    v_cvt_pk_bf16_f32 v91, v70, v71
    v_mfma_f32_32x32x16_bf16 v[96:111], v[44:47], v[84:87], v[96:111]
    v_exp_f32 v74, v74
    v_exp_f32 v75, v75
    v_cvt_pk_bf16_f32 v92, v72, v73
    v_exp_f32 v76, v76
    v_exp_f32 v77, v77
    v_cvt_pk_bf16_f32 v93, v74, v75
    v_exp_f32 v78, v78
    v_exp_f32 v79, v79
    v_cvt_pk_bf16_f32 v94, v76, v77
    v_cvt_pk_bf16_f32 v95, v78, v79
    v_mfma_f32_32x32x16_bf16 v[64:79], v[32:35], v[24:27], v[144:159]
    v_exp_f32 v48, v48
    v_exp_f32 v49, v49
    v_exp_f32 v50, v50
    v_mfma_f32_32x32x16_bf16 v[64:79], v[36:39], v[28:31], v[64:79]
    v_exp_f32 v51, v51
    v_cvt_pk_bf16_f32 v80, v48, v49
    v_exp_f32 v52, v52
    ds_read_b128 v[32:35], v12 offset:4608
    ds_read_b128 v[36:39], v13 offset:4608
    v_exp_f32 v53, v53
    v_cvt_pk_bf16_f32 v81, v50, v51
    v_exp_f32 v54, v54
    v_mfma_f32_32x32x16_bf16 v[112:127], v[40:43], v[88:91], v[112:127]
    v_exp_f32 v55, v55
    v_cvt_pk_bf16_f32 v82, v52, v53
    v_exp_f32 v56, v56
    v_exp_f32 v57, v57
    v_cvt_pk_bf16_f32 v83, v54, v55
    v_mfma_f32_32x32x16_bf16 v[112:127], v[44:47], v[92:95], v[112:127]
    v_exp_f32 v58, v58
    v_exp_f32 v59, v59
    v_cvt_pk_bf16_f32 v84, v56, v57
    v_exp_f32 v60, v60
    ds_read_b128 v[40:43], v14 offset:4096
    ds_read_b128 v[44:47], v14 offset:5120
    v_exp_f32 v61, v61
    v_cvt_pk_bf16_f32 v85, v58, v59
    v_exp_f32 v62, v62
    v_exp_f32 v63, v63
    v_cvt_pk_bf16_f32 v86, v60, v61
    v_cvt_pk_bf16_f32 v87, v62, v63
    s_waitcnt lgkmcnt(2)
    v_mfma_f32_32x32x16_bf16 v[48:63], v[32:35], v[16:19], v[128:143]
    v_exp_f32 v64, v64
    v_exp_f32 v65, v65
    v_exp_f32 v66, v66
    v_mfma_f32_32x32x16_bf16 v[48:63], v[36:39], v[20:23], v[48:63]
    v_exp_f32 v67, v67
    v_cvt_pk_bf16_f32 v88, v64, v65
    v_exp_f32 v68, v68
    v_exp_f32 v69, v69
    v_cvt_pk_bf16_f32 v89, v66, v67
    v_exp_f32 v70, v70
    s_waitcnt lgkmcnt(0)
    v_mfma_f32_32x32x16_bf16 v[96:111], v[40:43], v[80:83], v[96:111]
    v_exp_f32 v71, v71
    v_cvt_pk_bf16_f32 v90, v68, v69
    v_exp_f32 v72, v72
    v_exp_f32 v73, v73
    v_cvt_pk_bf16_f32 v91, v70, v71
    v_mfma_f32_32x32x16_bf16 v[96:111], v[44:47], v[84:87], v[96:111]
    v_exp_f32 v74, v74
    v_exp_f32 v75, v75
    v_cvt_pk_bf16_f32 v92, v72, v73
    v_exp_f32 v76, v76
    v_exp_f32 v77, v77
    v_cvt_pk_bf16_f32 v93, v74, v75
    v_exp_f32 v78, v78
    v_exp_f32 v79, v79
    v_cvt_pk_bf16_f32 v94, v76, v77
    v_cvt_pk_bf16_f32 v95, v78, v79
    v_mfma_f32_32x32x16_bf16 v[64:79], v[32:35], v[24:27], v[144:159]
    v_exp_f32 v48, v48
    v_exp_f32 v49, v49
    v_exp_f32 v50, v50
    v_mfma_f32_32x32x16_bf16 v[64:79], v[36:39], v[28:31], v[64:79]
    v_exp_f32 v51, v51
    v_cvt_pk_bf16_f32 v80, v48, v49
    v_exp_f32 v52, v52
    ds_read_b128 v[32:35], v12 offset:6144
    ds_read_b128 v[36:39], v13 offset:6144
    v_exp_f32 v53, v53
    v_cvt_pk_bf16_f32 v81, v50, v51
    v_exp_f32 v54, v54
    v_mfma_f32_32x32x16_bf16 v[112:127], v[40:43], v[88:91], v[112:127]
    v_exp_f32 v55, v55
    v_cvt_pk_bf16_f32 v82, v52, v53
    v_exp_f32 v56, v56
    v_exp_f32 v57, v57
    v_cvt_pk_bf16_f32 v83, v54, v55
    v_mfma_f32_32x32x16_bf16 v[112:127], v[44:47], v[92:95], v[112:127]
    v_exp_f32 v58, v58
    v_exp_f32 v59, v59
    v_cvt_pk_bf16_f32 v84, v56, v57
    v_exp_f32 v60, v60
    ds_read_b128 v[40:43], v14 offset:6144
    ds_read_b128 v[44:47], v14 offset:7168
    v_exp_f32 v61, v61
    v_cvt_pk_bf16_f32 v85, v58, v59
    v_exp_f32 v62, v62
    v_exp_f32 v63, v63
    v_cvt_pk_bf16_f32 v86, v60, v61
    v_cvt_pk_bf16_f32 v87, v62, v63
    s_waitcnt lgkmcnt(2)
    v_mfma_f32_32x32x16_bf16 v[48:63], v[32:35], v[16:19], v[128:143]
    v_exp_f32 v64, v64
    v_exp_f32 v65, v65
    v_exp_f32 v66, v66
    v_mfma_f32_32x32x16_bf16 v[48:63], v[36:39], v[20:23], v[48:63]
    v_exp_f32 v67, v67
    v_cvt_pk_bf16_f32 v88, v64, v65
    v_exp_f32 v68, v68
    v_exp_f32 v69, v69
    v_cvt_pk_bf16_f32 v89, v66, v67
    v_exp_f32 v70, v70
    s_waitcnt lgkmcnt(0)
    v_mfma_f32_32x32x16_bf16 v[96:111], v[40:43], v[80:83], v[96:111]
    v_exp_f32 v71, v71
    v_cvt_pk_bf16_f32 v90, v68, v69
    v_exp_f32 v72, v72
    v_exp_f32 v73, v73
    v_cvt_pk_bf16_f32 v91, v70, v71
    v_mfma_f32_32x32x16_bf16 v[96:111], v[44:47], v[84:87], v[96:111]
    v_exp_f32 v74, v74
    v_exp_f32 v75, v75
    v_cvt_pk_bf16_f32 v92, v72, v73
    v_exp_f32 v76, v76
    v_exp_f32 v77, v77
    v_cvt_pk_bf16_f32 v93, v74, v75
    v_exp_f32 v78, v78
    v_exp_f32 v79, v79
    v_cvt_pk_bf16_f32 v94, v76, v77
    v_cvt_pk_bf16_f32 v95, v78, v79
    v_add_u32 v12, 6144, v12
    v_add_u32 v13, 6144, v13
    s_add_u32 s36, s36, 8192
    s_and_b32 s36, s36, 0xffff
    s_add_u32 s39, s36, 98304
    v_add_u32 v14, s39, v10
    s_add_u32 s35, s35, 1
    s_cmp_lt_u32 s35, 16
    s_cbranch_scc1 P2_54
    v_mfma_f32_32x32x16_bf16 v[112:127], v[40:43], v[88:91], v[112:127]
    v_mfma_f32_32x32x16_bf16 v[112:127], v[44:47], v[92:95], v[112:127]
    s_mul_i32 s35, s32, 40
    v_lshrrev_b32 v4, 5, v1
    v_lshlrev_b32 v4, 3, v4
    v_add_u32 v4, s35, v4
    v_and_b32 v5, 8, v4
    v_lshrrev_b32 v4, 4, v4
    v_lshlrev_b32 v4, 9, v4
    v_add_u32 v4, v4, v5
    v_and_b32 v12, 31, v1
    v_lshlrev_b32 v12, 4, v12
    v_add_u32 v12, v12, v4
    s_and_b32 s36, s32, 1
    s_add_u32 s35, s35, 8
    s_lshr_b32 s35, s35, 4
    s_lshl_b32 s35, s35, 9
    v_lshrrev_b32 v4, 5, v1
    v_xor_b32 v4, s36, v4
    v_lshlrev_b32 v4, 3, v4
    v_and_b32 v12, 31, v1
    v_lshlrev_b32 v12, 4, v12
    v_add_u32 v12, v12, v4
    v_add_u32 v12, s35, v12
    s_mul_i32 s35, s36, 1536
    s_sub_u32 s35, 1024, s35
    v_add_u32 v13, s35, v12
    s_sub_u32 vcc_lo, 0, s36
    s_mov_b32 vcc_hi, 0
    s_lshl_b32 s34, s33, 8
    s_lshl_b32 s35, s24, 6
    s_add_u32 s34, s34, s35
    s_mul_i32 s34, s34, 1280
    s_mul_i32 s35, s32, 0
    s_add_u32 s34, s34, s35
    s_add_u32 s34, s34, 65011712
    v_mov_b32 v4, v104
    v_mov_b32 v5, v104
    s_nop 1
    v_permlane32_swap_b32 v4, v5
    v_rcp_f32 v5, v5
    s_nop 0
    v_mul_f32 v96, v96, v5
    v_mul_f32 v97, v97, v5
    v_mul_f32 v98, v98, v5
    v_mul_f32 v99, v99, v5
    v_mul_f32 v100, v100, v5
    v_mul_f32 v101, v101, v5
    v_mul_f32 v102, v102, v5
    v_mul_f32 v103, v103, v5
    v_mul_f32 v104, v104, v5
    v_mul_f32 v105, v105, v5
    v_mul_f32 v106, v106, v5
    v_mul_f32 v107, v107, v5
    v_cvt_pk_bf16_f32 v96, v96, v97
    v_cvt_pk_bf16_f32 v97, v98, v99
    v_cvt_pk_bf16_f32 v98, v100, v101
    v_cvt_pk_bf16_f32 v99, v102, v103
    v_cvt_pk_bf16_f32 v100, v104, v105
    v_cvt_pk_bf16_f32 v101, v106, v107
    v_cndmask_b32 v102, v96, v98, vcc
    v_cndmask_b32 v104, v98, v100, vcc
    v_cndmask_b32 v106, v100, v96, vcc
    v_cndmask_b32 v103, v97, v99, vcc
    v_cndmask_b32 v105, v99, v101, vcc
    v_cndmask_b32 v107, v101, v97, vcc
    buffer_store_dwordx2 v[102:103], v12, s[4:7], s34 offen sc1
    buffer_store_dwordx2 v[104:105], v12, s[4:7], s34 offen offset:512 sc1
    s_mov_b32 exec_hi, 0
    buffer_store_dwordx2 v[106:107], v13, s[4:7], s34 offen sc1
    s_mov_b32 exec_hi, -1
    s_add_u32 s34, s34, 40960
    v_mov_b32 v4, v120
    v_mov_b32 v5, v120
    s_nop 1
    v_permlane32_swap_b32 v4, v5
    v_rcp_f32 v5, v5
    s_nop 0
    v_mul_f32 v112, v112, v5
    v_mul_f32 v113, v113, v5
    v_mul_f32 v114, v114, v5
    v_mul_f32 v115, v115, v5
    v_mul_f32 v116, v116, v5
    v_mul_f32 v117, v117, v5
    v_mul_f32 v118, v118, v5
    v_mul_f32 v119, v119, v5
    v_mul_f32 v120, v120, v5
    v_mul_f32 v121, v121, v5
    v_mul_f32 v122, v122, v5
    v_mul_f32 v123, v123, v5
    v_cvt_pk_bf16_f32 v112, v112, v113
    v_cvt_pk_bf16_f32 v113, v114, v115
    v_cvt_pk_bf16_f32 v114, v116, v117
    v_cvt_pk_bf16_f32 v115, v118, v119
    v_cvt_pk_bf16_f32 v116, v120, v121
    v_cvt_pk_bf16_f32 v117, v122, v123
    v_cndmask_b32 v118, v112, v114, vcc
    v_cndmask_b32 v120, v114, v116, vcc
    v_cndmask_b32 v122, v116, v112, vcc
    v_cndmask_b32 v119, v113, v115, vcc
    v_cndmask_b32 v121, v115, v117, vcc
    v_cndmask_b32 v123, v117, v113, vcc
    buffer_store_dwordx2 v[118:119], v12, s[4:7], s34 offen sc1
    buffer_store_dwordx2 v[120:121], v12, s[4:7], s34 offen offset:512 sc1
    s_mov_b32 exec_hi, 0
    buffer_store_dwordx2 v[122:123], v13, s[4:7], s34 offen sc1
    s_mov_b32 exec_hi, -1
    s_add_u32 s34, s34, 40960
    s_waitcnt vmcnt(0)
    s_barrier
    s_cmp_lg_u32 s24, 0
    s_cbranch_scc1 NF_57
    s_lshl_b32 s39, s25, 2
    s_add_u32 s39, s39, 49664
    v_mov_b32 v4, 0
    v_mov_b32 v5, 1
    s_mov_b64 exec, 1
    buffer_store_dword v5, v4, s[4:7], s39 offen sc1
    s_mov_b64 exec, -1
NF_57:
    s_branch POOL
T_OP:
    s_mul_i32 s33, s25, 52
    s_lshr_b32 s33, s33, 8
    s_mul_i32 s32, s33, 5
    s_sub_u32 s32, s25, s32
    s_mov_b32 s8, s68
    s_mov_b32 s9, s69
    s_mov_b32 s10, 819200
    s_mov_b32 s11, 0x00020000
    s_barrier
    v_lshrrev_b32 v10, 4, v1
    v_mov_b32 v4, s24
    v_mul_u32_u24 v4, 4, v4
    v_add_u32 v10, v10, v4
    v_mul_u32_u24 v10, 1280, v10
    v_and_b32 v4, 15, v1
    v_lshrrev_b32 v5, 4, v1
    v_lshlrev_b32 v5, 1, v5
    v_xor_b32 v4, v4, v5
    v_lshlrev_b32 v4, 4, v4
    v_add_u32 v10, v10, v4
    v_mul_u32_u24 v11, 2176, v3
    v_and_b32 v4, 15, v1
    v_lshrrev_b32 v4, 2, v4
    v_lshlrev_b32 v4, 8, v4
    v_add_u32 v11, v11, v4
    v_mov_b32 v4, s24
    v_mul_u32_u24 v4, 2, v4
    v_and_b32 v5, 3, v1
    v_lshrrev_b32 v5, 1, v5
    v_add_u32 v4, v4, v5
    v_and_b32 v5, 15, v1
    v_lshrrev_b32 v5, 2, v5
    v_xor_b32 v4, v4, v5
    v_lshlrev_b32 v4, 5, v4
    v_add_u32 v11, v11, v4
    v_and_b32 v4, 3, v1
    v_and_b32 v4, 1, v4
    v_lshlrev_b32 v4, 4, v4
    v_add_u32 v11, v11, v4
    v_add_u32 v11, 0, v11
    v_add_u32 v13, 69632, v11
    v_mul_u32_u24 v12, 2176, v3
    v_and_b32 v4, 15, v1
    v_lshrrev_b32 v4, 2, v4
    v_lshlrev_b32 v4, 8, v4
    v_add_u32 v12, v12, v4
    v_mov_b32 v4, s24
    v_mul_u32_u24 v4, 2, v4
    v_and_b32 v5, 3, v1
    v_lshrrev_b32 v5, 1, v5
    v_add_u32 v4, v4, v5
    v_and_b32 v5, 15, v1
    v_lshrrev_b32 v5, 2, v5
    v_xor_b32 v4, v4, v5
    v_lshlrev_b32 v4, 5, v4
    v_add_u32 v12, v12, v4
    v_and_b32 v4, 3, v1
    v_and_b32 v4, 1, v4
    v_lshlrev_b32 v4, 4, v4
    v_add_u32 v12, v12, v4
    v_add_u32 v12, 8, v12
    v_add_u32 v14, 69632, v12
    s_lshl_b32 s28, s32, 8
    s_mul_i32 s26, s24, 1088
    s_add_u32 m0, s26, 0
    s_add_u32 s27, s28, 0
    buffer_load_dwordx4 v10, s[8:11], s27 offen lds
    s_add_u32 m0, s26, 4352
    s_add_u32 s27, s28, 20480
    buffer_load_dwordx4 v10, s[8:11], s27 offen lds
    s_add_u32 m0, s26, 8704
    s_add_u32 s27, s28, 40960
    buffer_load_dwordx4 v10, s[8:11], s27 offen lds
    s_add_u32 m0, s26, 13056
    s_add_u32 s27, s28, 61440
    buffer_load_dwordx4 v10, s[8:11], s27 offen lds
    s_add_u32 m0, s26, 17408
    s_add_u32 s27, s28, 81920
    buffer_load_dwordx4 v10, s[8:11], s27 offen lds
    s_add_u32 m0, s26, 21760
    s_add_u32 s27, s28, 102400
    buffer_load_dwordx4 v10, s[8:11], s27 offen lds
    s_add_u32 m0, s26, 26112
    s_add_u32 s27, s28, 122880
    buffer_load_dwordx4 v10, s[8:11], s27 offen lds
    s_add_u32 m0, s26, 30464
    s_add_u32 s27, s28, 143360
    buffer_load_dwordx4 v10, s[8:11], s27 offen lds
    s_add_u32 m0, s26, 34816
    s_add_u32 s27, s28, 163840
    buffer_load_dwordx4 v10, s[8:11], s27 offen lds
    s_add_u32 m0, s26, 39168
    s_add_u32 s27, s28, 184320
    buffer_load_dwordx4 v10, s[8:11], s27 offen lds
    s_add_u32 m0, s26, 43520
    s_add_u32 s27, s28, 204800
    buffer_load_dwordx4 v10, s[8:11], s27 offen lds
    s_add_u32 m0, s26, 47872
    s_add_u32 s27, s28, 225280
    buffer_load_dwordx4 v10, s[8:11], s27 offen lds
    s_add_u32 m0, s26, 52224
    s_add_u32 s27, s28, 245760
    buffer_load_dwordx4 v10, s[8:11], s27 offen lds
    s_add_u32 m0, s26, 56576
    s_add_u32 s27, s28, 266240
    buffer_load_dwordx4 v10, s[8:11], s27 offen lds
    s_add_u32 m0, s26, 60928
    s_add_u32 s27, s28, 286720
    buffer_load_dwordx4 v10, s[8:11], s27 offen lds
    s_add_u32 m0, s26, 65280
    s_add_u32 s27, s28, 307200
    buffer_load_dwordx4 v10, s[8:11], s27 offen lds
    s_add_u32 m0, s26, 69632
    s_add_u32 s27, s28, 327680
    buffer_load_dwordx4 v10, s[8:11], s27 offen lds
    s_add_u32 m0, s26, 73984
    s_add_u32 s27, s28, 348160
    buffer_load_dwordx4 v10, s[8:11], s27 offen lds
    s_add_u32 m0, s26, 78336
    s_add_u32 s27, s28, 368640
    buffer_load_dwordx4 v10, s[8:11], s27 offen lds
    s_add_u32 m0, s26, 82688
    s_add_u32 s27, s28, 389120
    buffer_load_dwordx4 v10, s[8:11], s27 offen lds
    s_add_u32 m0, s26, 87040
    s_add_u32 s27, s28, 409600
    buffer_load_dwordx4 v10, s[8:11], s27 offen lds
    s_add_u32 m0, s26, 91392
    s_add_u32 s27, s28, 430080
    buffer_load_dwordx4 v10, s[8:11], s27 offen lds
    s_add_u32 m0, s26, 95744
    s_add_u32 s27, s28, 450560
    buffer_load_dwordx4 v10, s[8:11], s27 offen lds
    s_add_u32 m0, s26, 100096
    s_add_u32 s27, s28, 471040
    buffer_load_dwordx4 v10, s[8:11], s27 offen lds
    s_add_u32 m0, s26, 104448
    s_add_u32 s27, s28, 491520
    buffer_load_dwordx4 v10, s[8:11], s27 offen lds
    s_add_u32 m0, s26, 108800
    s_add_u32 s27, s28, 512000
    buffer_load_dwordx4 v10, s[8:11], s27 offen lds
    s_add_u32 m0, s26, 113152
    s_add_u32 s27, s28, 532480
    buffer_load_dwordx4 v10, s[8:11], s27 offen lds
    s_add_u32 m0, s26, 117504
    s_add_u32 s27, s28, 552960
    buffer_load_dwordx4 v10, s[8:11], s27 offen lds
    s_add_u32 m0, s26, 121856
    s_add_u32 s27, s28, 573440
    buffer_load_dwordx4 v10, s[8:11], s27 offen lds
    s_add_u32 m0, s26, 126208
    s_add_u32 s27, s28, 593920
    buffer_load_dwordx4 v10, s[8:11], s27 offen lds
    s_add_u32 m0, s26, 130560
    s_add_u32 s27, s28, 614400
    buffer_load_dwordx4 v10, s[8:11], s27 offen lds
    s_add_u32 m0, s26, 134912
    s_add_u32 s27, s28, 634880
    buffer_load_dwordx4 v10, s[8:11], s27 offen lds
    s_waitcnt vmcnt(16)
    s_barrier
    ds_read_b64_tr_b16 a[0:1], v11 offset:0
    ds_read_b64_tr_b16 a[2:3], v11 offset:1088
    ds_read_b64_tr_b16 a[4:5], v11 offset:8704
    ds_read_b64_tr_b16 a[6:7], v11 offset:9792
    ds_read_b64_tr_b16 a[8:9], v11 offset:17408
    ds_read_b64_tr_b16 a[10:11], v11 offset:18496
    ds_read_b64_tr_b16 a[12:13], v11 offset:26112
    ds_read_b64_tr_b16 a[14:15], v11 offset:27200
    ds_read_b64_tr_b16 a[16:17], v11 offset:34816
    ds_read_b64_tr_b16 a[18:19], v11 offset:35904
    ds_read_b64_tr_b16 a[20:21], v11 offset:43520
    ds_read_b64_tr_b16 a[22:23], v11 offset:44608
    ds_read_b64_tr_b16 a[24:25], v11 offset:52224
    ds_read_b64_tr_b16 a[26:27], v11 offset:53312
    ds_read_b64_tr_b16 a[28:29], v11 offset:60928
    ds_read_b64_tr_b16 a[30:31], v11 offset:62016
    ds_read_b64_tr_b16 a[80:81], v12 offset:0
    ds_read_b64_tr_b16 a[82:83], v12 offset:1088
    ds_read_b64_tr_b16 a[84:85], v12 offset:8704
    ds_read_b64_tr_b16 a[86:87], v12 offset:9792
    ds_read_b64_tr_b16 a[88:89], v12 offset:17408
    ds_read_b64_tr_b16 a[90:91], v12 offset:18496
    ds_read_b64_tr_b16 a[92:93], v12 offset:26112
    ds_read_b64_tr_b16 a[94:95], v12 offset:27200
    ds_read_b64_tr_b16 a[96:97], v12 offset:34816
    ds_read_b64_tr_b16 a[98:99], v12 offset:35904
    ds_read_b64_tr_b16 a[100:101], v12 offset:43520
    ds_read_b64_tr_b16 a[102:103], v12 offset:44608
    ds_read_b64_tr_b16 a[104:105], v12 offset:52224
    ds_read_b64_tr_b16 a[106:107], v12 offset:53312
    ds_read_b64_tr_b16 a[108:109], v12 offset:60928
    ds_read_b64_tr_b16 a[110:111], v12 offset:62016
    s_waitcnt lgkmcnt(0)
    s_barrier
    s_add_u32 m0, s26, 0
    s_add_u32 s27, s28, 655360
    buffer_load_dwordx4 v10, s[8:11], s27 offen lds
    s_add_u32 m0, s26, 4352
    s_add_u32 s27, s28, 675840
    buffer_load_dwordx4 v10, s[8:11], s27 offen lds
    s_add_u32 m0, s26, 8704
    s_add_u32 s27, s28, 696320
    buffer_load_dwordx4 v10, s[8:11], s27 offen lds
    s_add_u32 m0, s26, 13056
    s_add_u32 s27, s28, 716800
    buffer_load_dwordx4 v10, s[8:11], s27 offen lds
    s_add_u32 m0, s26, 17408
    s_add_u32 s27, s28, 737280
    buffer_load_dwordx4 v10, s[8:11], s27 offen lds
    s_add_u32 m0, s26, 21760
    s_add_u32 s27, s28, 757760
    buffer_load_dwordx4 v10, s[8:11], s27 offen lds
    s_add_u32 m0, s26, 26112
    s_add_u32 s27, s28, 778240
    buffer_load_dwordx4 v10, s[8:11], s27 offen lds
    s_add_u32 m0, s26, 30464
    s_add_u32 s27, s28, 798720
    buffer_load_dwordx4 v10, s[8:11], s27 offen lds
    s_waitcnt vmcnt(8)
    s_barrier
    ds_read_b64_tr_b16 a[32:33], v13 offset:0
    ds_read_b64_tr_b16 a[34:35], v13 offset:1088
    ds_read_b64_tr_b16 a[36:37], v13 offset:8704
    ds_read_b64_tr_b16 a[38:39], v13 offset:9792
    ds_read_b64_tr_b16 a[40:41], v13 offset:17408
    ds_read_b64_tr_b16 a[42:43], v13 offset:18496
    ds_read_b64_tr_b16 a[44:45], v13 offset:26112
    ds_read_b64_tr_b16 a[46:47], v13 offset:27200
    ds_read_b64_tr_b16 a[48:49], v13 offset:34816
    ds_read_b64_tr_b16 a[50:51], v13 offset:35904
    ds_read_b64_tr_b16 a[52:53], v13 offset:43520
    ds_read_b64_tr_b16 a[54:55], v13 offset:44608
    ds_read_b64_tr_b16 a[56:57], v13 offset:52224
    ds_read_b64_tr_b16 a[58:59], v13 offset:53312
    ds_read_b64_tr_b16 a[60:61], v13 offset:60928
    ds_read_b64_tr_b16 a[62:63], v13 offset:62016
    ds_read_b64_tr_b16 a[112:113], v14 offset:0
    ds_read_b64_tr_b16 a[114:115], v14 offset:1088
    ds_read_b64_tr_b16 a[116:117], v14 offset:8704
    ds_read_b64_tr_b16 a[118:119], v14 offset:9792
    ds_read_b64_tr_b16 a[120:121], v14 offset:17408
    ds_read_b64_tr_b16 a[122:123], v14 offset:18496
    ds_read_b64_tr_b16 a[124:125], v14 offset:26112
    ds_read_b64_tr_b16 a[126:127], v14 offset:27200
    ds_read_b64_tr_b16 a[128:129], v14 offset:34816
    ds_read_b64_tr_b16 a[130:131], v14 offset:35904
    ds_read_b64_tr_b16 a[132:133], v14 offset:43520
    ds_read_b64_tr_b16 a[134:135], v14 offset:44608
    ds_read_b64_tr_b16 a[136:137], v14 offset:52224
    ds_read_b64_tr_b16 a[138:139], v14 offset:53312
    ds_read_b64_tr_b16 a[140:141], v14 offset:60928
    ds_read_b64_tr_b16 a[142:143], v14 offset:62016
    s_waitcnt lgkmcnt(0)
    s_barrier
    s_waitcnt vmcnt(0)
    s_barrier
    ds_read_b64_tr_b16 a[64:65], v11 offset:0
    ds_read_b64_tr_b16 a[66:67], v11 offset:1088
    ds_read_b64_tr_b16 a[68:69], v11 offset:8704
    ds_read_b64_tr_b16 a[70:71], v11 offset:9792
    ds_read_b64_tr_b16 a[72:73], v11 offset:17408
    ds_read_b64_tr_b16 a[74:75], v11 offset:18496
    ds_read_b64_tr_b16 a[76:77], v11 offset:26112
    ds_read_b64_tr_b16 a[78:79], v11 offset:27200
    ds_read_b64_tr_b16 a[144:145], v12 offset:0
    ds_read_b64_tr_b16 a[146:147], v12 offset:1088
    ds_read_b64_tr_b16 a[148:149], v12 offset:8704
    ds_read_b64_tr_b16 a[150:151], v12 offset:9792
    ds_read_b64_tr_b16 a[152:153], v12 offset:17408
    ds_read_b64_tr_b16 a[154:155], v12 offset:18496
    ds_read_b64_tr_b16 a[156:157], v12 offset:26112
    ds_read_b64_tr_b16 a[158:159], v12 offset:27200
    s_waitcnt lgkmcnt(0)
    s_barrier
    s_lshl_b32 s31, s33, 7
    s_add_u32 s31, s31, 49664
    v_min_u32 v4, 31, v1
    v_lshlrev_b32 v4, 2, v4
    s_mov_b32 s30, 50000
WF_58:
    buffer_load_dword v5, v4, s[4:7], s31 offen sc1
    s_waitcnt vmcnt(0)
    v_cmp_ne_u32 vcc, 1, v5
    s_cbranch_vccz WE_59
    s_sleep 48
    s_sub_u32 s30, s30, 1
    s_cmp_lg_u32 s30, 0
    s_cbranch_scc1 WF_58
    s_endpgm
WE_59:
    s_mul_i32 s34, s33, 327680
    s_add_u32 s34, s34, 65011712
    v_lshlrev_b32 v30, 4, v2
    v_lshlrev_b32 v4, 9, v3
    v_add_u32 v30, v30, v4
    v_mov_b32 v4, s24
    v_mul_u32_u24 v4, 10240, v4
    v_add_u32 v30, v30, v4
    s_mul_i32 s47, s24, 10240
    s_add_u32 s28, s47, 69632
    s_add_u32 m0, s28, 0
    s_add_u32 s27, s34, 0
    buffer_load_dwordx4 v30, s[4:7], s27 offen sc1 lds
    s_add_u32 m0, s28, 1024
    s_add_u32 s27, s34, 256
    buffer_load_dwordx4 v30, s[4:7], s27 offen sc1 lds
    s_add_u32 m0, s28, 2048
    s_add_u32 s27, s34, 2048
    buffer_load_dwordx4 v30, s[4:7], s27 offen sc1 lds
    s_add_u32 m0, s28, 3072
    s_add_u32 s27, s34, 2304
    buffer_load_dwordx4 v30, s[4:7], s27 offen sc1 lds
    s_add_u32 m0, s28, 4096
    s_add_u32 s27, s34, 4096
    buffer_load_dwordx4 v30, s[4:7], s27 offen sc1 lds
    s_add_u32 m0, s28, 5120
    s_add_u32 s27, s34, 4352
    buffer_load_dwordx4 v30, s[4:7], s27 offen sc1 lds
    s_add_u32 m0, s28, 6144
    s_add_u32 s27, s34, 6144
    buffer_load_dwordx4 v30, s[4:7], s27 offen sc1 lds
    s_add_u32 m0, s28, 7168
    s_add_u32 s27, s34, 6400
    buffer_load_dwordx4 v30, s[4:7], s27 offen sc1 lds
    s_add_u32 m0, s28, 8192
    s_add_u32 s27, s34, 8192
    buffer_load_dwordx4 v30, s[4:7], s27 offen sc1 lds
    s_add_u32 m0, s28, 9216
    s_add_u32 s27, s34, 8448
    buffer_load_dwordx4 v30, s[4:7], s27 offen sc1 lds
    s_add_u32 s28, s47, 110592
    s_add_u32 s36, s34, 40960
    s_add_u32 m0, s28, 0
    s_add_u32 s27, s36, 0
    buffer_load_dwordx4 v30, s[4:7], s27 offen sc1 lds
    s_add_u32 m0, s28, 1024
    s_add_u32 s27, s36, 256
    buffer_load_dwordx4 v30, s[4:7], s27 offen sc1 lds
    s_add_u32 m0, s28, 2048
    s_add_u32 s27, s36, 2048
    buffer_load_dwordx4 v30, s[4:7], s27 offen sc1 lds
    s_add_u32 m0, s28, 3072
    s_add_u32 s27, s36, 2304
    buffer_load_dwordx4 v30, s[4:7], s27 offen sc1 lds
    s_add_u32 m0, s28, 4096
    s_add_u32 s27, s36, 4096
    buffer_load_dwordx4 v30, s[4:7], s27 offen sc1 lds
    s_add_u32 m0, s28, 5120
    s_add_u32 s27, s36, 4352
    buffer_load_dwordx4 v30, s[4:7], s27 offen sc1 lds
    s_add_u32 m0, s28, 6144
    s_add_u32 s27, s36, 6144
    buffer_load_dwordx4 v30, s[4:7], s27 offen sc1 lds
    s_add_u32 m0, s28, 7168
    s_add_u32 s27, s36, 6400
    buffer_load_dwordx4 v30, s[4:7], s27 offen sc1 lds
    s_add_u32 m0, s28, 8192
    s_add_u32 s27, s36, 8192
    buffer_load_dwordx4 v30, s[4:7], s27 offen sc1 lds
    s_add_u32 m0, s28, 9216
    s_add_u32 s27, s36, 8448
    buffer_load_dwordx4 v30, s[4:7], s27 offen sc1 lds
    v_lshlrev_b32 v31, 4, v1
    v_add_u32 v31, 69632, v31
    v_mul_u32_u24 v29, 2560, v2
    v_lshlrev_b32 v4, 4, v3
    v_add_u32 v29, v29, v4
    v_mov_b32 v4, s24
    v_lshlrev_b32 v4, 6, v4
    v_add_u32 v29, v29, v4
    s_mul_i32 s37, s33, 655360
    s_lshl_b32 s38, s32, 8
    s_add_u32 s37, s37, s38
    s_mov_b32 s35, 0
    s_mov_b32 s44, 69632
    s_mov_b32 s45, 110592
    s_mov_b32 s46, 0
    s_waitcnt vmcnt(10)
    s_branch PW_65
OP_60:
    s_cmp_eq_u32 s35, 1
    s_cbranch_scc1 FW_64
    s_cmp_eq_u32 s35, 8
    s_cbranch_scc1 FW_64
    s_cmp_eq_u32 s35, 7
    s_cbranch_scc1 LW_67
    s_waitcnt vmcnt(12)
    s_branch PW_65
LW_67:
    s_waitcnt vmcnt(2)
    s_branch PW_65
FW_64:
    s_waitcnt vmcnt(0)
PW_65:
    s_barrier
    s_cmp_eq_u32 s35, 8
    s_cbranch_scc1 E_63
    v_lshlrev_b32 v31, 4, v1
    v_add_u32 v31, s44, v31
    s_cmp_ge_u32 s35, 6
    s_cbranch_scc1 SK_61
    s_add_u32 s36, s34, 81920
    s_add_u32 s28, s47, s46
    s_add_u32 m0, s28, 0
    s_add_u32 s27, s36, 0
    buffer_load_dwordx4 v30, s[4:7], s27 offen sc1 lds
    s_add_u32 m0, s28, 1024
    s_add_u32 s27, s36, 256
    buffer_load_dwordx4 v30, s[4:7], s27 offen sc1 lds
    s_add_u32 m0, s28, 2048
    s_add_u32 s27, s36, 2048
    buffer_load_dwordx4 v30, s[4:7], s27 offen sc1 lds
    s_add_u32 m0, s28, 3072
    s_add_u32 s27, s36, 2304
    buffer_load_dwordx4 v30, s[4:7], s27 offen sc1 lds
    s_add_u32 m0, s28, 4096
    s_add_u32 s27, s36, 4096
    buffer_load_dwordx4 v30, s[4:7], s27 offen sc1 lds
    s_add_u32 m0, s28, 5120
    s_add_u32 s27, s36, 4352
    buffer_load_dwordx4 v30, s[4:7], s27 offen sc1 lds
    s_add_u32 m0, s28, 6144
    s_add_u32 s27, s36, 6144
    buffer_load_dwordx4 v30, s[4:7], s27 offen sc1 lds
    s_add_u32 m0, s28, 7168
    s_add_u32 s27, s36, 6400
    buffer_load_dwordx4 v30, s[4:7], s27 offen sc1 lds
    s_add_u32 m0, s28, 8192
    s_add_u32 s27, s36, 8192
    buffer_load_dwordx4 v30, s[4:7], s27 offen sc1 lds
    s_add_u32 m0, s28, 9216
    s_add_u32 s27, s36, 8448
    buffer_load_dwordx4 v30, s[4:7], s27 offen sc1 lds
SK_61:
    ds_read_b128 v[72:75], v31 offset:0
    ds_read_b128 v[76:79], v31 offset:1024
    ds_read_b128 v[80:83], v31 offset:2048
    ds_read_b128 v[84:87], v31 offset:3072
    ds_read_b128 v[88:91], v31 offset:4096
    ds_read_b128 v[92:95], v31 offset:5120
    ds_read_b128 v[96:99], v31 offset:6144
    ds_read_b128 v[100:103], v31 offset:7168
    s_waitcnt lgkmcnt(6)
    v_mfma_f32_16x16x32_bf16 v[48:51], a[0:3], v[72:75], 0
    v_mfma_f32_16x16x32_bf16 v[56:59], a[80:83], v[72:75], 0
    v_mfma_f32_16x16x32_bf16 v[52:55], a[0:3], v[76:79], 0
    v_mfma_f32_16x16x32_bf16 v[60:63], a[80:83], v[76:79], 0
    ds_read_b128 v[72:75], v31 offset:8192
    ds_read_b128 v[76:79], v31 offset:9216
    s_waitcnt lgkmcnt(6)
    v_mfma_f32_16x16x32_bf16 v[48:51], a[4:7], v[80:83], v[48:51]
    v_mfma_f32_16x16x32_bf16 v[56:59], a[84:87], v[80:83], v[56:59]
    v_mfma_f32_16x16x32_bf16 v[52:55], a[4:7], v[84:87], v[52:55]
    v_mfma_f32_16x16x32_bf16 v[60:63], a[84:87], v[84:87], v[60:63]
    ds_read_b128 v[80:83], v31 offset:10240
    ds_read_b128 v[84:87], v31 offset:11264
    s_waitcnt lgkmcnt(6)
    v_mfma_f32_16x16x32_bf16 v[48:51], a[8:11], v[88:91], v[48:51]
    v_mfma_f32_16x16x32_bf16 v[56:59], a[88:91], v[88:91], v[56:59]
    v_mfma_f32_16x16x32_bf16 v[52:55], a[8:11], v[92:95], v[52:55]
    v_mfma_f32_16x16x32_bf16 v[60:63], a[88:91], v[92:95], v[60:63]
    ds_read_b128 v[88:91], v31 offset:12288
    ds_read_b128 v[92:95], v31 offset:13312
    s_waitcnt lgkmcnt(6)
    v_mfma_f32_16x16x32_bf16 v[48:51], a[12:15], v[96:99], v[48:51]
    v_mfma_f32_16x16x32_bf16 v[56:59], a[92:95], v[96:99], v[56:59]
    v_mfma_f32_16x16x32_bf16 v[52:55], a[12:15], v[100:103], v[52:55]
    v_mfma_f32_16x16x32_bf16 v[60:63], a[92:95], v[100:103], v[60:63]
    ds_read_b128 v[96:99], v31 offset:14336
    ds_read_b128 v[100:103], v31 offset:15360
    s_waitcnt lgkmcnt(6)
    v_mfma_f32_16x16x32_bf16 v[48:51], a[16:19], v[72:75], v[48:51]
    v_mfma_f32_16x16x32_bf16 v[56:59], a[96:99], v[72:75], v[56:59]
    v_mfma_f32_16x16x32_bf16 v[52:55], a[16:19], v[76:79], v[52:55]
    v_mfma_f32_16x16x32_bf16 v[60:63], a[96:99], v[76:79], v[60:63]
    ds_read_b128 v[72:75], v31 offset:16384
    ds_read_b128 v[76:79], v31 offset:17408
    s_waitcnt lgkmcnt(6)
    v_mfma_f32_16x16x32_bf16 v[48:51], a[20:23], v[80:83], v[48:51]
    v_mfma_f32_16x16x32_bf16 v[56:59], a[100:103], v[80:83], v[56:59]
    v_mfma_f32_16x16x32_bf16 v[52:55], a[20:23], v[84:87], v[52:55]
    v_mfma_f32_16x16x32_bf16 v[60:63], a[100:103], v[84:87], v[60:63]
    ds_read_b128 v[80:83], v31 offset:18432
    ds_read_b128 v[84:87], v31 offset:19456
    s_waitcnt lgkmcnt(6)
    v_mfma_f32_16x16x32_bf16 v[48:51], a[24:27], v[88:91], v[48:51]
    v_mfma_f32_16x16x32_bf16 v[56:59], a[104:107], v[88:91], v[56:59]
    v_mfma_f32_16x16x32_bf16 v[52:55], a[24:27], v[92:95], v[52:55]
    v_mfma_f32_16x16x32_bf16 v[60:63], a[104:107], v[92:95], v[60:63]
    ds_read_b128 v[88:91], v31 offset:20480
    ds_read_b128 v[92:95], v31 offset:21504
    s_waitcnt lgkmcnt(6)
    v_mfma_f32_16x16x32_bf16 v[48:51], a[28:31], v[96:99], v[48:51]
    v_mfma_f32_16x16x32_bf16 v[56:59], a[108:111], v[96:99], v[56:59]
    v_mfma_f32_16x16x32_bf16 v[52:55], a[28:31], v[100:103], v[52:55]
    v_mfma_f32_16x16x32_bf16 v[60:63], a[108:111], v[100:103], v[60:63]
    ds_read_b128 v[96:99], v31 offset:22528
    ds_read_b128 v[100:103], v31 offset:23552
    s_waitcnt lgkmcnt(6)
    v_mfma_f32_16x16x32_bf16 v[48:51], a[32:35], v[72:75], v[48:51]
    v_mfma_f32_16x16x32_bf16 v[56:59], a[112:115], v[72:75], v[56:59]
    v_mfma_f32_16x16x32_bf16 v[52:55], a[32:35], v[76:79], v[52:55]
    v_mfma_f32_16x16x32_bf16 v[60:63], a[112:115], v[76:79], v[60:63]
    ds_read_b128 v[72:75], v31 offset:24576
    ds_read_b128 v[76:79], v31 offset:25600
    s_waitcnt lgkmcnt(6)
    v_mfma_f32_16x16x32_bf16 v[48:51], a[36:39], v[80:83], v[48:51]
    v_mfma_f32_16x16x32_bf16 v[56:59], a[116:119], v[80:83], v[56:59]
    v_mfma_f32_16x16x32_bf16 v[52:55], a[36:39], v[84:87], v[52:55]
    v_mfma_f32_16x16x32_bf16 v[60:63], a[116:119], v[84:87], v[60:63]
    ds_read_b128 v[80:83], v31 offset:26624
    ds_read_b128 v[84:87], v31 offset:27648
    s_waitcnt lgkmcnt(6)
    v_mfma_f32_16x16x32_bf16 v[48:51], a[40:43], v[88:91], v[48:51]
    v_mfma_f32_16x16x32_bf16 v[56:59], a[120:123], v[88:91], v[56:59]
    v_mfma_f32_16x16x32_bf16 v[52:55], a[40:43], v[92:95], v[52:55]
    v_mfma_f32_16x16x32_bf16 v[60:63], a[120:123], v[92:95], v[60:63]
    ds_read_b128 v[88:91], v31 offset:28672
    ds_read_b128 v[92:95], v31 offset:29696
    s_waitcnt lgkmcnt(6)
    v_mfma_f32_16x16x32_bf16 v[48:51], a[44:47], v[96:99], v[48:51]
    v_mfma_f32_16x16x32_bf16 v[56:59], a[124:127], v[96:99], v[56:59]
    v_mfma_f32_16x16x32_bf16 v[52:55], a[44:47], v[100:103], v[52:55]
    v_mfma_f32_16x16x32_bf16 v[60:63], a[124:127], v[100:103], v[60:63]
    ds_read_b128 v[96:99], v31 offset:30720
    ds_read_b128 v[100:103], v31 offset:31744
    s_waitcnt lgkmcnt(6)
    v_mfma_f32_16x16x32_bf16 v[48:51], a[48:51], v[72:75], v[48:51]
    v_mfma_f32_16x16x32_bf16 v[56:59], a[128:131], v[72:75], v[56:59]
    v_mfma_f32_16x16x32_bf16 v[52:55], a[48:51], v[76:79], v[52:55]
    v_mfma_f32_16x16x32_bf16 v[60:63], a[128:131], v[76:79], v[60:63]
    ds_read_b128 v[72:75], v31 offset:32768
    ds_read_b128 v[76:79], v31 offset:33792
    s_waitcnt lgkmcnt(6)
    v_mfma_f32_16x16x32_bf16 v[48:51], a[52:55], v[80:83], v[48:51]
    v_mfma_f32_16x16x32_bf16 v[56:59], a[132:135], v[80:83], v[56:59]
    v_mfma_f32_16x16x32_bf16 v[52:55], a[52:55], v[84:87], v[52:55]
    v_mfma_f32_16x16x32_bf16 v[60:63], a[132:135], v[84:87], v[60:63]
    ds_read_b128 v[80:83], v31 offset:34816
    ds_read_b128 v[84:87], v31 offset:35840
    s_waitcnt lgkmcnt(6)
    v_mfma_f32_16x16x32_bf16 v[48:51], a[56:59], v[88:91], v[48:51]
    v_mfma_f32_16x16x32_bf16 v[56:59], a[136:139], v[88:91], v[56:59]
    v_mfma_f32_16x16x32_bf16 v[52:55], a[56:59], v[92:95], v[52:55]
    v_mfma_f32_16x16x32_bf16 v[60:63], a[136:139], v[92:95], v[60:63]
    ds_read_b128 v[88:91], v31 offset:36864
    ds_read_b128 v[92:95], v31 offset:37888
    s_waitcnt lgkmcnt(6)
    v_mfma_f32_16x16x32_bf16 v[48:51], a[60:63], v[96:99], v[48:51]
    v_mfma_f32_16x16x32_bf16 v[56:59], a[140:143], v[96:99], v[56:59]
    v_mfma_f32_16x16x32_bf16 v[52:55], a[60:63], v[100:103], v[52:55]
    v_mfma_f32_16x16x32_bf16 v[60:63], a[140:143], v[100:103], v[60:63]
    ds_read_b128 v[96:99], v31 offset:38912
    ds_read_b128 v[100:103], v31 offset:39936
    s_waitcnt lgkmcnt(6)
    v_mfma_f32_16x16x32_bf16 v[48:51], a[64:67], v[72:75], v[48:51]
    v_mfma_f32_16x16x32_bf16 v[56:59], a[144:147], v[72:75], v[56:59]
    v_mfma_f32_16x16x32_bf16 v[52:55], a[64:67], v[76:79], v[52:55]
    v_mfma_f32_16x16x32_bf16 v[60:63], a[144:147], v[76:79], v[60:63]
    s_waitcnt lgkmcnt(4)
    v_mfma_f32_16x16x32_bf16 v[48:51], a[68:71], v[80:83], v[48:51]
    v_mfma_f32_16x16x32_bf16 v[56:59], a[148:151], v[80:83], v[56:59]
    v_mfma_f32_16x16x32_bf16 v[52:55], a[68:71], v[84:87], v[52:55]
    v_mfma_f32_16x16x32_bf16 v[60:63], a[148:151], v[84:87], v[60:63]
    s_waitcnt lgkmcnt(2)
    v_mfma_f32_16x16x32_bf16 v[48:51], a[72:75], v[88:91], v[48:51]
    v_mfma_f32_16x16x32_bf16 v[56:59], a[152:155], v[88:91], v[56:59]
    v_mfma_f32_16x16x32_bf16 v[52:55], a[72:75], v[92:95], v[52:55]
    v_mfma_f32_16x16x32_bf16 v[60:63], a[152:155], v[92:95], v[60:63]
    s_waitcnt lgkmcnt(0)
    v_mfma_f32_16x16x32_bf16 v[48:51], a[76:79], v[96:99], v[48:51]
    v_mfma_f32_16x16x32_bf16 v[56:59], a[156:159], v[96:99], v[56:59]
    v_mfma_f32_16x16x32_bf16 v[52:55], a[76:79], v[100:103], v[52:55]
    v_mfma_f32_16x16x32_bf16 v[60:63], a[156:159], v[100:103], v[60:63]
    s_nop 4
    v_cvt_pk_bf16_f32 v64, v48, v49
    v_cvt_pk_bf16_f32 v65, v50, v51
    v_cvt_pk_bf16_f32 v66, v56, v57
    v_cvt_pk_bf16_f32 v67, v58, v59
    buffer_store_dwordx4 v[64:67], v29, s[16:19], s37 offen
    s_add_u32 s37, s37, 40960
    v_cvt_pk_bf16_f32 v68, v52, v53
    v_cvt_pk_bf16_f32 v69, v54, v55
    v_cvt_pk_bf16_f32 v70, v60, v61
    v_cvt_pk_bf16_f32 v71, v62, v63
    buffer_store_dwordx4 v[68:71], v29, s[16:19], s37 offen
    s_add_u32 s37, s37, 40960
    s_mov_b32 s31, s44
    s_mov_b32 s44, s45
    s_mov_b32 s45, s46
    s_mov_b32 s46, s31
    s_add_u32 s34, s34, 40960
    s_add_u32 s35, s35, 1
    s_branch OP_60
E_63:
    s_branch POOL
T_H:
    s_sub_u32 s25, s25, 630
    s_cmp_ge_u32 s25, 20
    s_cbranch_scc1 PEXIT
    s_and_b32 s39, s25, 1
    s_lshr_b32 s33, s25, 1
    s_lshl_b32 s33, s33, 2
    s_add_u32 s33, s33, s24
    s_mov_b32 s31, 16256
    v_min_u32 v4, 31, v1
    v_lshlrev_b32 v4, 2, v4
    s_mov_b32 s30, 50000
WF_68:
    buffer_load_dword v5, v4, s[4:7], s31 offen sc1
    s_waitcnt vmcnt(0)
    v_cmp_ne_u32 vcc, 1, v5
    s_cbranch_vccz WE_69
    s_sleep 16
    s_sub_u32 s30, s30, 1
    s_cmp_lg_u32 s30, 0
    s_cbranch_scc1 WF_68
    s_endpgm
WE_69:
    s_barrier
    v_lshlrev_b32 v10, 4, v1
    s_add_u32 s35, s33, 2520
    s_lshl_b32 s36, s35, 15
    s_add_u32 s36, s36, 92274688
    buffer_load_dwordx4 a[0:3], v10, s[4:7], s36 offen offset:0 sc1
    buffer_load_dwordx4 a[4:7], v10, s[4:7], s36 offen offset:1024 sc1
    buffer_load_dwordx4 a[8:11], v10, s[4:7], s36 offen offset:2048 sc1
    buffer_load_dwordx4 a[12:15], v10, s[4:7], s36 offen offset:3072 sc1
    s_add_u32 s36, s36, 4096
    buffer_load_dwordx4 a[16:19], v10, s[4:7], s36 offen offset:0 sc1
    buffer_load_dwordx4 a[20:23], v10, s[4:7], s36 offen offset:1024 sc1
    buffer_load_dwordx4 a[24:27], v10, s[4:7], s36 offen offset:2048 sc1
    buffer_load_dwordx4 a[28:31], v10, s[4:7], s36 offen offset:3072 sc1
    s_add_u32 s36, s36, 4096
    buffer_load_dwordx4 a[32:35], v10, s[4:7], s36 offen offset:0 sc1
    buffer_load_dwordx4 a[36:39], v10, s[4:7], s36 offen offset:1024 sc1
    buffer_load_dwordx4 a[40:43], v10, s[4:7], s36 offen offset:2048 sc1
    buffer_load_dwordx4 a[44:47], v10, s[4:7], s36 offen offset:3072 sc1
    s_add_u32 s36, s36, 4096
    buffer_load_dwordx4 a[48:51], v10, s[4:7], s36 offen offset:0 sc1
    buffer_load_dwordx4 a[52:55], v10, s[4:7], s36 offen offset:1024 sc1
    buffer_load_dwordx4 a[56:59], v10, s[4:7], s36 offen offset:2048 sc1
    buffer_load_dwordx4 a[60:63], v10, s[4:7], s36 offen offset:3072 sc1
    s_add_u32 s36, s36, 4096
    buffer_load_dwordx4 a[64:67], v10, s[4:7], s36 offen offset:0 sc1
    buffer_load_dwordx4 a[68:71], v10, s[4:7], s36 offen offset:1024 sc1
    buffer_load_dwordx4 a[72:75], v10, s[4:7], s36 offen offset:2048 sc1
    buffer_load_dwordx4 a[76:79], v10, s[4:7], s36 offen offset:3072 sc1
    s_add_u32 s36, s36, 4096
    buffer_load_dwordx4 a[80:83], v10, s[4:7], s36 offen offset:0 sc1
    buffer_load_dwordx4 a[84:87], v10, s[4:7], s36 offen offset:1024 sc1
    buffer_load_dwordx4 a[88:91], v10, s[4:7], s36 offen offset:2048 sc1
    buffer_load_dwordx4 a[92:95], v10, s[4:7], s36 offen offset:3072 sc1
    s_add_u32 s36, s36, 4096
    buffer_load_dwordx4 a[96:99], v10, s[4:7], s36 offen offset:0 sc1
    buffer_load_dwordx4 a[100:103], v10, s[4:7], s36 offen offset:1024 sc1
    buffer_load_dwordx4 a[104:107], v10, s[4:7], s36 offen offset:2048 sc1
    buffer_load_dwordx4 a[108:111], v10, s[4:7], s36 offen offset:3072 sc1
    s_add_u32 s36, s36, 4096
    buffer_load_dwordx4 a[112:115], v10, s[4:7], s36 offen offset:0 sc1
    buffer_load_dwordx4 a[116:119], v10, s[4:7], s36 offen offset:1024 sc1
    buffer_load_dwordx4 a[120:123], v10, s[4:7], s36 offen offset:2048 sc1
    buffer_load_dwordx4 a[124:127], v10, s[4:7], s36 offen offset:3072 sc1
    s_add_u32 s36, s36, 4096
    s_mov_b32 s31, 48768
    v_min_u32 v4, 31, v1
    v_lshlrev_b32 v4, 2, v4
    s_mov_b32 s30, 50000
WF_70:
    buffer_load_dword v5, v4, s[4:7], s31 offen sc1
    s_waitcnt vmcnt(0)
    v_cmp_ne_u32 vcc, 1, v5
    s_cbranch_vccz WE_71
    s_sleep 64
    s_sub_u32 s30, s30, 1
    s_cmp_lg_u32 s30, 0
    s_cbranch_scc1 WF_70
    s_endpgm
WE_71:
    s_mov_b32 s31, 49024
    v_min_u32 v4, 31, v1
    v_lshlrev_b32 v4, 2, v4
    s_mov_b32 s30, 50000
WF_72:
    buffer_load_dword v5, v4, s[4:7], s31 offen sc1
    s_waitcnt vmcnt(0)
    v_cmp_ne_u32 vcc, 1, v5
    s_cbranch_vccz WE_73
    s_sleep 3
    s_sub_u32 s30, s30, 1
    s_cmp_lg_u32 s30, 0
    s_cbranch_scc1 WF_72
    s_endpgm
WE_73:
    s_mul_i32 s26, s24, 10240
    s_lshl_b32 s38, s26, 1
    s_lshl_b32 s37, s39, 10
    s_add_u32 s38, s38, s37
    s_add_u32 s38, s38, 51298304
    s_add_u32 m0, s26, 0
    s_add_u32 s27, s38, 0
    buffer_load_dwordx4 v10, s[4:7], s27 offen sc1 lds
    s_add_u32 m0, s26, 1024
    s_add_u32 s27, s38, 2048
    buffer_load_dwordx4 v10, s[4:7], s27 offen sc1 lds
    s_add_u32 m0, s26, 2048
    s_add_u32 s27, s38, 4096
    buffer_load_dwordx4 v10, s[4:7], s27 offen sc1 lds
    s_add_u32 m0, s26, 3072
    s_add_u32 s27, s38, 6144
    buffer_load_dwordx4 v10, s[4:7], s27 offen sc1 lds
    s_add_u32 m0, s26, 4096
    s_add_u32 s27, s38, 8192
    buffer_load_dwordx4 v10, s[4:7], s27 offen sc1 lds
    s_add_u32 m0, s26, 5120
    s_add_u32 s27, s38, 10240
    buffer_load_dwordx4 v10, s[4:7], s27 offen sc1 lds
    s_add_u32 m0, s26, 6144
    s_add_u32 s27, s38, 12288
    buffer_load_dwordx4 v10, s[4:7], s27 offen sc1 lds
    s_add_u32 m0, s26, 7168
    s_add_u32 s27, s38, 14336
    buffer_load_dwordx4 v10, s[4:7], s27 offen sc1 lds
    s_add_u32 m0, s26, 8192
    s_add_u32 s27, s38, 16384
    buffer_load_dwordx4 v10, s[4:7], s27 offen sc1 lds
    s_add_u32 m0, s26, 9216
    s_add_u32 s27, s38, 18432
    buffer_load_dwordx4 v10, s[4:7], s27 offen sc1 lds
    s_lshl_b32 s31, s33, 2
    s_add_u32 s31, s31, 40704
    v_min_u32 v4, 0, v1
    v_lshlrev_b32 v4, 2, v4
    s_mov_b32 s30, 50000
WF_74:
    buffer_load_dword v5, v4, s[4:7], s31 offen sc1
    s_waitcnt vmcnt(0)
    v_cmp_ne_u32 vcc, 1, v5
    s_cbranch_vccz WE_75
    s_sleep 2
    s_sub_u32 s30, s30, 1
    s_cmp_lg_u32 s30, 0
    s_cbranch_scc1 WF_74
    s_endpgm
WE_75:
    s_lshl_b32 s38, s35, 13
    s_add_u32 s38, s38, 69206016
    buffer_load_dwordx4 a[128:131], v10, s[4:7], s38 offen offset:0 sc1
    buffer_load_dwordx4 a[132:135], v10, s[4:7], s38 offen offset:1024 sc1
    buffer_load_dwordx4 a[136:139], v10, s[4:7], s38 offen offset:2048 sc1
    buffer_load_dwordx4 a[140:143], v10, s[4:7], s38 offen offset:3072 sc1
    s_add_u32 s38, s38, 4096
    buffer_load_dwordx4 a[144:147], v10, s[4:7], s38 offen offset:0 sc1
    buffer_load_dwordx4 a[148:151], v10, s[4:7], s38 offen offset:1024 sc1
    buffer_load_dwordx4 a[152:155], v10, s[4:7], s38 offen offset:2048 sc1
    buffer_load_dwordx4 a[156:159], v10, s[4:7], s38 offen offset:3072 sc1
    s_waitcnt vmcnt(8)
    s_barrier
    ds_read_b128 v[16:19], v10 offset:0
    ds_read_b128 v[20:23], v10 offset:1024
    ds_read_b128 v[24:27], v10 offset:2048
    ds_read_b128 v[28:31], v10 offset:3072
    s_waitcnt lgkmcnt(3)
    v_mfma_f32_16x16x32_bf16 v[48:51], a[0:3], v[16:19], 0
    ds_read_b128 v[16:19], v10 offset:4096
    s_waitcnt lgkmcnt(3)
    v_mfma_f32_16x16x32_bf16 v[52:55], a[4:7], v[20:23], 0
    ds_read_b128 v[20:23], v10 offset:5120
    s_waitcnt lgkmcnt(3)
    v_mfma_f32_16x16x32_bf16 v[48:51], a[8:11], v[24:27], v[48:51]
    ds_read_b128 v[24:27], v10 offset:6144
    s_waitcnt lgkmcnt(3)
    v_mfma_f32_16x16x32_bf16 v[52:55], a[12:15], v[28:31], v[52:55]
    ds_read_b128 v[28:31], v10 offset:7168
    s_waitcnt lgkmcnt(3)
    v_mfma_f32_16x16x32_bf16 v[48:51], a[16:19], v[16:19], v[48:51]
    ds_read_b128 v[16:19], v10 offset:8192
    s_waitcnt lgkmcnt(3)
    v_mfma_f32_16x16x32_bf16 v[52:55], a[20:23], v[20:23], v[52:55]
    ds_read_b128 v[20:23], v10 offset:9216
    s_waitcnt lgkmcnt(3)
    v_mfma_f32_16x16x32_bf16 v[48:51], a[24:27], v[24:27], v[48:51]
    ds_read_b128 v[24:27], v10 offset:10240
    s_waitcnt lgkmcnt(3)
    v_mfma_f32_16x16x32_bf16 v[52:55], a[28:31], v[28:31], v[52:55]
    ds_read_b128 v[28:31], v10 offset:11264
    s_waitcnt lgkmcnt(3)
    v_mfma_f32_16x16x32_bf16 v[48:51], a[32:35], v[16:19], v[48:51]
    ds_read_b128 v[16:19], v10 offset:12288
    s_waitcnt lgkmcnt(3)
    v_mfma_f32_16x16x32_bf16 v[52:55], a[36:39], v[20:23], v[52:55]
    ds_read_b128 v[20:23], v10 offset:13312
    s_waitcnt lgkmcnt(3)
    v_mfma_f32_16x16x32_bf16 v[48:51], a[40:43], v[24:27], v[48:51]
    ds_read_b128 v[24:27], v10 offset:14336
    s_waitcnt lgkmcnt(3)
    v_mfma_f32_16x16x32_bf16 v[52:55], a[44:47], v[28:31], v[52:55]
    ds_read_b128 v[28:31], v10 offset:15360
    s_waitcnt lgkmcnt(3)
    v_mfma_f32_16x16x32_bf16 v[48:51], a[48:51], v[16:19], v[48:51]
    ds_read_b128 v[16:19], v10 offset:16384
    s_waitcnt lgkmcnt(3)
    v_mfma_f32_16x16x32_bf16 v[52:55], a[52:55], v[20:23], v[52:55]
    ds_read_b128 v[20:23], v10 offset:17408
    s_waitcnt lgkmcnt(3)
    v_mfma_f32_16x16x32_bf16 v[48:51], a[56:59], v[24:27], v[48:51]
    ds_read_b128 v[24:27], v10 offset:18432
    s_waitcnt lgkmcnt(3)
    v_mfma_f32_16x16x32_bf16 v[52:55], a[60:63], v[28:31], v[52:55]
    ds_read_b128 v[28:31], v10 offset:19456
    s_waitcnt lgkmcnt(3)
    v_mfma_f32_16x16x32_bf16 v[48:51], a[64:67], v[16:19], v[48:51]
    ds_read_b128 v[16:19], v10 offset:20480
    s_waitcnt lgkmcnt(3)
    v_mfma_f32_16x16x32_bf16 v[52:55], a[68:71], v[20:23], v[52:55]
    ds_read_b128 v[20:23], v10 offset:21504
    s_waitcnt lgkmcnt(3)
    v_mfma_f32_16x16x32_bf16 v[48:51], a[72:75], v[24:27], v[48:51]
    ds_read_b128 v[24:27], v10 offset:22528
    s_waitcnt lgkmcnt(3)
    v_mfma_f32_16x16x32_bf16 v[52:55], a[76:79], v[28:31], v[52:55]
    ds_read_b128 v[28:31], v10 offset:23552
    s_waitcnt lgkmcnt(3)
    v_mfma_f32_16x16x32_bf16 v[48:51], a[80:83], v[16:19], v[48:51]
    ds_read_b128 v[16:19], v10 offset:24576
    s_waitcnt lgkmcnt(3)
    v_mfma_f32_16x16x32_bf16 v[52:55], a[84:87], v[20:23], v[52:55]
    ds_read_b128 v[20:23], v10 offset:25600
    s_waitcnt lgkmcnt(3)
    v_mfma_f32_16x16x32_bf16 v[48:51], a[88:91], v[24:27], v[48:51]
    ds_read_b128 v[24:27], v10 offset:26624
    s_waitcnt lgkmcnt(3)
    v_mfma_f32_16x16x32_bf16 v[52:55], a[92:95], v[28:31], v[52:55]
    ds_read_b128 v[28:31], v10 offset:27648
    s_waitcnt lgkmcnt(3)
    v_mfma_f32_16x16x32_bf16 v[48:51], a[96:99], v[16:19], v[48:51]
    ds_read_b128 v[16:19], v10 offset:28672
    s_waitcnt lgkmcnt(3)
    v_mfma_f32_16x16x32_bf16 v[52:55], a[100:103], v[20:23], v[52:55]
    ds_read_b128 v[20:23], v10 offset:29696
    s_waitcnt lgkmcnt(3)
    v_mfma_f32_16x16x32_bf16 v[48:51], a[104:107], v[24:27], v[48:51]
    ds_read_b128 v[24:27], v10 offset:30720
    s_waitcnt lgkmcnt(3)
    v_mfma_f32_16x16x32_bf16 v[52:55], a[108:111], v[28:31], v[52:55]
    ds_read_b128 v[28:31], v10 offset:31744
    s_waitcnt lgkmcnt(3)
    v_mfma_f32_16x16x32_bf16 v[48:51], a[112:115], v[16:19], v[48:51]
    ds_read_b128 v[16:19], v10 offset:32768
    s_waitcnt lgkmcnt(3)
    v_mfma_f32_16x16x32_bf16 v[52:55], a[116:119], v[20:23], v[52:55]
    ds_read_b128 v[20:23], v10 offset:33792
    s_waitcnt lgkmcnt(3)
    v_mfma_f32_16x16x32_bf16 v[48:51], a[120:123], v[24:27], v[48:51]
    ds_read_b128 v[24:27], v10 offset:34816
    s_waitcnt lgkmcnt(3)
    v_mfma_f32_16x16x32_bf16 v[52:55], a[124:127], v[28:31], v[52:55]
    ds_read_b128 v[28:31], v10 offset:35840
    s_waitcnt lgkmcnt(3) vmcnt(7)
    v_mfma_f32_16x16x32_bf16 v[48:51], a[128:131], v[16:19], v[48:51]
    ds_read_b128 v[16:19], v10 offset:36864
    s_waitcnt lgkmcnt(3) vmcnt(6)
    v_mfma_f32_16x16x32_bf16 v[52:55], a[132:135], v[20:23], v[52:55]
    ds_read_b128 v[20:23], v10 offset:37888
    s_waitcnt lgkmcnt(3) vmcnt(5)
    v_mfma_f32_16x16x32_bf16 v[48:51], a[136:139], v[24:27], v[48:51]
    ds_read_b128 v[24:27], v10 offset:38912
    s_waitcnt lgkmcnt(3) vmcnt(4)
    v_mfma_f32_16x16x32_bf16 v[52:55], a[140:143], v[28:31], v[52:55]
    ds_read_b128 v[28:31], v10 offset:39936
    s_waitcnt lgkmcnt(3) vmcnt(3)
    v_mfma_f32_16x16x32_bf16 v[48:51], a[144:147], v[16:19], v[48:51]
    s_waitcnt lgkmcnt(2) vmcnt(2)
    v_mfma_f32_16x16x32_bf16 v[52:55], a[148:151], v[20:23], v[52:55]
    s_waitcnt lgkmcnt(1) vmcnt(1)
    v_mfma_f32_16x16x32_bf16 v[48:51], a[152:155], v[24:27], v[48:51]
    s_waitcnt lgkmcnt(0) vmcnt(0)
    v_mfma_f32_16x16x32_bf16 v[52:55], a[156:159], v[28:31], v[52:55]
    s_nop 7
    v_add_f32 v48, v48, v52
    v_add_f32 v49, v49, v53
    v_add_f32 v50, v50, v54
    v_add_f32 v51, v51, v55
    v_cvt_pk_bf16_f32 v16, v48, v49
    v_cvt_pk_bf16_f32 v17, v50, v51
    v_mul_u32_u24 v12, 2560, v2
    v_lshlrev_b32 v4, 3, v3
    v_add_u32 v12, v12, v4
    s_mul_i32 s36, s39, 40960
    s_lshl_b32 s37, s33, 5
    s_add_u32 s36, s36, s37
    s_add_u32 s36, s36, 5162240
    buffer_store_dwordx2 v[16:17], v12, s[16:19], s36 offen
    s_branch POOL
PEXIT:
    s_branch EXIT
R_QKR:
    s_mov_b32 s32, s25
    s_mov_b32 s8, s74
    s_mov_b32 s9, s75
    s_mov_b32 s10, 5242880
    s_mov_b32 s11, 0x00020000
    s_mov_b32 s12, s76
    s_mov_b32 s13, s77
    s_mov_b32 s14, 5242880
    s_mov_b32 s15, 0x00020000
    v_lshrrev_b32 v10, 4, v1
    v_mov_b32 v4, s24
    v_mul_u32_u24 v4, 4, v4
    v_add_u32 v10, v10, v4
    v_mul_u32_u24 v10, 8192, v10
    v_and_b32 v4, 15, v1
    v_lshrrev_b32 v5, 4, v1
    v_lshlrev_b32 v5, 1, v5
    v_xor_b32 v4, v4, v5
    v_lshlrev_b32 v4, 4, v4
    v_add_u32 v10, v10, v4
    v_mul_u32_u24 v11, 2176, v3
    v_and_b32 v4, 15, v1
    v_lshrrev_b32 v4, 2, v4
    v_lshlrev_b32 v4, 8, v4
    v_add_u32 v11, v11, v4
    v_mov_b32 v4, s24
    v_mul_u32_u24 v4, 2, v4
    v_add_u32 v4, 0, v4
    v_and_b32 v5, 15, v1
    v_lshrrev_b32 v5, 2, v5
    v_xor_b32 v4, v4, v5
    v_lshlrev_b32 v4, 5, v4
    v_add_u32 v11, v11, v4
    v_and_b32 v4, 3, v1
    v_lshlrev_b32 v4, 3, v4
    v_add_u32 v11, v11, v4
    v_add_u32 v13, 69632, v11
    v_mul_u32_u24 v12, 2176, v3
    v_and_b32 v4, 15, v1
    v_lshrrev_b32 v4, 2, v4
    v_lshlrev_b32 v4, 8, v4
    v_add_u32 v12, v12, v4
    v_mov_b32 v4, s24
    v_mul_u32_u24 v4, 2, v4
    v_add_u32 v4, 1, v4
    v_and_b32 v5, 15, v1
    v_lshrrev_b32 v5, 2, v5
    v_xor_b32 v4, v4, v5
    v_lshlrev_b32 v4, 5, v4
    v_add_u32 v12, v12, v4
    v_and_b32 v4, 3, v1
    v_lshlrev_b32 v4, 3, v4
    v_add_u32 v12, v12, v4
    v_add_u32 v14, 69632, v12
    s_lshl_b32 s28, s32, 8
    s_mul_i32 s26, s24, 1088
    s_add_u32 m0, s26, 0
    s_add_u32 s27, s28, 0
    buffer_load_dwordx4 v10, s[8:11], s27 offen lds
    s_add_u32 m0, s26, 4352
    s_add_u32 s27, s28, 131072
    buffer_load_dwordx4 v10, s[8:11], s27 offen lds
    s_add_u32 m0, s26, 8704
    s_add_u32 s27, s28, 262144
    buffer_load_dwordx4 v10, s[8:11], s27 offen lds
    s_add_u32 m0, s26, 13056
    s_add_u32 s27, s28, 393216
    buffer_load_dwordx4 v10, s[8:11], s27 offen lds
    s_add_u32 m0, s26, 17408
    s_add_u32 s27, s28, 524288
    buffer_load_dwordx4 v10, s[8:11], s27 offen lds
    s_add_u32 m0, s26, 21760
    s_add_u32 s27, s28, 655360
    buffer_load_dwordx4 v10, s[8:11], s27 offen lds
    s_add_u32 m0, s26, 26112
    s_add_u32 s27, s28, 786432
    buffer_load_dwordx4 v10, s[8:11], s27 offen lds
    s_add_u32 m0, s26, 30464
    s_add_u32 s27, s28, 917504
    buffer_load_dwordx4 v10, s[8:11], s27 offen lds
    s_add_u32 m0, s26, 34816
    s_add_u32 s27, s28, 0
    buffer_load_dwordx4 v10, s[12:15], s27 offen lds
    s_add_u32 m0, s26, 39168
    s_add_u32 s27, s28, 131072
    buffer_load_dwordx4 v10, s[12:15], s27 offen lds
    s_add_u32 m0, s26, 43520
    s_add_u32 s27, s28, 262144
    buffer_load_dwordx4 v10, s[12:15], s27 offen lds
    s_add_u32 m0, s26, 47872
    s_add_u32 s27, s28, 393216
    buffer_load_dwordx4 v10, s[12:15], s27 offen lds
    s_add_u32 m0, s26, 52224
    s_add_u32 s27, s28, 524288
    buffer_load_dwordx4 v10, s[12:15], s27 offen lds
    s_add_u32 m0, s26, 56576
    s_add_u32 s27, s28, 655360
    buffer_load_dwordx4 v10, s[12:15], s27 offen lds
    s_add_u32 m0, s26, 60928
    s_add_u32 s27, s28, 786432
    buffer_load_dwordx4 v10, s[12:15], s27 offen lds
    s_add_u32 m0, s26, 65280
    s_add_u32 s27, s28, 917504
    buffer_load_dwordx4 v10, s[12:15], s27 offen lds
    s_add_u32 m0, s26, 69632
    s_add_u32 s27, s28, 1048576
    buffer_load_dwordx4 v10, s[8:11], s27 offen lds
    s_add_u32 m0, s26, 73984
    s_add_u32 s27, s28, 1179648
    buffer_load_dwordx4 v10, s[8:11], s27 offen lds
    s_add_u32 m0, s26, 78336
    s_add_u32 s27, s28, 1310720
    buffer_load_dwordx4 v10, s[8:11], s27 offen lds
    s_add_u32 m0, s26, 82688
    s_add_u32 s27, s28, 1441792
    buffer_load_dwordx4 v10, s[8:11], s27 offen lds
    s_add_u32 m0, s26, 87040
    s_add_u32 s27, s28, 1572864
    buffer_load_dwordx4 v10, s[8:11], s27 offen lds
    s_add_u32 m0, s26, 91392
    s_add_u32 s27, s28, 1703936
    buffer_load_dwordx4 v10, s[8:11], s27 offen lds
    s_add_u32 m0, s26, 95744
    s_add_u32 s27, s28, 1835008
    buffer_load_dwordx4 v10, s[8:11], s27 offen lds
    s_add_u32 m0, s26, 100096
    s_add_u32 s27, s28, 1966080
    buffer_load_dwordx4 v10, s[8:11], s27 offen lds
    s_add_u32 m0, s26, 104448
    s_add_u32 s27, s28, 1048576
    buffer_load_dwordx4 v10, s[12:15], s27 offen lds
    s_add_u32 m0, s26, 108800
    s_add_u32 s27, s28, 1179648
    buffer_load_dwordx4 v10, s[12:15], s27 offen lds
    s_add_u32 m0, s26, 113152
    s_add_u32 s27, s28, 1310720
    buffer_load_dwordx4 v10, s[12:15], s27 offen lds
    s_add_u32 m0, s26, 117504
    s_add_u32 s27, s28, 1441792
    buffer_load_dwordx4 v10, s[12:15], s27 offen lds
    s_add_u32 m0, s26, 121856
    s_add_u32 s27, s28, 1572864
    buffer_load_dwordx4 v10, s[12:15], s27 offen lds
    s_add_u32 m0, s26, 126208
    s_add_u32 s27, s28, 1703936
    buffer_load_dwordx4 v10, s[12:15], s27 offen lds
    s_add_u32 m0, s26, 130560
    s_add_u32 s27, s28, 1835008
    buffer_load_dwordx4 v10, s[12:15], s27 offen lds
    s_add_u32 m0, s26, 134912
    s_add_u32 s27, s28, 1966080
    buffer_load_dwordx4 v10, s[12:15], s27 offen lds
    s_waitcnt vmcnt(16)
    s_barrier
    ds_read_b64_tr_b16 a[0:1], v11 offset:0
    ds_read_b64_tr_b16 a[2:3], v11 offset:1088
    ds_read_b64_tr_b16 a[4:5], v11 offset:8704
    ds_read_b64_tr_b16 a[6:7], v11 offset:9792
    ds_read_b64_tr_b16 a[8:9], v11 offset:17408
    ds_read_b64_tr_b16 a[10:11], v11 offset:18496
    ds_read_b64_tr_b16 a[12:13], v11 offset:26112
    ds_read_b64_tr_b16 a[14:15], v11 offset:27200
    ds_read_b64_tr_b16 a[80:81], v12 offset:0
    ds_read_b64_tr_b16 a[82:83], v12 offset:1088
    ds_read_b64_tr_b16 a[84:85], v12 offset:8704
    ds_read_b64_tr_b16 a[86:87], v12 offset:9792
    ds_read_b64_tr_b16 a[88:89], v12 offset:17408
    ds_read_b64_tr_b16 a[90:91], v12 offset:18496
    ds_read_b64_tr_b16 a[92:93], v12 offset:26112
    ds_read_b64_tr_b16 a[94:95], v12 offset:27200
    ds_read_b64_tr_b16 a[160:161], v11 offset:34816
    ds_read_b64_tr_b16 a[162:163], v11 offset:35904
    ds_read_b64_tr_b16 a[164:165], v11 offset:43520
    ds_read_b64_tr_b16 a[166:167], v11 offset:44608
    ds_read_b64_tr_b16 a[168:169], v11 offset:52224
    ds_read_b64_tr_b16 a[170:171], v11 offset:53312
    ds_read_b64_tr_b16 a[172:173], v11 offset:60928
    ds_read_b64_tr_b16 a[174:175], v11 offset:62016
    ds_read_b64_tr_b16 a[240:241], v12 offset:34816
    ds_read_b64_tr_b16 a[242:243], v12 offset:35904
    ds_read_b64_tr_b16 a[244:245], v12 offset:43520
    ds_read_b64_tr_b16 a[246:247], v12 offset:44608
    ds_read_b64_tr_b16 a[248:249], v12 offset:52224
    ds_read_b64_tr_b16 a[250:251], v12 offset:53312
    ds_read_b64_tr_b16 a[252:253], v12 offset:60928
    ds_read_b64_tr_b16 a[254:255], v12 offset:62016
    s_waitcnt lgkmcnt(0)
    s_barrier
    s_add_u32 m0, s26, 0
    s_add_u32 s27, s28, 2097152
    buffer_load_dwordx4 v10, s[8:11], s27 offen lds
    s_add_u32 m0, s26, 4352
    s_add_u32 s27, s28, 2228224
    buffer_load_dwordx4 v10, s[8:11], s27 offen lds
    s_add_u32 m0, s26, 8704
    s_add_u32 s27, s28, 2359296
    buffer_load_dwordx4 v10, s[8:11], s27 offen lds
    s_add_u32 m0, s26, 13056
    s_add_u32 s27, s28, 2490368
    buffer_load_dwordx4 v10, s[8:11], s27 offen lds
    s_add_u32 m0, s26, 17408
    s_add_u32 s27, s28, 2621440
    buffer_load_dwordx4 v10, s[8:11], s27 offen lds
    s_add_u32 m0, s26, 21760
    s_add_u32 s27, s28, 2752512
    buffer_load_dwordx4 v10, s[8:11], s27 offen lds
    s_add_u32 m0, s26, 26112
    s_add_u32 s27, s28, 2883584
    buffer_load_dwordx4 v10, s[8:11], s27 offen lds
    s_add_u32 m0, s26, 30464
    s_add_u32 s27, s28, 3014656
    buffer_load_dwordx4 v10, s[8:11], s27 offen lds
    s_add_u32 m0, s26, 34816
    s_add_u32 s27, s28, 2097152
    buffer_load_dwordx4 v10, s[12:15], s27 offen lds
    s_add_u32 m0, s26, 39168
    s_add_u32 s27, s28, 2228224
    buffer_load_dwordx4 v10, s[12:15], s27 offen lds
    s_add_u32 m0, s26, 43520
    s_add_u32 s27, s28, 2359296
    buffer_load_dwordx4 v10, s[12:15], s27 offen lds
    s_add_u32 m0, s26, 47872
    s_add_u32 s27, s28, 2490368
    buffer_load_dwordx4 v10, s[12:15], s27 offen lds
    s_add_u32 m0, s26, 52224
    s_add_u32 s27, s28, 2621440
    buffer_load_dwordx4 v10, s[12:15], s27 offen lds
    s_add_u32 m0, s26, 56576
    s_add_u32 s27, s28, 2752512
    buffer_load_dwordx4 v10, s[12:15], s27 offen lds
    s_add_u32 m0, s26, 60928
    s_add_u32 s27, s28, 2883584
    buffer_load_dwordx4 v10, s[12:15], s27 offen lds
    s_add_u32 m0, s26, 65280
    s_add_u32 s27, s28, 3014656
    buffer_load_dwordx4 v10, s[12:15], s27 offen lds
    s_waitcnt vmcnt(16)
    s_barrier
    ds_read_b64_tr_b16 a[16:17], v13 offset:0
    ds_read_b64_tr_b16 a[18:19], v13 offset:1088
    ds_read_b64_tr_b16 a[20:21], v13 offset:8704
    ds_read_b64_tr_b16 a[22:23], v13 offset:9792
    ds_read_b64_tr_b16 a[24:25], v13 offset:17408
    ds_read_b64_tr_b16 a[26:27], v13 offset:18496
    ds_read_b64_tr_b16 a[28:29], v13 offset:26112
    ds_read_b64_tr_b16 a[30:31], v13 offset:27200
    ds_read_b64_tr_b16 a[96:97], v14 offset:0
    ds_read_b64_tr_b16 a[98:99], v14 offset:1088
    ds_read_b64_tr_b16 a[100:101], v14 offset:8704
    ds_read_b64_tr_b16 a[102:103], v14 offset:9792
    ds_read_b64_tr_b16 a[104:105], v14 offset:17408
    ds_read_b64_tr_b16 a[106:107], v14 offset:18496
    ds_read_b64_tr_b16 a[108:109], v14 offset:26112
    ds_read_b64_tr_b16 a[110:111], v14 offset:27200
    ds_read_b64_tr_b16 a[176:177], v13 offset:34816
    ds_read_b64_tr_b16 a[178:179], v13 offset:35904
    ds_read_b64_tr_b16 a[180:181], v13 offset:43520
    ds_read_b64_tr_b16 a[182:183], v13 offset:44608
    ds_read_b64_tr_b16 a[184:185], v13 offset:52224
    ds_read_b64_tr_b16 a[186:187], v13 offset:53312
    ds_read_b64_tr_b16 a[188:189], v13 offset:60928
    ds_read_b64_tr_b16 a[190:191], v13 offset:62016
    ds_read_b64_tr_b16 v[192:193], v14 offset:34816
    ds_read_b64_tr_b16 v[194:195], v14 offset:35904
    ds_read_b64_tr_b16 v[196:197], v14 offset:43520
    ds_read_b64_tr_b16 v[198:199], v14 offset:44608
    ds_read_b64_tr_b16 v[200:201], v14 offset:52224
    ds_read_b64_tr_b16 v[202:203], v14 offset:53312
    ds_read_b64_tr_b16 v[204:205], v14 offset:60928
    ds_read_b64_tr_b16 v[206:207], v14 offset:62016
    s_waitcnt lgkmcnt(0)
    s_barrier
    s_add_u32 m0, s26, 69632
    s_add_u32 s27, s28, 3145728
    buffer_load_dwordx4 v10, s[8:11], s27 offen lds
    s_add_u32 m0, s26, 73984
    s_add_u32 s27, s28, 3276800
    buffer_load_dwordx4 v10, s[8:11], s27 offen lds
    s_add_u32 m0, s26, 78336
    s_add_u32 s27, s28, 3407872
    buffer_load_dwordx4 v10, s[8:11], s27 offen lds
    s_add_u32 m0, s26, 82688
    s_add_u32 s27, s28, 3538944
    buffer_load_dwordx4 v10, s[8:11], s27 offen lds
    s_add_u32 m0, s26, 87040
    s_add_u32 s27, s28, 3670016
    buffer_load_dwordx4 v10, s[8:11], s27 offen lds
    s_add_u32 m0, s26, 91392
    s_add_u32 s27, s28, 3801088
    buffer_load_dwordx4 v10, s[8:11], s27 offen lds
    s_add_u32 m0, s26, 95744
    s_add_u32 s27, s28, 3932160
    buffer_load_dwordx4 v10, s[8:11], s27 offen lds
    s_add_u32 m0, s26, 100096
    s_add_u32 s27, s28, 4063232
    buffer_load_dwordx4 v10, s[8:11], s27 offen lds
    s_add_u32 m0, s26, 104448
    s_add_u32 s27, s28, 3145728
    buffer_load_dwordx4 v10, s[12:15], s27 offen lds
    s_add_u32 m0, s26, 108800
    s_add_u32 s27, s28, 3276800
    buffer_load_dwordx4 v10, s[12:15], s27 offen lds
    s_add_u32 m0, s26, 113152
    s_add_u32 s27, s28, 3407872
    buffer_load_dwordx4 v10, s[12:15], s27 offen lds
    s_add_u32 m0, s26, 117504
    s_add_u32 s27, s28, 3538944
    buffer_load_dwordx4 v10, s[12:15], s27 offen lds
    s_add_u32 m0, s26, 121856
    s_add_u32 s27, s28, 3670016
    buffer_load_dwordx4 v10, s[12:15], s27 offen lds
    s_add_u32 m0, s26, 126208
    s_add_u32 s27, s28, 3801088
    buffer_load_dwordx4 v10, s[12:15], s27 offen lds
    s_add_u32 m0, s26, 130560
    s_add_u32 s27, s28, 3932160
    buffer_load_dwordx4 v10, s[12:15], s27 offen lds
    s_add_u32 m0, s26, 134912
    s_add_u32 s27, s28, 4063232
    buffer_load_dwordx4 v10, s[12:15], s27 offen lds
    s_waitcnt vmcnt(16)
    s_barrier
    ds_read_b64_tr_b16 a[32:33], v11 offset:0
    ds_read_b64_tr_b16 a[34:35], v11 offset:1088
    ds_read_b64_tr_b16 a[36:37], v11 offset:8704
    ds_read_b64_tr_b16 a[38:39], v11 offset:9792
    ds_read_b64_tr_b16 a[40:41], v11 offset:17408
    ds_read_b64_tr_b16 a[42:43], v11 offset:18496
    ds_read_b64_tr_b16 a[44:45], v11 offset:26112
    ds_read_b64_tr_b16 a[46:47], v11 offset:27200
    ds_read_b64_tr_b16 a[112:113], v12 offset:0
    ds_read_b64_tr_b16 a[114:115], v12 offset:1088
    ds_read_b64_tr_b16 a[116:117], v12 offset:8704
    ds_read_b64_tr_b16 a[118:119], v12 offset:9792
    ds_read_b64_tr_b16 a[120:121], v12 offset:17408
    ds_read_b64_tr_b16 a[122:123], v12 offset:18496
    ds_read_b64_tr_b16 a[124:125], v12 offset:26112
    ds_read_b64_tr_b16 a[126:127], v12 offset:27200
    ds_read_b64_tr_b16 a[192:193], v11 offset:34816
    ds_read_b64_tr_b16 a[194:195], v11 offset:35904
    ds_read_b64_tr_b16 a[196:197], v11 offset:43520
    ds_read_b64_tr_b16 a[198:199], v11 offset:44608
    ds_read_b64_tr_b16 a[200:201], v11 offset:52224
    ds_read_b64_tr_b16 a[202:203], v11 offset:53312
    ds_read_b64_tr_b16 a[204:205], v11 offset:60928
    ds_read_b64_tr_b16 a[206:207], v11 offset:62016
    ds_read_b64_tr_b16 v[208:209], v12 offset:34816
    ds_read_b64_tr_b16 v[210:211], v12 offset:35904
    ds_read_b64_tr_b16 v[212:213], v12 offset:43520
    ds_read_b64_tr_b16 v[214:215], v12 offset:44608
    ds_read_b64_tr_b16 v[216:217], v12 offset:52224
    ds_read_b64_tr_b16 v[218:219], v12 offset:53312
    ds_read_b64_tr_b16 v[220:221], v12 offset:60928
    ds_read_b64_tr_b16 v[222:223], v12 offset:62016
    s_waitcnt lgkmcnt(0)
    s_barrier
    s_add_u32 m0, s26, 0
    s_add_u32 s27, s28, 4194304
    buffer_load_dwordx4 v10, s[8:11], s27 offen lds
    s_add_u32 m0, s26, 4352
    s_add_u32 s27, s28, 4325376
    buffer_load_dwordx4 v10, s[8:11], s27 offen lds
    s_add_u32 m0, s26, 8704
    s_add_u32 s27, s28, 4456448
    buffer_load_dwordx4 v10, s[8:11], s27 offen lds
    s_add_u32 m0, s26, 13056
    s_add_u32 s27, s28, 4587520
    buffer_load_dwordx4 v10, s[8:11], s27 offen lds
    s_add_u32 m0, s26, 17408
    s_add_u32 s27, s28, 4718592
    buffer_load_dwordx4 v10, s[8:11], s27 offen lds
    s_add_u32 m0, s26, 21760
    s_add_u32 s27, s28, 4849664
    buffer_load_dwordx4 v10, s[8:11], s27 offen lds
    s_add_u32 m0, s26, 26112
    s_add_u32 s27, s28, 4980736
    buffer_load_dwordx4 v10, s[8:11], s27 offen lds
    s_add_u32 m0, s26, 30464
    s_add_u32 s27, s28, 5111808
    buffer_load_dwordx4 v10, s[8:11], s27 offen lds
    s_add_u32 m0, s26, 34816
    s_add_u32 s27, s28, 4194304
    buffer_load_dwordx4 v10, s[12:15], s27 offen lds
    s_add_u32 m0, s26, 39168
    s_add_u32 s27, s28, 4325376
    buffer_load_dwordx4 v10, s[12:15], s27 offen lds
    s_add_u32 m0, s26, 43520
    s_add_u32 s27, s28, 4456448
    buffer_load_dwordx4 v10, s[12:15], s27 offen lds
    s_add_u32 m0, s26, 47872
    s_add_u32 s27, s28, 4587520
    buffer_load_dwordx4 v10, s[12:15], s27 offen lds
    s_add_u32 m0, s26, 52224
    s_add_u32 s27, s28, 4718592
    buffer_load_dwordx4 v10, s[12:15], s27 offen lds
    s_add_u32 m0, s26, 56576
    s_add_u32 s27, s28, 4849664
    buffer_load_dwordx4 v10, s[12:15], s27 offen lds
    s_add_u32 m0, s26, 60928
    s_add_u32 s27, s28, 4980736
    buffer_load_dwordx4 v10, s[12:15], s27 offen lds
    s_add_u32 m0, s26, 65280
    s_add_u32 s27, s28, 5111808
    buffer_load_dwordx4 v10, s[12:15], s27 offen lds
    s_waitcnt vmcnt(16)
    s_barrier
    ds_read_b64_tr_b16 a[48:49], v13 offset:0
    ds_read_b64_tr_b16 a[50:51], v13 offset:1088
    ds_read_b64_tr_b16 a[52:53], v13 offset:8704
    ds_read_b64_tr_b16 a[54:55], v13 offset:9792
    ds_read_b64_tr_b16 a[56:57], v13 offset:17408
    ds_read_b64_tr_b16 a[58:59], v13 offset:18496
    ds_read_b64_tr_b16 a[60:61], v13 offset:26112
    ds_read_b64_tr_b16 a[62:63], v13 offset:27200
    ds_read_b64_tr_b16 a[128:129], v14 offset:0
    ds_read_b64_tr_b16 a[130:131], v14 offset:1088
    ds_read_b64_tr_b16 a[132:133], v14 offset:8704
    ds_read_b64_tr_b16 a[134:135], v14 offset:9792
    ds_read_b64_tr_b16 a[136:137], v14 offset:17408
    ds_read_b64_tr_b16 a[138:139], v14 offset:18496
    ds_read_b64_tr_b16 a[140:141], v14 offset:26112
    ds_read_b64_tr_b16 a[142:143], v14 offset:27200
    ds_read_b64_tr_b16 a[208:209], v13 offset:34816
    ds_read_b64_tr_b16 a[210:211], v13 offset:35904
    ds_read_b64_tr_b16 a[212:213], v13 offset:43520
    ds_read_b64_tr_b16 a[214:215], v13 offset:44608
    ds_read_b64_tr_b16 a[216:217], v13 offset:52224
    ds_read_b64_tr_b16 a[218:219], v13 offset:53312
    ds_read_b64_tr_b16 a[220:221], v13 offset:60928
    ds_read_b64_tr_b16 a[222:223], v13 offset:62016
    ds_read_b64_tr_b16 v[224:225], v14 offset:34816
    ds_read_b64_tr_b16 v[226:227], v14 offset:35904
    ds_read_b64_tr_b16 v[228:229], v14 offset:43520
    ds_read_b64_tr_b16 v[230:231], v14 offset:44608
    ds_read_b64_tr_b16 v[232:233], v14 offset:52224
    ds_read_b64_tr_b16 v[234:235], v14 offset:53312
    ds_read_b64_tr_b16 v[236:237], v14 offset:60928
    ds_read_b64_tr_b16 v[238:239], v14 offset:62016
    s_waitcnt lgkmcnt(0)
    s_barrier
    s_waitcnt vmcnt(0)
    s_barrier
    ds_read_b64_tr_b16 a[64:65], v11 offset:0
    ds_read_b64_tr_b16 a[66:67], v11 offset:1088
    ds_read_b64_tr_b16 a[68:69], v11 offset:8704
    ds_read_b64_tr_b16 a[70:71], v11 offset:9792
    ds_read_b64_tr_b16 a[72:73], v11 offset:17408
    ds_read_b64_tr_b16 a[74:75], v11 offset:18496
    ds_read_b64_tr_b16 a[76:77], v11 offset:26112
    ds_read_b64_tr_b16 a[78:79], v11 offset:27200
    ds_read_b64_tr_b16 a[144:145], v12 offset:0
    ds_read_b64_tr_b16 a[146:147], v12 offset:1088
    ds_read_b64_tr_b16 a[148:149], v12 offset:8704
    ds_read_b64_tr_b16 a[150:151], v12 offset:9792
    ds_read_b64_tr_b16 a[152:153], v12 offset:17408
    ds_read_b64_tr_b16 a[154:155], v12 offset:18496
    ds_read_b64_tr_b16 a[156:157], v12 offset:26112
    ds_read_b64_tr_b16 a[158:159], v12 offset:27200
    ds_read_b64_tr_b16 a[224:225], v11 offset:34816
    ds_read_b64_tr_b16 a[226:227], v11 offset:35904
    ds_read_b64_tr_b16 a[228:229], v11 offset:43520
    ds_read_b64_tr_b16 a[230:231], v11 offset:44608
    ds_read_b64_tr_b16 a[232:233], v11 offset:52224
    ds_read_b64_tr_b16 a[234:235], v11 offset:53312
    ds_read_b64_tr_b16 a[236:237], v11 offset:60928
    ds_read_b64_tr_b16 a[238:239], v11 offset:62016
    ds_read_b64_tr_b16 v[240:241], v12 offset:34816
    ds_read_b64_tr_b16 v[242:243], v12 offset:35904
    ds_read_b64_tr_b16 v[244:245], v12 offset:43520
    ds_read_b64_tr_b16 v[246:247], v12 offset:44608
    ds_read_b64_tr_b16 v[248:249], v12 offset:52224
    ds_read_b64_tr_b16 v[250:251], v12 offset:53312
    ds_read_b64_tr_b16 v[252:253], v12 offset:60928
    ds_read_b64_tr_b16 v[254:255], v12 offset:62016
    s_waitcnt lgkmcnt(0)
    s_barrier
    v_lshrrev_b32 v30, 3, v2
    v_mul_u32_u24 v30, 43690, v30
    v_add_u32 v30, 17476, v30
    v_lshlrev_b32 v10, 4, v1
    v_mov_b32 v4, s24
    v_mul_u32_u24 v4, 5120, v4
    v_add_u32 v10, v10, v4
    v_lshlrev_b32 v11, 4, v1
    v_mov_b32 v12, s24
    v_lshlrev_b32 v12, 3, v12
    v_and_b32 v4, 1, v3
    v_lshlrev_b32 v4, 2, v4
    v_add_u32 v12, v12, v4
    v_lshrrev_b32 v4, 1, v3
    v_add_u32 v12, v12, v4
    v_lshlrev_b32 v12, 6, v12
    v_lshlrev_b32 v4, 2, v2
    v_add_u32 v12, v12, v4
    v_lshlrev_b32 v13, 4, v1
    v_mov_b32 v4, s24
    v_mul_u32_u24 v4, 5120, v4
    v_add_u32 v13, v13, v4
    v_lshlrev_b32 v14, 4, v1
    v_mov_b32 v4, s24
    v_mul_u32_u24 v4, 13312, v4
    v_add_u32 v14, v14, v4
    v_add_u32 v14, 3072, v14
    v_add_u32 v15, 1024, v14
    v_and_b32 v17, 7, v2
    v_lshlrev_b32 v17, 6, v17
    v_lshlrev_b32 v4, 4, v3
    v_add_u32 v17, v17, v4
    v_add_u32 v17, 10240, v17
    v_and_b32 v18, 1, v2
    v_and_b32 v4, 2, v2
    v_lshlrev_b32 v4, 1, v4
    v_add_u32 v18, v18, v4
    v_and_b32 v4, 4, v2
    v_lshrrev_b32 v4, 1, v4
    v_add_u32 v18, v18, v4
    v_lshlrev_b32 v18, 6, v18
    v_lshlrev_b32 v4, 4, v3
    v_add_u32 v18, v18, v4
    v_add_u32 v18, 12288, v18
    v_mov_b32 v19, s32
    v_lshrrev_b32 v19, 1, v19
    v_lshlrev_b32 v19, 10, v19
    v_mov_b32 v4, s32
    v_lshrrev_b32 v4, 4, v4
    v_lshlrev_b32 v4, 13, v4
    v_add_u32 v19, v19, v4
    v_mov_b32 v4, s32
    v_and_b32 v4, 1, v4
    v_lshlrev_b32 v4, 1, v4
    v_lshrrev_b32 v5, 1, v3
    v_add_u32 v4, v4, v5
    v_lshlrev_b32 v4, 8, v4
    v_add_u32 v19, v19, v4
    v_lshlrev_b32 v4, 4, v2
    v_add_u32 v19, v19, v4
    v_mov_b32 v16, s32
    v_lshrrev_b32 v16, 3, v16
    v_lshlrev_b32 v16, 10, v16
    v_mov_b32 v4, s32
    v_and_b32 v4, 7, v4
    v_lshrrev_b32 v4, 1, v4
    v_lshlrev_b32 v4, 8, v4
    v_add_u32 v16, v16, v4
    v_and_b32 v4, 1, v3
    v_lshlrev_b32 v4, 3, v4
    v_and_b32 v5, 7, v2
    v_add_u32 v4, v4, v5
    v_lshlrev_b32 v4, 4, v4
    v_add_u32 v16, v16, v4
    v_mov_b32 v4, s32
    v_and_b32 v4, 1, v4
    v_lshlrev_b32 v4, 3, v4
    v_add_u32 v16, v16, v4
    v_add_u32 v16, 32768, v16
    v_mov_b32 v26, s32
    v_lshlrev_b32 v26, 2, v26
    v_add_u32 v26, 0, v26
    v_and_b32 v21, 3, v2
    v_lshrrev_b32 v21, 1, v21
    v_lshlrev_b32 v21, 12, v21
    v_lshlrev_b32 v4, 8, v3
    v_add_u32 v21, v21, v4
    v_lshrrev_b32 v4, 2, v2
    v_lshlrev_b32 v4, 2, v4
    v_and_b32 v5, 1, v2
    v_add_u32 v4, v4, v5
    v_lshlrev_b32 v4, 4, v4
    v_add_u32 v21, v21, v4
    v_add_u32 v27, 14336, v11
    v_and_b32 v22, 7, v2
    v_lshlrev_b32 v22, 6, v22
    v_lshlrev_b32 v4, 4, v3
    v_add_u32 v22, v22, v4
    v_add_u32 v22, 12288, v22
    v_lshlrev_b32 v23, 4, v1
    v_mov_b32 v4, s24
    v_and_b32 v4, 1, v4
    v_lshlrev_b32 v4, 12, v4
    v_add_u32 v23, v23, v4
    v_add_u32 v23, 32768, v23
    v_lshlrev_b32 v24, 4, v1
    v_mov_b32 v4, s24
    v_and_b32 v4, 1, v4
    v_lshlrev_b32 v4, 10, v4
    v_add_u32 v24, v24, v4
    v_mov_b32 v4, s32
    v_lshlrev_b32 v4, 11, v4
    v_add_u32 v24, v24, v4
    v_mov_b32 v25, s32
    v_lshrrev_b32 v25, 2, v25
    v_lshlrev_b32 v25, 11, v25
    v_mov_b32 v4, s24
    v_and_b32 v4, 1, v4
    v_lshlrev_b32 v4, 10, v4
    v_add_u32 v25, v25, v4
    v_mov_b32 v4, s32
    v_and_b32 v4, 3, v4
    v_lshlrev_b32 v4, 8, v4
    v_add_u32 v25, v25, v4
    v_lshlrev_b32 v4, 4, v2
    v_add_u32 v25, v25, v4
    v_and_b32 v4, 1, v3
    v_lshlrev_b32 v4, 3, v4
    v_add_u32 v25, v25, v4
    v_add_u32 v25, 65536, v25
    v_mov_b32 v28, s24
    v_and_b32 v28, 1, v28
    v_lshlrev_b32 v28, 4, v28
    v_add_u32 v28, v28, v2
    v_add_u32 v28, 16, v28
    v_lshlrev_b32 v4, 2, v3
    v_sub_u32 v28, v28, v4
    v_mov_b32 v180, -1
    v_mov_b32 v181, -1
    v_mov_b32 v182, -1
    v_mov_b32 v183, -1
    v_mov_b32 v4, 4
    s_mov_b32 s30, 50000
PW_76:
    buffer_load_dword v5, v4, s[20:23], 0 offen sc1
    s_waitcnt vmcnt(0)
    v_readfirstlane_b32 s46, v5
    s_cmp_lg_u32 s46, 0
    s_cbranch_scc1 PE_77
    s_sleep 2
    s_sub_u32 s30, s30, 1
    s_cmp_lg_u32 s30, 0
    s_cbranch_scc1 PW_76
    s_endpgm
PE_77:
    s_and_b32 s46, s46, 2
    s_lshl_b32 s46, s46, 12
    s_sub_u32 s47, 0, s88
    s_and_b32 s47, s47, 0x1fffff
    s_add_u32 s46, s46, s47
    s_add_u32 s46, s46, 2097152
    s_mov_b32 s31, 0
    v_min_u32 v4, 0, v1
    v_lshlrev_b32 v4, 2, v4
    s_mov_b32 s30, 50000
WF_78:
    buffer_load_dword v5, v4, s[20:23], s31 offen sc1
    s_waitcnt vmcnt(0)
    v_cmp_ne_u32 vcc, 16, v5
    s_cbranch_vccz WE_79
    s_sleep 2
    s_sub_u32 s30, s30, 1
    s_cmp_lg_u32 s30, 0
    s_cbranch_scc1 WF_78
    s_endpgm
WE_79:
    s_lshl_b32 s52, s32, 13
    s_add_u32 s52, s52, 8388608
    s_mov_b32 s53, 14336
    s_mov_b32 s55, 46137344
    s_mov_b32 s43, 8192
    s_mov_b32 s58, 0
    v_mov_b32 v29, 0
    s_cmp_lg_u32 s24, 3
    s_cbranch_scc1 PI_80
    v_and_b32 v4, 1, v1
    v_lshlrev_b32 v4, 7, v4
    v_add_u32 v31, v4, v26
    s_lshl_b32 s38, s58, 7
    s_mov_b32 s30, 50000
DL_81:
    v_cmp_ne_u32 vcc, 1, v29
    s_cbranch_vccz DO_82
    buffer_load_dword v29, v31, s[4:7], s38 offen sc1
    s_waitcnt vmcnt(0)
    s_sub_u32 s30, s30, 1
    s_cmp_lg_u32 s30, 0
    s_cbranch_scc1 DL_81
    s_endpgm
DO_82:
    s_lshl_b32 s38, s58, 7
    s_add_u32 m0, s53, 0
    s_add_u32 s31, s52, 0
    buffer_load_dwordx4 v21, s[4:7], s31 offen sc1 lds
    s_add_u32 m0, s53, 1024
    s_add_u32 s31, s52, 1024
    buffer_load_dwordx4 v21, s[4:7], s31 offen sc1 lds
    s_add_u32 m0, s53, 2048
    s_add_u32 s31, s52, 2048
    buffer_load_dwordx4 v21, s[4:7], s31 offen sc1 lds
    s_add_u32 m0, s53, 3072
    s_add_u32 s31, s52, 3072
    buffer_load_dwordx4 v21, s[4:7], s31 offen sc1 lds
    s_add_u32 m0, s53, 4096
    s_add_u32 s31, s52, 32
    buffer_load_dwordx4 v21, s[4:7], s31 offen sc1 lds
    s_add_u32 m0, s53, 5120
    s_add_u32 s31, s52, 1056
    buffer_load_dwordx4 v21, s[4:7], s31 offen sc1 lds
    s_add_u32 m0, s53, 6144
    s_add_u32 s31, s52, 2080
    buffer_load_dwordx4 v21, s[4:7], s31 offen sc1 lds
    s_add_u32 m0, s53, 7168
    s_add_u32 s31, s52, 3104
    buffer_load_dwordx4 v21, s[4:7], s31 offen sc1 lds
    s_add_u32 m0, s53, 18432
    s_add_u32 s31, s52, 16777216
    buffer_load_dwordx4 v11, s[4:7], s31 offen sc1 lds
    s_add_u32 m0, s53, 19456
    s_add_u32 s31, s52, 16778240
    buffer_load_dwordx4 v11, s[4:7], s31 offen sc1 lds
    s_add_u32 m0, s53, 20480
    s_add_u32 s31, s52, 16779264
    buffer_load_dwordx4 v11, s[4:7], s31 offen sc1 lds
    s_add_u32 m0, s53, 21504
    s_add_u32 s31, s52, 16780288
    buffer_load_dwordx4 v11, s[4:7], s31 offen sc1 lds
    s_add_u32 m0, s53, 22528
    s_add_u32 s31, s52, 16781312
    buffer_load_dwordx4 v11, s[4:7], s31 offen sc1 lds
    s_add_u32 m0, s53, 23552
    s_add_u32 s31, s52, 16782336
    buffer_load_dwordx4 v11, s[4:7], s31 offen sc1 lds
    s_add_u32 m0, s53, 24576
    s_add_u32 s31, s52, 16783360
    buffer_load_dwordx4 v11, s[4:7], s31 offen sc1 lds
    s_add_u32 m0, s53, 25600
    s_add_u32 s31, s52, 16784384
    buffer_load_dwordx4 v11, s[4:7], s31 offen sc1 lds
DK_83:
    s_add_u32 s58, s58, 1
    s_add_u32 s52, s52, 262144
    s_add_u32 s53, s53, s43
    s_sub_u32 s43, 0, s43
    s_lshl_b32 s38, s58, 7
    s_add_u32 m0, s53, 0
    s_add_u32 s31, s52, 0
    buffer_load_dwordx4 v21, s[4:7], s31 offen sc1 lds
    s_add_u32 m0, s53, 1024
    s_add_u32 s31, s52, 1024
    buffer_load_dwordx4 v21, s[4:7], s31 offen sc1 lds
    s_add_u32 m0, s53, 2048
    s_add_u32 s31, s52, 2048
    buffer_load_dwordx4 v21, s[4:7], s31 offen sc1 lds
    s_add_u32 m0, s53, 3072
    s_add_u32 s31, s52, 3072
    buffer_load_dwordx4 v21, s[4:7], s31 offen sc1 lds
    s_add_u32 m0, s53, 4096
    s_add_u32 s31, s52, 32
    buffer_load_dwordx4 v21, s[4:7], s31 offen sc1 lds
    s_add_u32 m0, s53, 5120
    s_add_u32 s31, s52, 1056
    buffer_load_dwordx4 v21, s[4:7], s31 offen sc1 lds
    s_add_u32 m0, s53, 6144
    s_add_u32 s31, s52, 2080
    buffer_load_dwordx4 v21, s[4:7], s31 offen sc1 lds
    s_add_u32 m0, s53, 7168
    s_add_u32 s31, s52, 3104
    buffer_load_dwordx4 v21, s[4:7], s31 offen sc1 lds
    s_add_u32 m0, s53, 18432
    s_add_u32 s31, s52, 16777216
    buffer_load_dwordx4 v11, s[4:7], s31 offen sc1 lds
    s_add_u32 m0, s53, 19456
    s_add_u32 s31, s52, 16778240
    buffer_load_dwordx4 v11, s[4:7], s31 offen sc1 lds
    s_add_u32 m0, s53, 20480
    s_add_u32 s31, s52, 16779264
    buffer_load_dwordx4 v11, s[4:7], s31 offen sc1 lds
    s_add_u32 m0, s53, 21504
    s_add_u32 s31, s52, 16780288
    buffer_load_dwordx4 v11, s[4:7], s31 offen sc1 lds
    s_add_u32 m0, s53, 22528
    s_add_u32 s31, s52, 16781312
    buffer_load_dwordx4 v11, s[4:7], s31 offen sc1 lds
    s_add_u32 m0, s53, 23552
    s_add_u32 s31, s52, 16782336
    buffer_load_dwordx4 v11, s[4:7], s31 offen sc1 lds
    s_add_u32 m0, s53, 24576
    s_add_u32 s31, s52, 16783360
    buffer_load_dwordx4 v11, s[4:7], s31 offen sc1 lds
    s_add_u32 m0, s53, 25600
    s_add_u32 s31, s52, 16784384
    buffer_load_dwordx4 v11, s[4:7], s31 offen sc1 lds
    s_add_u32 s38, s38, 128
    buffer_load_dword v29, v26, s[4:7], s38 offen sc1
DK_84:
    s_add_u32 s58, s58, 1
    s_add_u32 s52, s52, 262144
    s_add_u32 s53, s53, s43
    s_sub_u32 s43, 0, s43
    s_waitcnt vmcnt(17)
PI_80:
    v_min_u32 v31, 19, v1
    v_mov_b32 v4, s24
    v_and_b32 v4, 1, v4
    v_mul_u32_u24 v4, 20, v4
    v_add_u32 v31, v31, v4
    v_lshlrev_b32 v31, 7, v31
    v_add_u32 v31, 1736704, v31
    v_lshrrev_b32 v20, 5, v1
    v_lshlrev_b32 v20, 12, v20
    v_mov_b32 v4, s32
    v_lshlrev_b32 v4, 7, v4
    v_add_u32 v20, v20, v4
    v_and_b32 v4, 31, v1
    v_lshlrev_b32 v4, 2, v4
    v_add_u32 v20, v20, v4
    v_add_u32 v20, 1720320, v20
    s_cmp_eq_u32 s24, 1
    s_cselect_b64 s[60:61], -1, 0
    s_mov_b32 s33, 0
    s_mov_b32 s56, 1040356334
    s_mov_b32 s62, 8192
    s_barrier
QK_85:
    s_and_b32 s31, s33, 3
    s_lshl_b32 s34, s31, 15
    s_add_u32 s34, s34, s46
    s_mul_i32 s35, s31, 49152
    s_add_u32 s35, s35, s46
    s_add_u32 s35, s35, 131072
    s_cmp_eq_u32 s24, 1
    s_cbranch_scc1 N0_86
    ds_read_b128 v[144:147], v27 offset:0
    ds_read_b128 v[148:151], v27 offset:1024
    ds_read_b128 v[152:155], v27 offset:2048
    ds_read_b128 v[156:159], v27 offset:3072
    ds_read_b128 v[160:163], v27 offset:4096
    ds_read_b128 v[164:167], v27 offset:5120
    ds_read_b128 v[168:171], v27 offset:6144
    ds_read_b128 v[172:175], v27 offset:7168
    s_cmp_eq_u32 s24, 0
    s_cbranch_scc1 N0_86
    ds_read_b128 v[96:99], v23 offset:0
    ds_read_b128 v[100:103], v23 offset:1024
    ds_read_b128 v[104:107], v23 offset:2048
    ds_read_b128 v[108:111], v23 offset:3072
    s_waitcnt lgkmcnt(0)
    v_mfma_f32_16x16x32_bf16 v[112:115], v[144:147], v[96:99], 0
    v_mfma_f32_16x16x32_bf16 v[116:119], v[160:163], v[96:99], 0
    v_mfma_f32_16x16x32_bf16 v[112:115], v[148:151], v[100:103], v[112:115]
    v_mfma_f32_16x16x32_bf16 v[116:119], v[164:167], v[100:103], v[116:119]
    v_mfma_f32_16x16x32_bf16 v[112:115], v[152:155], v[104:107], v[112:115]
    v_mfma_f32_16x16x32_bf16 v[116:119], v[168:171], v[104:107], v[116:119]
    v_mfma_f32_16x16x32_bf16 v[112:115], v[156:159], v[108:111], v[112:115]
    v_mfma_f32_16x16x32_bf16 v[116:119], v[172:175], v[108:111], v[116:119]
    v_mov_b32 v5, 0xff800000
    v_cmp_le_i32 vcc, 16, v28
    s_nop 4
    v_cndmask_b32 v112, v5, v112, vcc
    v_cmp_le_i32 vcc, 17, v28
    s_nop 1
    v_cndmask_b32 v113, v5, v113, vcc
    v_cmp_le_i32 vcc, 32, v28
    s_nop 1
    v_cndmask_b32 v114, v5, v114, vcc
    v_cmp_le_i32 vcc, 33, v28
    s_nop 1
    v_cndmask_b32 v115, v5, v115, vcc
    v_cmp_le_i32 vcc, 18, v28
    s_nop 1
    v_cndmask_b32 v116, v5, v116, vcc
    v_cmp_le_i32 vcc, 19, v28
    s_nop 1
    v_cndmask_b32 v117, v5, v117, vcc
    v_cmp_le_i32 vcc, 34, v28
    s_nop 1
    v_cndmask_b32 v118, v5, v118, vcc
    v_cmp_le_i32 vcc, 35, v28
    s_nop 1
    v_cndmask_b32 v119, v5, v119, vcc
    v_max3_f32 v124, v112, v113, v114
    v_max3_f32 v124, v124, v115, v116
    v_max3_f32 v124, v124, v117, v118
    v_max_f32 v124, v124, v119
N0_86:
    v_add_u32 v27, s62, v27
    v_add_u32 v23, s62, v23
    s_sub_u32 s62, 0, s62
    v_mov_b32 v72, 0
    v_mov_b32 v73, 0
    v_mov_b32 v74, 0
    v_mov_b32 v75, 0
    v_mov_b32 v76, 0
    v_mov_b32 v77, 0
    v_mov_b32 v78, 0
    v_mov_b32 v79, 0
    v_mov_b32 v80, 0
    v_mov_b32 v81, 0
    v_mov_b32 v82, 0
    v_mov_b32 v83, 0
    v_mov_b32 v84, 0
    v_mov_b32 v85, 0
    v_mov_b32 v86, 0
    v_mov_b32 v87, 0
    s_add_u32 s42, s33, 1
    v_mov_b32 v176, s42
    s_cmp_ge_u32 s24, 2
    s_cbranch_scc1 B1_87
    s_mov_b32 s30, 50000
PM_88:
    buffer_load_dwordx4 v[32:35], v13, s[4:7], s34 offen offset:0 sc1
    buffer_load_dwordx4 v[36:39], v13, s[4:7], s34 offen offset:1024 sc1
    buffer_load_dwordx4 v[40:43], v13, s[4:7], s34 offen offset:2048 sc1
    buffer_load_dwordx4 v[44:47], v14, s[4:7], s34 offen offset:0 sc1
    buffer_load_dwordx4 v[48:51], v15, s[4:7], s34 offen offset:0 sc1
    s_waitcnt vmcnt(4)
    ds_write_b128 v10, v[32:35] offset:0
    s_waitcnt vmcnt(3)
    ds_write_b128 v10, v[36:39] offset:1024
    s_waitcnt vmcnt(2)
    ds_write_b128 v10, v[40:43] offset:2048
    s_waitcnt vmcnt(1)
    ds_write_b128 v10, v[44:47] offset:3072
    s_waitcnt vmcnt(0)
    ds_write_b128 v10, v[48:51] offset:4096
    s_waitcnt vmcnt(0)
    v_max3_u32 v4, v32, v36, v40
    v_max3_u32 v4, v4, v44, v48
    v_cmp_eq_u32 vcc, -1, v4
    s_cbranch_vccz PO_89
    s_waitcnt lgkmcnt(0)
    s_sub_u32 s30, s30, 1
    s_cmp_lg_u32 s30, 0
    s_cbranch_scc1 PM_88
    s_endpgm
PO_89:
B1_87:
    s_waitcnt vmcnt(0)
B1_87_x:
    s_waitcnt lgkmcnt(0)
    s_barrier
    ds_read_b128 v[32:35], v11 offset:0
    ds_read_b128 v[36:39], v11 offset:1024
    ds_read_b128 v[40:43], v11 offset:2048
    ds_read_b128 v[44:47], v11 offset:3072
    ds_read_b128 v[48:51], v11 offset:4096
    ds_read_b128 v[52:55], v11 offset:5120
    ds_read_b128 v[56:59], v11 offset:6144
    ds_read_b128 v[60:63], v11 offset:7168
    ds_read_b128 v[64:67], v11 offset:8192
    ds_read_b128 v[68:71], v11 offset:9216
    s_waitcnt lgkmcnt(9)
    v_smfmac_f32_16x16x64_bf16 v[72:75], v[32:35], a[0:7], v30
    v_smfmac_f32_16x16x64_bf16 v[76:79], v[32:35], a[80:87], v30
    s_waitcnt lgkmcnt(8)
    v_smfmac_f32_16x16x64_bf16 v[72:75], v[36:39], a[8:15], v30
    v_smfmac_f32_16x16x64_bf16 v[76:79], v[36:39], a[88:95], v30
    s_waitcnt lgkmcnt(7)
    v_smfmac_f32_16x16x64_bf16 v[72:75], v[40:43], a[16:23], v30
    v_smfmac_f32_16x16x64_bf16 v[76:79], v[40:43], a[96:103], v30
    s_waitcnt lgkmcnt(6)
    v_smfmac_f32_16x16x64_bf16 v[72:75], v[44:47], a[24:31], v30
    v_smfmac_f32_16x16x64_bf16 v[76:79], v[44:47], a[104:111], v30
    s_waitcnt lgkmcnt(5)
    v_smfmac_f32_16x16x64_bf16 v[72:75], v[48:51], a[32:39], v30
    v_smfmac_f32_16x16x64_bf16 v[76:79], v[48:51], a[112:119], v30
    s_waitcnt lgkmcnt(4)
    v_smfmac_f32_16x16x64_bf16 v[72:75], v[52:55], a[40:47], v30
    v_smfmac_f32_16x16x64_bf16 v[76:79], v[52:55], a[120:127], v30
    s_waitcnt lgkmcnt(3)
    v_smfmac_f32_16x16x64_bf16 v[72:75], v[56:59], a[48:55], v30
    v_smfmac_f32_16x16x64_bf16 v[76:79], v[56:59], a[128:135], v30
    s_waitcnt lgkmcnt(2)
    v_smfmac_f32_16x16x64_bf16 v[72:75], v[60:63], a[56:63], v30
    v_smfmac_f32_16x16x64_bf16 v[76:79], v[60:63], a[136:143], v30
    s_waitcnt lgkmcnt(1)
    v_smfmac_f32_16x16x64_bf16 v[72:75], v[64:67], a[64:71], v30
    v_smfmac_f32_16x16x64_bf16 v[76:79], v[64:67], a[144:151], v30
    s_waitcnt lgkmcnt(0)
    v_smfmac_f32_16x16x64_bf16 v[72:75], v[68:71], a[72:79], v30
    v_smfmac_f32_16x16x64_bf16 v[76:79], v[68:71], a[152:159], v30
    v_smfmac_f32_16x16x64_bf16 v[80:83], v[32:35], a[160:167], v30
    v_smfmac_f32_16x16x64_bf16 v[84:87], v[32:35], a[240:247], v30
    v_smfmac_f32_16x16x64_bf16 v[80:83], v[36:39], a[168:175], v30
    s_nop 3
    v_permlane32_swap_b32 v72, v73
    v_smfmac_f32_16x16x64_bf16 v[84:87], v[36:39], a[248:255], v30
    v_permlane32_swap_b32 v74, v75
    v_smfmac_f32_16x16x64_bf16 v[80:83], v[40:43], a[176:183], v30
    v_permlane32_swap_b32 v76, v77
    v_smfmac_f32_16x16x64_bf16 v[84:87], v[40:43], v[192:199], v30
    v_permlane32_swap_b32 v78, v79
    v_smfmac_f32_16x16x64_bf16 v[80:83], v[44:47], a[184:191], v30
    v_add_f32 v72, v72, v73
    v_smfmac_f32_16x16x64_bf16 v[84:87], v[44:47], v[200:207], v30
    v_add_f32 v74, v74, v75
    v_smfmac_f32_16x16x64_bf16 v[80:83], v[48:51], a[192:199], v30
    v_add_f32 v76, v76, v77
    v_smfmac_f32_16x16x64_bf16 v[84:87], v[48:51], v[208:215], v30
    v_add_f32 v78, v78, v79
    v_smfmac_f32_16x16x64_bf16 v[80:83], v[52:55], a[200:207], v30
    v_cvt_pk_bf16_f32 v4, v72, v76
    v_smfmac_f32_16x16x64_bf16 v[84:87], v[52:55], v[216:223], v30
    v_cvt_pk_bf16_f32 v5, v74, v78
    v_smfmac_f32_16x16x64_bf16 v[80:83], v[56:59], a[208:215], v30
    ds_write_b32 v12, v4 offset:10240
    v_smfmac_f32_16x16x64_bf16 v[84:87], v[56:59], v[224:231], v30
    ds_write_b32 v12, v5 offset:10368
    v_smfmac_f32_16x16x64_bf16 v[80:83], v[60:63], a[216:223], v30
    v_smfmac_f32_16x16x64_bf16 v[84:87], v[60:63], v[232:239], v30
    v_smfmac_f32_16x16x64_bf16 v[80:83], v[64:67], a[224:231], v30
    v_smfmac_f32_16x16x64_bf16 v[84:87], v[64:67], v[240:247], v30
    v_smfmac_f32_16x16x64_bf16 v[80:83], v[68:71], a[232:239], v30
    v_smfmac_f32_16x16x64_bf16 v[84:87], v[68:71], v[248:255], v30
    s_nop 6
    v_permlane32_swap_b32 v80, v81
    v_permlane32_swap_b32 v82, v83
    v_permlane32_swap_b32 v84, v85
    v_permlane32_swap_b32 v86, v87
    v_add_f32 v80, v80, v81
    v_add_f32 v82, v82, v83
    v_add_f32 v84, v84, v85
    v_add_f32 v86, v86, v87
    v_cvt_pk_bf16_f32 v4, v80, v84
    v_cvt_pk_bf16_f32 v5, v82, v86
    ds_write_b32 v12, v4 offset:12288
    ds_write_b32 v12, v5 offset:12416
    s_waitcnt lgkmcnt(0)
    s_barrier
    s_mov_b64 exec, s[60:61]
    buffer_store_dword v176, v20, s[4:7], s46 offen sc1
    s_mov_b64 exec, -1
    s_cmp_ge_u32 s24, 2
    s_cbranch_scc1 T1_91
    s_cmp_lg_u32 s24, 0
    s_cbranch_scc1 B3_90
    s_cmp_eq_u32 s33, 63
    s_cbranch_scc1 B3_90
    ds_read_b128 v[32:35], v17 offset:0
    ds_read_b128 v[36:39], v17 offset:512
    ds_read_b128 v[40:43], v17 offset:1024
    ds_read_b128 v[44:47], v17 offset:1536
    ds_read_b128 v[48:51], v18 offset:0
    ds_read_b128 v[52:55], v18 offset:512
    ds_read_b128 v[56:59], v18 offset:1024
    ds_read_b128 v[60:63], v18 offset:1536
    s_waitcnt lgkmcnt(7)
    v_mfma_f32_16x16x32_bf16 v[72:75], v[144:147], v[32:35], 0
    v_mfma_f32_16x16x32_bf16 v[76:79], v[160:163], v[32:35], 0
    s_waitcnt lgkmcnt(6)
    v_mfma_f32_16x16x32_bf16 v[72:75], v[148:151], v[36:39], v[72:75]
    v_mfma_f32_16x16x32_bf16 v[76:79], v[164:167], v[36:39], v[76:79]
    s_waitcnt lgkmcnt(5)
    v_mfma_f32_16x16x32_bf16 v[72:75], v[152:155], v[40:43], v[72:75]
    v_mfma_f32_16x16x32_bf16 v[76:79], v[168:171], v[40:43], v[76:79]
    s_waitcnt lgkmcnt(4)
    v_mfma_f32_16x16x32_bf16 v[72:75], v[156:159], v[44:47], v[72:75]
    v_mfma_f32_16x16x32_bf16 v[76:79], v[172:175], v[44:47], v[76:79]
    s_waitcnt lgkmcnt(0)
    v_mfma_f32_16x16x32_bf16 v[80:83], v[48:51], v[32:35], 0
    v_mfma_f32_16x16x32_bf16 v[84:87], v[52:55], v[36:39], 0
    v_mfma_f32_16x16x32_bf16 v[80:83], v[56:59], v[40:43], v[80:83]
    v_mfma_f32_16x16x32_bf16 v[84:87], v[60:63], v[44:47], v[84:87]
    v_cmp_gt_u32 vcc, 8, v2
    s_nop 1
    v_cndmask_b32 v72, v76, v72, vcc
    v_cndmask_b32 v73, v77, v73, vcc
    v_cndmask_b32 v74, v78, v74, vcc
    v_cndmask_b32 v75, v79, v75, vcc
    v_max3_f32 v4, v72, v73, v74
    v_max_f32 v4, v4, v75
    v_add_f32 v76, v80, v84
    v_add_f32 v77, v81, v85
    v_add_f32 v78, v82, v86
    v_add_f32 v79, v83, v87
    v_max3_f32 v4, v4, v76, v77
    v_max3_f32 v4, v4, v78, v79
    s_nop 1
    v_max_f32_dpp v4, v4, v4 row_ror:8 row_mask:0xf bank_mask:0xf
    v_mov_b32 v5, v4
    s_nop 1
    v_permlane16_swap_b32 v5, v4
    v_max_f32 v4, v5, v4
    v_mov_b32 v5, v4
    s_nop 1
    v_permlane32_swap_b32 v5, v4
    v_max_f32 v4, v5, v4
    v_mul_f32 v4, s56, v4
    v_fma_f32 v72, v72, s56, -v4
    v_fma_f32 v73, v73, s56, -v4
    v_fma_f32 v74, v74, s56, -v4
    v_fma_f32 v75, v75, s56, -v4
    v_fma_f32 v76, v76, s56, -v4
    v_fma_f32 v77, v77, s56, -v4
    v_fma_f32 v78, v78, s56, -v4
    v_fma_f32 v79, v79, s56, -v4
    v_exp_f32 v72, v72
    v_exp_f32 v73, v73
    v_exp_f32 v74, v74
    v_exp_f32 v75, v75
    v_exp_f32 v76, v76
    v_exp_f32 v77, v77
    v_exp_f32 v78, v78
    v_exp_f32 v79, v79
    v_add_f32 v4, v72, v73
    v_add_f32 v5, v74, v75
    v_add_f32 v6, v76, v77
    v_add_f32 v7, v78, v79
    v_add_f32 v4, v4, v5
    v_add_f32 v6, v6, v7
    v_fmac_f32 v4, 0x3e800000, v6
    s_nop 1
    v_add_f32_dpp v4, v4, v4 row_ror:8 row_mask:0xf bank_mask:0xf
    v_mov_b32 v5, v4
    s_nop 1
    v_permlane16_swap_b32 v5, v4
    v_add_f32 v4, v5, v4
    v_mov_b32 v5, v4
    s_nop 1
    v_permlane32_swap_b32 v5, v4
    v_add_f32 v4, v5, v4
    v_rcp_f32 v4, v4
    s_nop 0
    v_mul_f32 v72, v72, v4
    v_mul_f32 v73, v73, v4
    v_mul_f32 v74, v74, v4
    v_mul_f32 v75, v75, v4
    v_mul_f32 v76, v76, v4
    v_mul_f32 v77, v77, v4
    v_mul_f32 v78, v78, v4
    v_mul_f32 v79, v79, v4
    v_cvt_pk_bf16_f32 v80, v72, v73
    v_cvt_pk_bf16_f32 v81, v74, v75
    v_cvt_pk_bf16_f32 v84, v76, v77
    v_cvt_pk_bf16_f32 v85, v78, v79
    v_permlane16_swap_b32 v80, v82
    v_permlane16_swap_b32 v81, v83
    v_min_u32 v84, -2, v84
    v_min_u32 v80, -2, v80
    s_mov_b32 exec_lo, 0xffff
    s_mov_b32 exec_hi, 0xffff
    buffer_store_dwordx4 v[80:83], v19, s[4:7], s35 offen sc1
    s_mov_b64 exec, 0xff00ff
    buffer_store_dwordx2 v[84:85], v16, s[4:7], s35 offen sc1
    s_mov_b64 exec, -1
    s_branch B3_90
T1_91:
    s_sleep 2
    ds_read_b128 v[48:51], v22 offset:0
    ds_read_b128 v[52:55], v22 offset:512
    ds_read_b128 v[56:59], v22 offset:1024
    ds_read_b128 v[60:63], v22 offset:1536
    s_waitcnt lgkmcnt(3)
    v_mfma_f32_16x16x32_bf16 v[120:123], v[48:51], v[96:99], 0
    s_waitcnt lgkmcnt(2)
    v_mfma_f32_16x16x32_bf16 v[120:123], v[52:55], v[100:103], v[120:123]
    s_waitcnt lgkmcnt(1)
    v_mfma_f32_16x16x32_bf16 v[120:123], v[56:59], v[104:107], v[120:123]
    s_waitcnt lgkmcnt(0)
    v_mfma_f32_16x16x32_bf16 v[120:123], v[60:63], v[108:111], v[120:123]
    s_nop 7
    v_max3_f32 v4, v124, v120, v121
    v_max3_f32 v4, v4, v122, v123
    v_mov_b32 v5, v4
    s_nop 1
    v_permlane16_swap_b32 v5, v4
    v_max_f32 v4, v5, v4
    v_mov_b32 v5, v4
    s_nop 1
    v_permlane32_swap_b32 v5, v4
    v_max_f32 v4, v5, v4
    v_mul_f32 v4, s56, v4
    v_fma_f32 v112, v112, s56, -v4
    v_fma_f32 v113, v113, s56, -v4
    v_fma_f32 v114, v114, s56, -v4
    v_fma_f32 v115, v115, s56, -v4
    v_fma_f32 v116, v116, s56, -v4
    v_fma_f32 v117, v117, s56, -v4
    v_fma_f32 v118, v118, s56, -v4
    v_fma_f32 v119, v119, s56, -v4
    v_fma_f32 v120, v120, s56, -v4
    v_fma_f32 v121, v121, s56, -v4
    v_fma_f32 v122, v122, s56, -v4
    v_fma_f32 v123, v123, s56, -v4
    v_exp_f32 v112, v112
    v_exp_f32 v113, v113
    v_exp_f32 v114, v114
    v_exp_f32 v115, v115
    v_exp_f32 v116, v116
    v_exp_f32 v117, v117
    v_exp_f32 v118, v118
    v_exp_f32 v119, v119
    v_exp_f32 v120, v120
    v_exp_f32 v121, v121
    v_exp_f32 v122, v122
    v_exp_f32 v123, v123
    v_add_f32 v4, v120, v121
    v_add_f32 v5, v122, v123
    v_add_f32 v4, v4, v5
    v_mul_f32 v4, 0.5, v4
    v_add_f32 v4, v4, v112
    v_add_f32 v4, v4, v113
    v_add_f32 v4, v4, v114
    v_add_f32 v4, v4, v115
    v_add_f32 v4, v4, v116
    v_add_f32 v4, v4, v117
    v_add_f32 v4, v4, v118
    v_add_f32 v4, v4, v119
    v_mov_b32 v5, v4
    s_nop 1
    v_permlane16_swap_b32 v5, v4
    v_add_f32 v4, v5, v4
    v_mov_b32 v5, v4
    s_nop 1
    v_permlane32_swap_b32 v5, v4
    v_add_f32 v4, v5, v4
    v_rcp_f32 v4, v4
    s_nop 0
    v_mul_f32 v112, v112, v4
    v_mul_f32 v113, v113, v4
    v_mul_f32 v114, v114, v4
    v_mul_f32 v115, v115, v4
    v_mul_f32 v116, v116, v4
    v_mul_f32 v117, v117, v4
    v_mul_f32 v118, v118, v4
    v_mul_f32 v119, v119, v4
    v_mul_f32 v120, v120, v4
    v_mul_f32 v121, v121, v4
    v_mul_f32 v122, v122, v4
    v_mul_f32 v123, v123, v4
    v_cvt_pk_bf16_f32 v124, v112, v113
    v_cvt_pk_bf16_f32 v125, v116, v117
    v_cvt_pk_bf16_f32 v126, v114, v115
    v_cvt_pk_bf16_f32 v127, v118, v119
    v_cvt_pk_bf16_f32 v128, v120, v121
    v_cvt_pk_bf16_f32 v129, v122, v123
B3_90:
    s_barrier
    s_cmp_lt_u32 s24, 2
    s_cbranch_scc1 NX_93
    buffer_store_dwordx4 v[124:127], v24, s[4:7], s55 offen sc1
    s_mov_b32 exec_hi, 0
    buffer_store_dwordx2 v[128:129], v25, s[4:7], s55 offen sc1
    s_mov_b32 exec_hi, -1
    s_add_u32 s55, s55, 81920
    s_cmp_eq_u32 s24, 3
    s_cbranch_scc1 W3_92
    s_cmp_eq_u32 s33, 0
    s_cbranch_scc1 NX_93
    s_add_u32 s31, s33, 3
    s_and_b32 s31, s31, 3
    s_mul_i32 s40, s31, 49152
    s_add_u32 s40, s40, s46
    s_add_u32 s40, s40, 131072
    buffer_store_dwordx4 v[180:183], v19, s[4:7], s40 offen sc1
    buffer_store_dwordx2 v[180:181], v16, s[4:7], s40 offen sc1
    s_sub_u32 s39, s33, 1
    s_lshl_b32 s39, s39, 5
    s_add_u32 s39, s39, s32
    s_lshl_b32 s39, s39, 2
    s_add_u32 s39, s39, 40960
    v_mov_b32 v4, 0
    v_mov_b32 v5, 1
    s_mov_b64 exec, 1
    buffer_store_dword v5, v4, s[4:7], s39 offen sc1
    s_mov_b64 exec, -1
    s_branch NX_93
W3_92:
    s_cmp_ge_u32 s58, 64
    s_cbranch_scc1 DK_95
    s_lshl_b32 s38, s58, 7
    s_mov_b32 s30, 50000
DL_96:
    v_cmp_ne_u32 vcc, 1, v29
    s_cbranch_vccz DO_97
    buffer_load_dword v29, v26, s[4:7], s38 offen sc1
    s_waitcnt vmcnt(0)
    s_sub_u32 s30, s30, 1
    s_cmp_lg_u32 s30, 0
    s_cbranch_scc1 DL_96
    s_endpgm
DO_97:
    s_add_u32 m0, s53, 0
    s_add_u32 s31, s52, 0
    buffer_load_dwordx4 v21, s[4:7], s31 offen sc1 lds
    s_add_u32 m0, s53, 1024
    s_add_u32 s31, s52, 1024
    buffer_load_dwordx4 v21, s[4:7], s31 offen sc1 lds
    s_add_u32 m0, s53, 2048
    s_add_u32 s31, s52, 2048
    buffer_load_dwordx4 v21, s[4:7], s31 offen sc1 lds
    s_add_u32 m0, s53, 3072
    s_add_u32 s31, s52, 3072
    buffer_load_dwordx4 v21, s[4:7], s31 offen sc1 lds
    s_add_u32 m0, s53, 4096
    s_add_u32 s31, s52, 32
    buffer_load_dwordx4 v21, s[4:7], s31 offen sc1 lds
    s_add_u32 m0, s53, 5120
    s_add_u32 s31, s52, 1056
    buffer_load_dwordx4 v21, s[4:7], s31 offen sc1 lds
    s_add_u32 m0, s53, 6144
    s_add_u32 s31, s52, 2080
    buffer_load_dwordx4 v21, s[4:7], s31 offen sc1 lds
    s_add_u32 m0, s53, 7168
    s_add_u32 s31, s52, 3104
    buffer_load_dwordx4 v21, s[4:7], s31 offen sc1 lds
    s_add_u32 m0, s53, 18432
    s_add_u32 s31, s52, 16777216
    buffer_load_dwordx4 v11, s[4:7], s31 offen sc1 lds
    s_add_u32 m0, s53, 19456
    s_add_u32 s31, s52, 16778240
    buffer_load_dwordx4 v11, s[4:7], s31 offen sc1 lds
    s_add_u32 m0, s53, 20480
    s_add_u32 s31, s52, 16779264
    buffer_load_dwordx4 v11, s[4:7], s31 offen sc1 lds
    s_add_u32 m0, s53, 21504
    s_add_u32 s31, s52, 16780288
    buffer_load_dwordx4 v11, s[4:7], s31 offen sc1 lds
    s_add_u32 m0, s53, 22528
    s_add_u32 s31, s52, 16781312
    buffer_load_dwordx4 v11, s[4:7], s31 offen sc1 lds
    s_add_u32 m0, s53, 23552
    s_add_u32 s31, s52, 16782336
    buffer_load_dwordx4 v11, s[4:7], s31 offen sc1 lds
    s_add_u32 m0, s53, 24576
    s_add_u32 s31, s52, 16783360
    buffer_load_dwordx4 v11, s[4:7], s31 offen sc1 lds
    s_add_u32 m0, s53, 25600
    s_add_u32 s31, s52, 16784384
    buffer_load_dwordx4 v11, s[4:7], s31 offen sc1 lds
    s_add_u32 s38, s38, 128
    buffer_load_dword v29, v26, s[4:7], s38 offen sc1
DK_95:
    s_add_u32 s58, s58, 1
    s_add_u32 s52, s52, 262144
    s_add_u32 s53, s53, s43
    s_sub_u32 s43, 0, s43
NX_93:
    s_add_u32 s33, s33, 1
    s_cmp_lt_u32 s33, 64
    s_cbranch_scc1 QK_85
    s_waitcnt vmcnt(0)
    s_barrier
    s_cmp_lg_u32 s24, 2
    s_cbranch_scc1 E2_98
    s_sub_u32 s39, s33, 1
    s_lshl_b32 s39, s39, 5
    s_add_u32 s39, s39, s32
    s_lshl_b32 s39, s39, 2
    s_add_u32 s39, s39, 40960
    v_mov_b32 v4, 0
    v_mov_b32 v5, 1
    s_mov_b64 exec, 1
    buffer_store_dword v5, v4, s[4:7], s39 offen sc1
    s_mov_b64 exec, -1
E2_98:
    s_waitcnt vmcnt(0)
    s_branch EXIT
R_R:
    s_cmp_lg_u32 s25, 0
    s_cbranch_scc1 PRE
R_PROBE:
    s_cmp_lg_u32 s24, 0
    s_cbranch_scc1 PRE
    s_sub_u32 s47, 0, s88
    s_and_b32 s47, s47, 0x1fffff
    s_add_u32 s46, s47, 3932160
    s_mov_b32 s34, -1
    s_mov_b32 s35, -1
    s_mov_b32 s36, 0
    v_mov_b32 v4, 0
    v_mov_b32 v5, 0
    s_mov_b64 exec, 1
PRL:
    s_add_u32 s37, s46, 0
    s_memtime s[40:41]
    s_waitcnt lgkmcnt(0)
    buffer_store_dword v5, v4, s[4:7], s37 offen offset:0 sc1
    s_waitcnt vmcnt(0)
    buffer_store_dword v5, v4, s[4:7], s37 offen offset:128 sc1
    s_waitcnt vmcnt(0)
    s_memtime s[42:43]
    s_waitcnt lgkmcnt(0)
    s_sub_u32 s42, s42, s40
    s_min_u32 s34, s34, s42
    s_add_u32 s37, s46, 8192
    s_memtime s[40:41]
    s_waitcnt lgkmcnt(0)
    buffer_store_dword v5, v4, s[4:7], s37 offen offset:0 sc1
    s_waitcnt vmcnt(0)
    buffer_store_dword v5, v4, s[4:7], s37 offen offset:128 sc1
    s_waitcnt vmcnt(0)
    s_memtime s[42:43]
    s_waitcnt lgkmcnt(0)
    s_sub_u32 s42, s42, s40
    s_min_u32 s35, s35, s42
    s_add_u32 s46, s46, 16384
    s_add_u32 s36, s36, 1
    s_cmp_lt_u32 s36, 5
    s_cbranch_scc1 PRL
    s_cmp_le_u32 s34, s35
    s_cselect_b32 s36, 1, 2
    v_mov_b32 v5, s36
    v_mov_b32 v4, 4
    buffer_store_dword v5, v4, s[20:23], 0 offen sc1
    s_waitcnt vmcnt(0)
    s_mov_b64 exec, -1
PRE:
    s_mov_b32 s32, s25
    v_lshrrev_b32 v30, 3, v2
    v_mul_u32_u24 v30, 43690, v30
    v_add_u32 v30, 17476, v30
    v_lshlrev_b32 v10, 4, v1
    v_mov_b32 v4, s24
    v_mul_u32_u24 v4, 5120, v4
    v_add_u32 v10, v10, v4
    v_lshlrev_b32 v11, 4, v1
    v_mov_b32 v12, s24
    v_lshlrev_b32 v12, 3, v12
    v_and_b32 v4, 1, v3
    v_lshlrev_b32 v4, 2, v4
    v_add_u32 v12, v12, v4
    v_lshrrev_b32 v4, 1, v3
    v_add_u32 v12, v12, v4
    v_lshlrev_b32 v12, 6, v12
    v_lshlrev_b32 v4, 2, v2
    v_add_u32 v12, v12, v4
    v_lshlrev_b32 v17, 4, v1
    v_mov_b32 v4, s24
    v_lshlrev_b32 v4, 12, v4
    v_add_u32 v17, v17, v4
    v_mov_b32 v4, s24
    v_lshrrev_b32 v4, 1, v4
    v_lshlrev_b32 v4, 13, v4
    v_add_u32 v17, v17, v4
    v_lshlrev_b32 v18, 4, v1
    v_mov_b32 v4, s24
    v_lshlrev_b32 v4, 10, v4
    v_add_u32 v18, v18, v4
    v_add_u32 v18, 32768, v18
    v_lshlrev_b32 v19, 4, v1
    v_mov_b32 v4, s24
    v_lshlrev_b32 v4, 11, v4
    v_add_u32 v19, v19, v4
    v_mov_b32 v4, s32
    v_lshlrev_b32 v4, 14, v4
    v_add_u32 v19, v19, v4
    v_lshlrev_b32 v20, 4, v1
    v_mov_b32 v4, s24
    v_lshlrev_b32 v4, 13, v4
    v_add_u32 v20, v20, v4
    v_mov_b32 v4, s32
    v_lshlrev_b32 v4, 15, v4
    v_add_u32 v20, v20, v4
    v_mov_b32 v22, s24
    v_lshlrev_b32 v22, 9, v22
    v_and_b32 v4, 1, v3
    v_lshlrev_b32 v4, 2, v4
    v_lshrrev_b32 v5, 1, v3
    v_add_u32 v4, v4, v5
    v_lshlrev_b32 v4, 6, v4
    v_add_u32 v22, v22, v4
    v_lshlrev_b32 v4, 2, v2
    v_add_u32 v22, v22, v4
    v_and_b32 v23, 7, v2
    v_lshlrev_b32 v23, 6, v23
    v_lshlrev_b32 v4, 4, v3
    v_add_u32 v23, v23, v4
    v_lshrrev_b32 v4, 3, v2
    v_lshlrev_b32 v4, 3, v4
    v_add_u32 v23, v23, v4
    v_mov_b32 v24, s32
    v_lshlrev_b32 v24, 8, v24
    v_mov_b32 v4, s32
    v_lshrrev_b32 v4, 5, v4
    v_lshlrev_b32 v4, 13, v4
    v_add_u32 v24, v24, v4
    v_lshlrev_b32 v4, 4, v2
    v_add_u32 v24, v24, v4
    v_lshlrev_b32 v21, 4, v1
    v_mov_b32 v4, s24
    v_lshlrev_b32 v4, 11, v4
    v_add_u32 v21, v21, v4
    v_mov_b32 v4, s32
    v_lshlrev_b32 v4, 13, v4
    v_add_u32 v21, v21, v4
    s_mov_b32 s55, 69206016
    s_lshl_b32 s57, s32, 2
    s_add_u32 s57, s57, 24320
    v_and_b32 v26, 31, v1
    v_lshlrev_b32 v26, 2, v26
    v_add_u32 v26, 8192, v26
    v_add_u32 v25, 1638400, v24
    v_mov_b32 v180, -1
    v_mov_b32 v181, -1
    v_mov_b32 v182, -1
    v_mov_b32 v183, -1
    v_mov_b32 v4, 4
    s_mov_b32 s30, 50000
PW_99:
    buffer_load_dword v5, v4, s[20:23], 0 offen sc1
    s_waitcnt vmcnt(0)
    v_readfirstlane_b32 s46, v5
    s_cmp_lg_u32 s46, 0
    s_cbranch_scc1 PE_100
    s_sleep 2
    s_sub_u32 s30, s30, 1
    s_cmp_lg_u32 s30, 0
    s_cbranch_scc1 PW_99
    s_endpgm
PE_100:
    s_and_b32 s46, s46, 2
    s_lshl_b32 s46, s46, 12
    s_sub_u32 s47, 0, s88
    s_and_b32 s47, s47, 0x1fffff
    s_add_u32 s46, s46, s47
    s_add_u32 s46, s46, 2097152
    s_mov_b32 s31, 0
    v_min_u32 v4, 0, v1
    v_lshlrev_b32 v4, 2, v4
    s_mov_b32 s30, 50000
WF_101:
    buffer_load_dword v5, v4, s[20:23], s31 offen sc1
    s_waitcnt vmcnt(0)
    v_cmp_ne_u32 vcc, 16, v5
    s_cbranch_vccz WE_102
    s_sleep 2
    s_sub_u32 s30, s30, 1
    s_cmp_lg_u32 s30, 0
    s_cbranch_scc1 WF_101
    s_endpgm
WE_102:
    s_mov_b32 s54, 92274688
    s_mov_b32 s58, 0
    v_mov_b32 v29, 0
    v_lshlrev_b32 v31, 2, v1
    v_add_u32 v31, 8192, v31
    s_lshl_b32 s38, s58, 7
    s_mov_b32 s30, 50000
DL_103:
    v_cmp_ne_u32 vcc, 1, v29
    s_cbranch_vccz DO_104
    buffer_load_dword v29, v31, s[4:7], s38 offen sc1
    s_waitcnt vmcnt(0)
    s_sub_u32 s30, s30, 1
    s_cmp_lg_u32 s30, 0
    s_cbranch_scc1 DL_103
    s_endpgm
DO_104:
    s_lshl_b32 s38, s58, 7
    s_add_u32 s31, s54, 4096
    buffer_load_dwordx4 v[96:99], v20, s[4:7], s54 offen offset:0 sc1
    buffer_load_dwordx4 v[100:103], v20, s[4:7], s54 offen offset:1024 sc1
    buffer_load_dwordx4 v[104:107], v20, s[4:7], s54 offen offset:2048 sc1
    buffer_load_dwordx4 v[108:111], v20, s[4:7], s54 offen offset:3072 sc1
    buffer_load_dwordx4 v[112:115], v20, s[4:7], s31 offen offset:0 sc1
    buffer_load_dwordx4 v[116:119], v20, s[4:7], s31 offen offset:1024 sc1
    buffer_load_dwordx4 v[120:123], v20, s[4:7], s31 offen offset:2048 sc1
    buffer_load_dwordx4 v[124:127], v20, s[4:7], s31 offen offset:3072 sc1
DK_105:
    s_add_u32 s58, s58, 1
    s_add_u32 s54, s54, 1310720
    s_lshl_b32 s38, s58, 7
    s_add_u32 s31, s54, 4096
    buffer_load_dwordx4 v[128:131], v20, s[4:7], s54 offen offset:0 sc1
    buffer_load_dwordx4 v[132:135], v20, s[4:7], s54 offen offset:1024 sc1
    buffer_load_dwordx4 v[136:139], v20, s[4:7], s54 offen offset:2048 sc1
    buffer_load_dwordx4 v[140:143], v20, s[4:7], s54 offen offset:3072 sc1
    buffer_load_dwordx4 v[144:147], v20, s[4:7], s31 offen offset:0 sc1
    buffer_load_dwordx4 v[148:151], v20, s[4:7], s31 offen offset:1024 sc1
    buffer_load_dwordx4 v[152:155], v20, s[4:7], s31 offen offset:2048 sc1
    buffer_load_dwordx4 v[156:159], v20, s[4:7], s31 offen offset:3072 sc1
    s_add_u32 s38, s38, 128
    buffer_load_dword v29, v26, s[4:7], s38 offen sc1
DK_106:
    s_add_u32 s58, s58, 1
    s_add_u32 s54, s54, 1310720
    s_cmp_ge_u32 s32, 20
    s_cselect_b32 s43, 1, 0
    s_mul_i32 s44, s43, 20
    s_sub_u32 s44, s32, s44
    v_and_b32 v31, 7, v1
    v_lshlrev_b32 v31, 7, v31
    v_mov_b32 v4, s24
    v_lshlrev_b32 v4, 10, v4
    v_add_u32 v31, v31, v4
    v_mov_b32 v4, s43
    v_lshlrev_b32 v4, 12, v4
    v_add_u32 v31, v31, v4
    v_add_u32 v31, 1720320, v31
    v_lshrrev_b32 v27, 5, v1
    v_lshlrev_b32 v27, 14, v27
    v_mov_b32 v4, s32
    v_lshlrev_b32 v4, 7, v4
    v_add_u32 v27, v27, v4
    v_and_b32 v4, 31, v1
    v_lshlrev_b32 v4, 2, v4
    v_add_u32 v27, v27, v4
    v_add_u32 v27, 1736704, v27
    s_cmp_eq_u32 s24, 1
    s_cselect_b64 s[60:61], -1, 0
    v_mov_b32 v16, 8192
    v_mov_b32 v15, 1
    v_mov_b32 v14, 0
    ds_write_b32 v16, v14
    s_waitcnt lgkmcnt(0)
    s_barrier
    s_mov_b32 s33, 0
R_107:
    s_and_b32 s31, s33, 3
    s_mul_i32 s35, s31, 49152
    s_add_u32 s35, s35, s46
    s_add_u32 s35, s35, 131072
    s_add_u32 s36, s46, 327680
    s_lshl_b32 s40, s31, 15
    s_add_u32 s40, s40, s46
    s_add_u32 s31, s31, 1
    s_and_b32 s31, s31, 3
    s_lshl_b32 s39, s31, 15
    s_add_u32 s39, s39, s46
    v_mov_b32 v88, 0
    v_mov_b32 v89, 0
    v_mov_b32 v90, 0
    v_mov_b32 v91, 0
    v_mov_b32 v92, 0
    v_mov_b32 v93, 0
    v_mov_b32 v94, 0
    v_mov_b32 v95, 0
    s_add_u32 s42, s33, 1
    v_mov_b32 v28, s42
    v_mov_b32 v15, 1
    s_mov_b32 s30, 40
    buffer_load_dword v60, v31, s[4:7], s46 offen sc1
    s_sleep 4
HL_108:
    buffer_load_dword v61, v31, s[4:7], s46 offen sc1
    s_waitcnt vmcnt(1)
    v_cmp_ne_u32 vcc, s42, v60
    s_cbranch_vccz HK_109
    s_sleep 4
    buffer_load_dword v60, v31, s[4:7], s46 offen sc1
    s_waitcnt vmcnt(1)
    v_cmp_ne_u32 vcc, s42, v61
    s_cbranch_vccz HK_109
    s_sleep 4
    s_sub_u32 s30, s30, 1
    s_cmp_lg_u32 s30, 0
    s_cbranch_scc1 HL_108
HK_109:
    s_mov_b32 s30, 50000
L0_110:
    buffer_load_dwordx4 v[52:55], v19, s[4:7], s36 offen offset:0 sc1
    buffer_load_dwordx4 v[56:59], v19, s[4:7], s36 offen offset:1024 sc1
LP_111:
    buffer_load_dwordx4 v[48:51], v18, s[4:7], s35 offen sc1
    buffer_load_dwordx4 v[32:35], v17, s[4:7], s35 offen offset:0 sc1
    buffer_load_dwordx4 v[36:39], v17, s[4:7], s35 offen offset:1024 sc1
    buffer_load_dwordx4 v[40:43], v17, s[4:7], s35 offen offset:2048 sc1
    buffer_load_dwordx4 v[44:47], v17, s[4:7], s35 offen offset:3072 sc1
    s_waitcnt vmcnt(4)
    v_smfmac_f32_16x16x64_bf16 v[88:91], v[48:51], v[52:59], v30
    s_waitcnt vmcnt(3)
    v_smfmac_f32_16x16x64_bf16 v[92:95], v[32:35], v[96:103], v30
    s_waitcnt vmcnt(2)
    v_smfmac_f32_16x16x64_bf16 v[88:91], v[36:39], v[104:111], v30
    s_waitcnt vmcnt(1)
    v_smfmac_f32_16x16x64_bf16 v[92:95], v[40:43], v[112:119], v30
    s_waitcnt vmcnt(0)
    v_smfmac_f32_16x16x64_bf16 v[88:91], v[44:47], v[120:127], v30
HJ_116:
    v_max_u32 v6, v52, v56
    v_max3_u32 v4, v32, v36, v40
    v_max3_u32 v5, v44, v48, v50
    v_max3_u32 v4, v4, v5, v6
    v_cmp_eq_u32 vcc, -1, v4
    s_cbranch_vccz FIN_114_b
    s_nop 1
    v_mov_b32 v88, 0
    v_mov_b32 v89, 0
    v_mov_b32 v90, 0
    v_mov_b32 v91, 0
    v_mov_b32 v92, 0
    v_mov_b32 v93, 0
    v_mov_b32 v94, 0
    v_mov_b32 v95, 0
    s_sub_u32 s30, s30, 1
    s_cmp_eq_u32 s30, 0
    s_cbranch_scc1 EXIT
    v_cmp_eq_u32 vcc, -1, v6
    s_cbranch_vccz LP_111
    s_branch L0_110
FIN_114_b:
    s_nop 1
    v_add_f32 v88, v88, v92
    v_add_f32 v89, v89, v93
    v_add_f32 v90, v90, v94
    v_add_f32 v91, v91, v95
    v_permlane32_swap_b32 v88, v89
    s_nop 0
    v_permlane32_swap_b32 v90, v91
    v_add_f32 v88, v88, v89
    v_add_f32 v90, v90, v91
    ds_write_b32 v22, v88 offset:0
    ds_write_b32 v22, v90 offset:128
    s_waitcnt lgkmcnt(0)
    s_barrier
    s_cmp_lg_u32 s24, 0
    s_cbranch_scc1 NX_117
    ds_read_b64 v[32:33], v23 offset:0
    ds_read_b64 v[34:35], v23 offset:512
    ds_read_b64 v[36:37], v23 offset:1024
    ds_read_b64 v[38:39], v23 offset:1536
    s_waitcnt lgkmcnt(2)
    v_add_f32 v32, v32, v34
    v_add_f32 v33, v33, v35
    s_waitcnt lgkmcnt(0)
    v_add_f32 v36, v36, v38
    v_add_f32 v37, v37, v39
    v_add_f32 v32, v32, v36
    v_add_f32 v33, v33, v37
    v_cvt_pk_bf16_f32 v40, v32, v33
    v_min_u32 v40, -2, v40
    s_nop 1
    v_permlane16_swap_b32 v40, v41
    s_nop 1
    v_permlane32_swap_b32 v40, v42
    v_permlane32_swap_b32 v41, v43
    s_mov_b64 exec, 0xffff
    buffer_store_dwordx4 v[40:43], v24, s[4:7], s39 offen sc1
    buffer_store_dwordx4 v[180:183], v24, s[4:7], s40 offen sc1
    s_mov_b64 exec, -1
NX_117:
    s_barrier
    buffer_store_dwordx4 v[180:183], v19, s[4:7], s36 offen offset:0 sc1
    buffer_store_dwordx4 v[180:183], v19, s[4:7], s36 offen offset:1024 sc1
    buffer_store_dwordx4 v[52:55], v21, s[4:7], s55 offen offset:0 sc1
    buffer_store_dwordx4 v[56:59], v21, s[4:7], s55 offen offset:1024 sc1
    s_add_u32 s55, s55, 327680
    s_cmp_lg_u32 s24, 1
    s_cbranch_scc1 NZ_118
    s_cmp_eq_u32 s33, 0
    s_cbranch_scc1 NZ_118
    v_mov_b32 v4, 0
    v_mov_b32 v5, 1
    s_mov_b64 exec, 1
    buffer_store_dword v5, v4, s[4:7], s57 offen sc1
    s_mov_b64 exec, -1
NZ_118:
    s_add_u32 s57, s57, 256
    s_cmp_ge_u32 s58, 63
    s_cbranch_scc1 DK_119
    s_lshl_b32 s38, s58, 7
    s_mov_b32 s30, 50000
DL_120:
    v_cmp_ne_u32 vcc, 1, v29
    s_cbranch_vccz DO_121
    buffer_load_dword v29, v26, s[4:7], s38 offen sc1
    s_waitcnt vmcnt(0)
    s_sub_u32 s30, s30, 1
    s_cmp_lg_u32 s30, 0
    s_cbranch_scc1 DL_120
    s_endpgm
DO_121:
    s_add_u32 s31, s54, 4096
    buffer_load_dwordx4 v[96:99], v20, s[4:7], s54 offen offset:0 sc1
    buffer_load_dwordx4 v[100:103], v20, s[4:7], s54 offen offset:1024 sc1
    buffer_load_dwordx4 v[104:107], v20, s[4:7], s54 offen offset:2048 sc1
    buffer_load_dwordx4 v[108:111], v20, s[4:7], s54 offen offset:3072 sc1
    buffer_load_dwordx4 v[112:115], v20, s[4:7], s31 offen offset:0 sc1
    buffer_load_dwordx4 v[116:119], v20, s[4:7], s31 offen offset:1024 sc1
    buffer_load_dwordx4 v[120:123], v20, s[4:7], s31 offen offset:2048 sc1
    buffer_load_dwordx4 v[124:127], v20, s[4:7], s31 offen offset:3072 sc1
    s_add_u32 s38, s38, 128
    buffer_load_dword v29, v26, s[4:7], s38 offen sc1
DK_119:
    s_add_u32 s58, s58, 1
    s_add_u32 s54, s54, 1310720
    s_add_u32 s33, s33, 1
    s_cmp_eq_u32 s33, 63
    s_cbranch_scc1 R_END
    s_and_b32 s31, s33, 3
    s_mul_i32 s35, s31, 49152
    s_add_u32 s35, s35, s46
    s_add_u32 s35, s35, 131072
    s_add_u32 s36, s46, 983040
    s_lshl_b32 s40, s31, 15
    s_add_u32 s40, s40, s46
    s_add_u32 s31, s31, 1
    s_and_b32 s31, s31, 3
    s_lshl_b32 s39, s31, 15
    s_add_u32 s39, s39, s46
    v_mov_b32 v88, 0
    v_mov_b32 v89, 0
    v_mov_b32 v90, 0
    v_mov_b32 v91, 0
    v_mov_b32 v92, 0
    v_mov_b32 v93, 0
    v_mov_b32 v94, 0
    v_mov_b32 v95, 0
    s_add_u32 s42, s33, 1
    v_mov_b32 v28, s42
    v_mov_b32 v15, 1
    s_mov_b32 s30, 40
    buffer_load_dword v60, v31, s[4:7], s46 offen sc1
    s_sleep 4
HL_122:
    buffer_load_dword v61, v31, s[4:7], s46 offen sc1
    s_waitcnt vmcnt(1)
    v_cmp_ne_u32 vcc, s42, v60
    s_cbranch_vccz HK_123
    s_sleep 4
    buffer_load_dword v60, v31, s[4:7], s46 offen sc1
    s_waitcnt vmcnt(1)
    v_cmp_ne_u32 vcc, s42, v61
    s_cbranch_vccz HK_123
    s_sleep 4
    s_sub_u32 s30, s30, 1
    s_cmp_lg_u32 s30, 0
    s_cbranch_scc1 HL_122
HK_123:
    s_mov_b32 s30, 50000
L0_124:
    buffer_load_dwordx4 v[52:55], v19, s[4:7], s36 offen offset:0 sc1
    buffer_load_dwordx4 v[56:59], v19, s[4:7], s36 offen offset:1024 sc1
LP_125:
    buffer_load_dwordx4 v[48:51], v18, s[4:7], s35 offen sc1
    buffer_load_dwordx4 v[32:35], v17, s[4:7], s35 offen offset:0 sc1
    buffer_load_dwordx4 v[36:39], v17, s[4:7], s35 offen offset:1024 sc1
    buffer_load_dwordx4 v[40:43], v17, s[4:7], s35 offen offset:2048 sc1
    buffer_load_dwordx4 v[44:47], v17, s[4:7], s35 offen offset:3072 sc1
    s_waitcnt vmcnt(4)
    v_smfmac_f32_16x16x64_bf16 v[88:91], v[48:51], v[52:59], v30
    s_waitcnt vmcnt(3)
    v_smfmac_f32_16x16x64_bf16 v[92:95], v[32:35], v[128:135], v30
    s_waitcnt vmcnt(2)
    v_smfmac_f32_16x16x64_bf16 v[88:91], v[36:39], v[136:143], v30
    s_waitcnt vmcnt(1)
    v_smfmac_f32_16x16x64_bf16 v[92:95], v[40:43], v[144:151], v30
    s_waitcnt vmcnt(0)
    v_smfmac_f32_16x16x64_bf16 v[88:91], v[44:47], v[152:159], v30
HJ_130:
    v_max_u32 v6, v52, v56
    v_max3_u32 v4, v32, v36, v40
    v_max3_u32 v5, v44, v48, v50
    v_max3_u32 v4, v4, v5, v6
    v_cmp_eq_u32 vcc, -1, v4
    s_cbranch_vccz FIN_128_b
    s_nop 1
    v_mov_b32 v88, 0
    v_mov_b32 v89, 0
    v_mov_b32 v90, 0
    v_mov_b32 v91, 0
    v_mov_b32 v92, 0
    v_mov_b32 v93, 0
    v_mov_b32 v94, 0
    v_mov_b32 v95, 0
    s_sub_u32 s30, s30, 1
    s_cmp_eq_u32 s30, 0
    s_cbranch_scc1 EXIT
    v_cmp_eq_u32 vcc, -1, v6
    s_cbranch_vccz LP_125
    s_branch L0_124
FIN_128_b:
    s_nop 1
    v_add_f32 v88, v88, v92
    v_add_f32 v89, v89, v93
    v_add_f32 v90, v90, v94
    v_add_f32 v91, v91, v95
    v_permlane32_swap_b32 v88, v89
    s_nop 0
    v_permlane32_swap_b32 v90, v91
    v_add_f32 v88, v88, v89
    v_add_f32 v90, v90, v91
    ds_write_b32 v22, v88 offset:2048
    ds_write_b32 v22, v90 offset:2176
    s_waitcnt lgkmcnt(0)
    s_barrier
    s_cmp_lg_u32 s24, 0
    s_cbranch_scc1 NX_131
    ds_read_b64 v[32:33], v23 offset:2048
    ds_read_b64 v[34:35], v23 offset:2560
    ds_read_b64 v[36:37], v23 offset:3072
    ds_read_b64 v[38:39], v23 offset:3584
    s_waitcnt lgkmcnt(2)
    v_add_f32 v32, v32, v34
    v_add_f32 v33, v33, v35
    s_waitcnt lgkmcnt(0)
    v_add_f32 v36, v36, v38
    v_add_f32 v37, v37, v39
    v_add_f32 v32, v32, v36
    v_add_f32 v33, v33, v37
    v_cvt_pk_bf16_f32 v40, v32, v33
    v_min_u32 v40, -2, v40
    s_nop 1
    v_permlane16_swap_b32 v40, v41
    s_nop 1
    v_permlane32_swap_b32 v40, v42
    v_permlane32_swap_b32 v41, v43
    s_mov_b64 exec, 0xffff
    buffer_store_dwordx4 v[40:43], v24, s[4:7], s39 offen sc1
    buffer_store_dwordx4 v[180:183], v24, s[4:7], s40 offen sc1
    s_mov_b64 exec, -1
NX_131:
    s_barrier
    buffer_store_dwordx4 v[180:183], v19, s[4:7], s36 offen offset:0 sc1
    buffer_store_dwordx4 v[180:183], v19, s[4:7], s36 offen offset:1024 sc1
    buffer_store_dwordx4 v[52:55], v21, s[4:7], s55 offen offset:0 sc1
    buffer_store_dwordx4 v[56:59], v21, s[4:7], s55 offen offset:1024 sc1
    s_add_u32 s55, s55, 327680
    s_cmp_lg_u32 s24, 1
    s_cbranch_scc1 NZ_132
    s_cmp_eq_u32 s33, 0
    s_cbranch_scc1 NZ_132
    v_mov_b32 v4, 0
    v_mov_b32 v5, 1
    s_mov_b64 exec, 1
    buffer_store_dword v5, v4, s[4:7], s57 offen sc1
    s_mov_b64 exec, -1
NZ_132:
    s_add_u32 s57, s57, 256
    s_cmp_ge_u32 s58, 63
    s_cbranch_scc1 DK_133
    s_lshl_b32 s38, s58, 7
    s_mov_b32 s30, 50000
DL_134:
    v_cmp_ne_u32 vcc, 1, v29
    s_cbranch_vccz DO_135
    buffer_load_dword v29, v26, s[4:7], s38 offen sc1
    s_waitcnt vmcnt(0)
    s_sub_u32 s30, s30, 1
    s_cmp_lg_u32 s30, 0
    s_cbranch_scc1 DL_134
    s_endpgm
DO_135:
    s_add_u32 s31, s54, 4096
    buffer_load_dwordx4 v[128:131], v20, s[4:7], s54 offen offset:0 sc1
    buffer_load_dwordx4 v[132:135], v20, s[4:7], s54 offen offset:1024 sc1
    buffer_load_dwordx4 v[136:139], v20, s[4:7], s54 offen offset:2048 sc1
    buffer_load_dwordx4 v[140:143], v20, s[4:7], s54 offen offset:3072 sc1
    buffer_load_dwordx4 v[144:147], v20, s[4:7], s31 offen offset:0 sc1
    buffer_load_dwordx4 v[148:151], v20, s[4:7], s31 offen offset:1024 sc1
    buffer_load_dwordx4 v[152:155], v20, s[4:7], s31 offen offset:2048 sc1
    buffer_load_dwordx4 v[156:159], v20, s[4:7], s31 offen offset:3072 sc1
    s_add_u32 s38, s38, 128
    buffer_load_dword v29, v26, s[4:7], s38 offen sc1
DK_133:
    s_add_u32 s58, s58, 1
    s_add_u32 s54, s54, 1310720
    s_add_u32 s33, s33, 1
    s_branch R_107
R_END:
    s_add_u32 s36, s46, 983040
    s_mov_b32 s30, 50000
LZ_136:
    buffer_load_dwordx4 v[52:55], v19, s[4:7], s36 offen offset:0 sc1
    buffer_load_dwordx4 v[56:59], v19, s[4:7], s36 offen offset:1024 sc1
    s_waitcnt vmcnt(0)
    v_max_u32 v4, v52, v56
    v_cmp_eq_u32 vcc, -1, v4
    s_cbranch_vccz FZ_137
    s_sub_u32 s30, s30, 1
    s_cmp_lg_u32 s30, 0
    s_cbranch_scc1 LZ_136
    s_endpgm
FZ_137:
    s_barrier
    buffer_store_dwordx4 v[52:55], v21, s[4:7], s55 offen offset:0 sc1
    buffer_store_dwordx4 v[56:59], v21, s[4:7], s55 offen offset:1024 sc1
    s_add_u32 s55, s55, 327680
    s_cmp_lg_u32 s24, 1
    s_cbranch_scc1 NZ_138
    s_cmp_eq_u32 s33, 0
    s_cbranch_scc1 NZ_138
    v_mov_b32 v4, 0
    v_mov_b32 v5, 1
    s_mov_b64 exec, 1
    buffer_store_dword v5, v4, s[4:7], s57 offen sc1
    s_mov_b64 exec, -1
NZ_138:
    s_add_u32 s57, s57, 256
    s_waitcnt vmcnt(0)
    s_barrier
    s_cmp_lg_u32 s24, 1
    s_cbranch_scc1 NZ_139
    s_cmp_eq_u32 s33, 0
    s_cbranch_scc1 NZ_139
    v_mov_b32 v4, 0
    v_mov_b32 v5, 1
    s_mov_b64 exec, 1
    buffer_store_dword v5, v4, s[4:7], s57 offen sc1
    s_mov_b64 exec, -1
NZ_139:
    s_add_u32 s57, s57, 256
    s_waitcnt vmcnt(0)
    s_branch EXIT
R_VO:
    s_mov_b32 s32, s25
    s_mov_b32 s8, s78
    s_mov_b32 s9, s79
    s_mov_b32 s10, 5242880
    s_mov_b32 s11, 0x00020000
    s_mov_b32 s12, s80
    s_mov_b32 s13, s81
    s_mov_b32 s14, 5242880
    s_mov_b32 s15, 0x00020000
    v_lshrrev_b32 v10, 4, v1
    v_mov_b32 v4, s24
    v_mul_u32_u24 v4, 4, v4
    v_add_u32 v10, v10, v4
    v_mul_u32_u24 v10, 8192, v10
    v_and_b32 v4, 15, v1
    v_lshrrev_b32 v5, 4, v1
    v_lshlrev_b32 v5, 1, v5
    v_xor_b32 v4, v4, v5
    v_lshlrev_b32 v4, 4, v4
    v_add_u32 v10, v10, v4
    v_lshrrev_b32 v15, 4, v1
    v_mov_b32 v4, s24
    v_mul_u32_u24 v4, 4, v4
    v_add_u32 v15, v15, v4
    v_mul_u32_u24 v15, 1280, v15
    v_and_b32 v4, 15, v1
    v_lshrrev_b32 v5, 4, v1
    v_lshlrev_b32 v5, 1, v5
    v_xor_b32 v4, v4, v5
    v_lshlrev_b32 v4, 4, v4
    v_add_u32 v15, v15, v4
    v_mul_u32_u24 v11, 2176, v3
    v_and_b32 v4, 15, v1
    v_lshrrev_b32 v4, 2, v4
    v_lshlrev_b32 v4, 8, v4
    v_add_u32 v11, v11, v4
    v_mov_b32 v4, s24
    v_mul_u32_u24 v4, 2, v4
    v_add_u32 v4, 0, v4
    v_and_b32 v5, 15, v1
    v_lshrrev_b32 v5, 2, v5
    v_xor_b32 v4, v4, v5
    v_lshlrev_b32 v4, 5, v4
    v_add_u32 v11, v11, v4
    v_and_b32 v4, 3, v1
    v_lshlrev_b32 v4, 3, v4
    v_add_u32 v11, v11, v4
    v_lshrrev_b32 v9, 1, v3
    v_lshlrev_b32 v9, 3, v9
    v_and_b32 v4, 1, v3
    v_lshlrev_b32 v4, 1, v4
    v_add_u32 v9, v9, v4
    v_add_u32 v9, 0, v9
    v_and_b32 v4, 15, v1
    v_lshrrev_b32 v4, 2, v4
    v_and_b32 v4, 1, v4
    v_lshlrev_b32 v4, 4, v4
    v_add_u32 v9, v9, v4
    v_and_b32 v4, 15, v1
    v_lshrrev_b32 v4, 2, v4
    v_lshrrev_b32 v4, 1, v4
    v_lshlrev_b32 v4, 2, v4
    v_add_u32 v9, v9, v4
    v_lshrrev_b32 v16, 2, v9
    v_mul_u32_u24 v16, 1088, v16
    v_and_b32 v4, 3, v9
    v_lshlrev_b32 v4, 8, v4
    v_add_u32 v16, v16, v4
    v_mov_b32 v4, s24
    v_mul_u32_u24 v4, 2, v4
    v_add_u32 v4, 0, v4
    v_and_b32 v5, 3, v9
    v_xor_b32 v4, v4, v5
    v_lshlrev_b32 v4, 5, v4
    v_add_u32 v16, v16, v4
    v_and_b32 v4, 3, v1
    v_lshlrev_b32 v4, 3, v4
    v_add_u32 v16, v16, v4
    v_lshrrev_b32 v9, 1, v3
    v_lshlrev_b32 v9, 3, v9
    v_and_b32 v4, 1, v3
    v_lshlrev_b32 v4, 1, v4
    v_add_u32 v9, v9, v4
    v_add_u32 v9, 1, v9
    v_and_b32 v4, 15, v1
    v_lshrrev_b32 v4, 2, v4
    v_and_b32 v4, 1, v4
    v_lshlrev_b32 v4, 4, v4
    v_add_u32 v9, v9, v4
    v_and_b32 v4, 15, v1
    v_lshrrev_b32 v4, 2, v4
    v_lshrrev_b32 v4, 1, v4
    v_lshlrev_b32 v4, 2, v4
    v_add_u32 v9, v9, v4
    v_lshrrev_b32 v18, 2, v9
    v_mul_u32_u24 v18, 1088, v18
    v_and_b32 v4, 3, v9
    v_lshlrev_b32 v4, 8, v4
    v_add_u32 v18, v18, v4
    v_mov_b32 v4, s24
    v_mul_u32_u24 v4, 2, v4
    v_add_u32 v4, 0, v4
    v_and_b32 v5, 3, v9
    v_xor_b32 v4, v4, v5
    v_lshlrev_b32 v4, 5, v4
    v_add_u32 v18, v18, v4
    v_and_b32 v4, 3, v1
    v_lshlrev_b32 v4, 3, v4
    v_add_u32 v18, v18, v4
    v_mul_u32_u24 v12, 2176, v3
    v_and_b32 v4, 15, v1
    v_lshrrev_b32 v4, 2, v4
    v_lshlrev_b32 v4, 8, v4
    v_add_u32 v12, v12, v4
    v_mov_b32 v4, s24
    v_mul_u32_u24 v4, 2, v4
    v_add_u32 v4, 1, v4
    v_and_b32 v5, 15, v1
    v_lshrrev_b32 v5, 2, v5
    v_xor_b32 v4, v4, v5
    v_lshlrev_b32 v4, 5, v4
    v_add_u32 v12, v12, v4
    v_and_b32 v4, 3, v1
    v_lshlrev_b32 v4, 3, v4
    v_add_u32 v12, v12, v4
    v_lshrrev_b32 v9, 1, v3
    v_lshlrev_b32 v9, 3, v9
    v_and_b32 v4, 1, v3
    v_lshlrev_b32 v4, 1, v4
    v_add_u32 v9, v9, v4
    v_add_u32 v9, 0, v9
    v_and_b32 v4, 15, v1
    v_lshrrev_b32 v4, 2, v4
    v_and_b32 v4, 1, v4
    v_lshlrev_b32 v4, 4, v4
    v_add_u32 v9, v9, v4
    v_and_b32 v4, 15, v1
    v_lshrrev_b32 v4, 2, v4
    v_lshrrev_b32 v4, 1, v4
    v_lshlrev_b32 v4, 2, v4
    v_add_u32 v9, v9, v4
    v_lshrrev_b32 v17, 2, v9
    v_mul_u32_u24 v17, 1088, v17
    v_and_b32 v4, 3, v9
    v_lshlrev_b32 v4, 8, v4
    v_add_u32 v17, v17, v4
    v_mov_b32 v4, s24
    v_mul_u32_u24 v4, 2, v4
    v_add_u32 v4, 1, v4
    v_and_b32 v5, 3, v9
    v_xor_b32 v4, v4, v5
    v_lshlrev_b32 v4, 5, v4
    v_add_u32 v17, v17, v4
    v_and_b32 v4, 3, v1
    v_lshlrev_b32 v4, 3, v4
    v_add_u32 v17, v17, v4
    v_lshrrev_b32 v9, 1, v3
    v_lshlrev_b32 v9, 3, v9
    v_and_b32 v4, 1, v3
    v_lshlrev_b32 v4, 1, v4
    v_add_u32 v9, v9, v4
    v_add_u32 v9, 1, v9
    v_and_b32 v4, 15, v1
    v_lshrrev_b32 v4, 2, v4
    v_and_b32 v4, 1, v4
    v_lshlrev_b32 v4, 4, v4
    v_add_u32 v9, v9, v4
    v_and_b32 v4, 15, v1
    v_lshrrev_b32 v4, 2, v4
    v_lshrrev_b32 v4, 1, v4
    v_lshlrev_b32 v4, 2, v4
    v_add_u32 v9, v9, v4
    v_lshrrev_b32 v19, 2, v9
    v_mul_u32_u24 v19, 1088, v19
    v_and_b32 v4, 3, v9
    v_lshlrev_b32 v4, 8, v4
    v_add_u32 v19, v19, v4
    v_mov_b32 v4, s24
    v_mul_u32_u24 v4, 2, v4
    v_add_u32 v4, 1, v4
    v_and_b32 v5, 3, v9
    v_xor_b32 v4, v4, v5
    v_lshlrev_b32 v4, 5, v4
    v_add_u32 v19, v19, v4
    v_and_b32 v4, 3, v1
    v_lshlrev_b32 v4, 3, v4
    v_add_u32 v19, v19, v4
    v_add_u32 v20, 69632, v11
    v_add_u32 v21, 69632, v12
    v_add_u32 v25, 69632, v16
    v_add_u32 v26, 69632, v17
    v_add_u32 v27, 69632, v18
    v_add_u32 v28, 69632, v19
    s_lshl_b32 s28, s32, 8
    s_mul_i32 s29, s32, 163840
    s_mul_i32 s26, s24, 1088
    s_add_u32 m0, s26, 0
    s_add_u32 s27, s28, 0
    buffer_load_dwordx4 v10, s[8:11], s27 offen lds
    s_add_u32 m0, s26, 4352
    s_add_u32 s27, s28, 131072
    buffer_load_dwordx4 v10, s[8:11], s27 offen lds
    s_add_u32 m0, s26, 8704
    s_add_u32 s27, s28, 262144
    buffer_load_dwordx4 v10, s[8:11], s27 offen lds
    s_add_u32 m0, s26, 13056
    s_add_u32 s27, s28, 393216
    buffer_load_dwordx4 v10, s[8:11], s27 offen lds
    s_add_u32 m0, s26, 17408
    s_add_u32 s27, s28, 524288
    buffer_load_dwordx4 v10, s[8:11], s27 offen lds
    s_add_u32 m0, s26, 21760
    s_add_u32 s27, s28, 655360
    buffer_load_dwordx4 v10, s[8:11], s27 offen lds
    s_add_u32 m0, s26, 26112
    s_add_u32 s27, s28, 786432
    buffer_load_dwordx4 v10, s[8:11], s27 offen lds
    s_add_u32 m0, s26, 30464
    s_add_u32 s27, s28, 917504
    buffer_load_dwordx4 v10, s[8:11], s27 offen lds
    s_add_u32 m0, s26, 34816
    s_add_u32 s27, s28, 1048576
    buffer_load_dwordx4 v10, s[8:11], s27 offen lds
    s_add_u32 m0, s26, 39168
    s_add_u32 s27, s28, 1179648
    buffer_load_dwordx4 v10, s[8:11], s27 offen lds
    s_add_u32 m0, s26, 43520
    s_add_u32 s27, s28, 1310720
    buffer_load_dwordx4 v10, s[8:11], s27 offen lds
    s_add_u32 m0, s26, 47872
    s_add_u32 s27, s28, 1441792
    buffer_load_dwordx4 v10, s[8:11], s27 offen lds
    s_add_u32 m0, s26, 52224
    s_add_u32 s27, s28, 1572864
    buffer_load_dwordx4 v10, s[8:11], s27 offen lds
    s_add_u32 m0, s26, 56576
    s_add_u32 s27, s28, 1703936
    buffer_load_dwordx4 v10, s[8:11], s27 offen lds
    s_add_u32 m0, s26, 60928
    s_add_u32 s27, s28, 1835008
    buffer_load_dwordx4 v10, s[8:11], s27 offen lds
    s_add_u32 m0, s26, 65280
    s_add_u32 s27, s28, 1966080
    buffer_load_dwordx4 v10, s[8:11], s27 offen lds
    s_add_u32 m0, s26, 69632
    s_add_u32 s27, s28, 2097152
    buffer_load_dwordx4 v10, s[8:11], s27 offen lds
    s_add_u32 m0, s26, 73984
    s_add_u32 s27, s28, 2228224
    buffer_load_dwordx4 v10, s[8:11], s27 offen lds
    s_add_u32 m0, s26, 78336
    s_add_u32 s27, s28, 2359296
    buffer_load_dwordx4 v10, s[8:11], s27 offen lds
    s_add_u32 m0, s26, 82688
    s_add_u32 s27, s28, 2490368
    buffer_load_dwordx4 v10, s[8:11], s27 offen lds
    s_add_u32 m0, s26, 87040
    s_add_u32 s27, s28, 2621440
    buffer_load_dwordx4 v10, s[8:11], s27 offen lds
    s_add_u32 m0, s26, 91392
    s_add_u32 s27, s28, 2752512
    buffer_load_dwordx4 v10, s[8:11], s27 offen lds
    s_add_u32 m0, s26, 95744
    s_add_u32 s27, s28, 2883584
    buffer_load_dwordx4 v10, s[8:11], s27 offen lds
    s_add_u32 m0, s26, 100096
    s_add_u32 s27, s28, 3014656
    buffer_load_dwordx4 v10, s[8:11], s27 offen lds
    s_add_u32 m0, s26, 104448
    s_add_u32 s27, s28, 3145728
    buffer_load_dwordx4 v10, s[8:11], s27 offen lds
    s_add_u32 m0, s26, 108800
    s_add_u32 s27, s28, 3276800
    buffer_load_dwordx4 v10, s[8:11], s27 offen lds
    s_add_u32 m0, s26, 113152
    s_add_u32 s27, s28, 3407872
    buffer_load_dwordx4 v10, s[8:11], s27 offen lds
    s_add_u32 m0, s26, 117504
    s_add_u32 s27, s28, 3538944
    buffer_load_dwordx4 v10, s[8:11], s27 offen lds
    s_add_u32 m0, s26, 121856
    s_add_u32 s27, s28, 3670016
    buffer_load_dwordx4 v10, s[8:11], s27 offen lds
    s_add_u32 m0, s26, 126208
    s_add_u32 s27, s28, 3801088
    buffer_load_dwordx4 v10, s[8:11], s27 offen lds
    s_add_u32 m0, s26, 130560
    s_add_u32 s27, s28, 3932160
    buffer_load_dwordx4 v10, s[8:11], s27 offen lds
    s_add_u32 m0, s26, 134912
    s_add_u32 s27, s28, 4063232
    buffer_load_dwordx4 v10, s[8:11], s27 offen lds
    s_waitcnt vmcnt(16)
    s_barrier
    ds_read_b64_tr_b16 a[0:1], v11 offset:0
    ds_read_b64_tr_b16 a[2:3], v11 offset:1088
    ds_read_b64_tr_b16 a[4:5], v11 offset:8704
    ds_read_b64_tr_b16 a[6:7], v11 offset:9792
    ds_read_b64_tr_b16 a[8:9], v11 offset:17408
    ds_read_b64_tr_b16 a[10:11], v11 offset:18496
    ds_read_b64_tr_b16 a[12:13], v11 offset:26112
    ds_read_b64_tr_b16 a[14:15], v11 offset:27200
    ds_read_b64_tr_b16 a[16:17], v11 offset:34816
    ds_read_b64_tr_b16 a[18:19], v11 offset:35904
    ds_read_b64_tr_b16 a[20:21], v11 offset:43520
    ds_read_b64_tr_b16 a[22:23], v11 offset:44608
    ds_read_b64_tr_b16 a[24:25], v11 offset:52224
    ds_read_b64_tr_b16 a[26:27], v11 offset:53312
    ds_read_b64_tr_b16 a[28:29], v11 offset:60928
    ds_read_b64_tr_b16 a[30:31], v11 offset:62016
    ds_read_b64_tr_b16 a[80:81], v12 offset:0
    ds_read_b64_tr_b16 a[82:83], v12 offset:1088
    ds_read_b64_tr_b16 a[84:85], v12 offset:8704
    ds_read_b64_tr_b16 a[86:87], v12 offset:9792
    ds_read_b64_tr_b16 a[88:89], v12 offset:17408
    ds_read_b64_tr_b16 a[90:91], v12 offset:18496
    ds_read_b64_tr_b16 a[92:93], v12 offset:26112
    ds_read_b64_tr_b16 a[94:95], v12 offset:27200
    ds_read_b64_tr_b16 a[96:97], v12 offset:34816
    ds_read_b64_tr_b16 a[98:99], v12 offset:35904
    ds_read_b64_tr_b16 a[100:101], v12 offset:43520
    ds_read_b64_tr_b16 a[102:103], v12 offset:44608
    ds_read_b64_tr_b16 a[104:105], v12 offset:52224
    ds_read_b64_tr_b16 a[106:107], v12 offset:53312
    ds_read_b64_tr_b16 a[108:109], v12 offset:60928
    ds_read_b64_tr_b16 a[110:111], v12 offset:62016
    s_waitcnt lgkmcnt(0)
    s_barrier
    s_add_u32 m0, s26, 0
    s_add_u32 s27, s28, 4194304
    buffer_load_dwordx4 v10, s[8:11], s27 offen lds
    s_add_u32 m0, s26, 4352
    s_add_u32 s27, s28, 4325376
    buffer_load_dwordx4 v10, s[8:11], s27 offen lds
    s_add_u32 m0, s26, 8704
    s_add_u32 s27, s28, 4456448
    buffer_load_dwordx4 v10, s[8:11], s27 offen lds
    s_add_u32 m0, s26, 13056
    s_add_u32 s27, s28, 4587520
    buffer_load_dwordx4 v10, s[8:11], s27 offen lds
    s_add_u32 m0, s26, 17408
    s_add_u32 s27, s28, 4718592
    buffer_load_dwordx4 v10, s[8:11], s27 offen lds
    s_add_u32 m0, s26, 21760
    s_add_u32 s27, s28, 4849664
    buffer_load_dwordx4 v10, s[8:11], s27 offen lds
    s_add_u32 m0, s26, 26112
    s_add_u32 s27, s28, 4980736
    buffer_load_dwordx4 v10, s[8:11], s27 offen lds
    s_add_u32 m0, s26, 30464
    s_add_u32 s27, s28, 5111808
    buffer_load_dwordx4 v10, s[8:11], s27 offen lds
    s_add_u32 m0, s26, 34816
    s_add_u32 s27, s29, 0
    buffer_load_dwordx4 v15, s[12:15], s27 offen lds
    s_add_u32 m0, s26, 39168
    s_add_u32 s27, s29, 20480
    buffer_load_dwordx4 v15, s[12:15], s27 offen lds
    s_add_u32 m0, s26, 43520
    s_add_u32 s27, s29, 40960
    buffer_load_dwordx4 v15, s[12:15], s27 offen lds
    s_add_u32 m0, s26, 47872
    s_add_u32 s27, s29, 61440
    buffer_load_dwordx4 v15, s[12:15], s27 offen lds
    s_add_u32 m0, s26, 52224
    s_add_u32 s27, s29, 81920
    buffer_load_dwordx4 v15, s[12:15], s27 offen lds
    s_add_u32 m0, s26, 56576
    s_add_u32 s27, s29, 102400
    buffer_load_dwordx4 v15, s[12:15], s27 offen lds
    s_add_u32 m0, s26, 60928
    s_add_u32 s27, s29, 122880
    buffer_load_dwordx4 v15, s[12:15], s27 offen lds
    s_add_u32 m0, s26, 65280
    s_add_u32 s27, s29, 143360
    buffer_load_dwordx4 v15, s[12:15], s27 offen lds
    s_waitcnt vmcnt(16)
    s_barrier
    ds_read_b64_tr_b16 a[32:33], v20 offset:0
    ds_read_b64_tr_b16 a[34:35], v20 offset:1088
    ds_read_b64_tr_b16 a[36:37], v20 offset:8704
    ds_read_b64_tr_b16 a[38:39], v20 offset:9792
    ds_read_b64_tr_b16 a[40:41], v20 offset:17408
    ds_read_b64_tr_b16 a[42:43], v20 offset:18496
    ds_read_b64_tr_b16 a[44:45], v20 offset:26112
    ds_read_b64_tr_b16 a[46:47], v20 offset:27200
    ds_read_b64_tr_b16 a[48:49], v20 offset:34816
    ds_read_b64_tr_b16 a[50:51], v20 offset:35904
    ds_read_b64_tr_b16 a[52:53], v20 offset:43520
    ds_read_b64_tr_b16 a[54:55], v20 offset:44608
    ds_read_b64_tr_b16 a[56:57], v20 offset:52224
    ds_read_b64_tr_b16 a[58:59], v20 offset:53312
    ds_read_b64_tr_b16 a[60:61], v20 offset:60928
    ds_read_b64_tr_b16 a[62:63], v20 offset:62016
    ds_read_b64_tr_b16 a[112:113], v21 offset:0
    ds_read_b64_tr_b16 a[114:115], v21 offset:1088
    ds_read_b64_tr_b16 a[116:117], v21 offset:8704
    ds_read_b64_tr_b16 a[118:119], v21 offset:9792
    ds_read_b64_tr_b16 a[120:121], v21 offset:17408
    ds_read_b64_tr_b16 a[122:123], v21 offset:18496
    ds_read_b64_tr_b16 a[124:125], v21 offset:26112
    ds_read_b64_tr_b16 a[126:127], v21 offset:27200
    ds_read_b64_tr_b16 a[128:129], v21 offset:34816
    ds_read_b64_tr_b16 a[130:131], v21 offset:35904
    ds_read_b64_tr_b16 a[132:133], v21 offset:43520
    ds_read_b64_tr_b16 a[134:135], v21 offset:44608
    ds_read_b64_tr_b16 a[136:137], v21 offset:52224
    ds_read_b64_tr_b16 a[138:139], v21 offset:53312
    ds_read_b64_tr_b16 a[140:141], v21 offset:60928
    ds_read_b64_tr_b16 a[142:143], v21 offset:62016
    s_waitcnt lgkmcnt(0)
    s_barrier
    s_add_u32 m0, s26, 69632
    s_add_u32 s27, s29, 256
    buffer_load_dwordx4 v15, s[12:15], s27 offen lds
    s_add_u32 m0, s26, 73984
    s_add_u32 s27, s29, 20736
    buffer_load_dwordx4 v15, s[12:15], s27 offen lds
    s_add_u32 m0, s26, 78336
    s_add_u32 s27, s29, 41216
    buffer_load_dwordx4 v15, s[12:15], s27 offen lds
    s_add_u32 m0, s26, 82688
    s_add_u32 s27, s29, 61696
    buffer_load_dwordx4 v15, s[12:15], s27 offen lds
    s_add_u32 m0, s26, 87040
    s_add_u32 s27, s29, 82176
    buffer_load_dwordx4 v15, s[12:15], s27 offen lds
    s_add_u32 m0, s26, 91392
    s_add_u32 s27, s29, 102656
    buffer_load_dwordx4 v15, s[12:15], s27 offen lds
    s_add_u32 m0, s26, 95744
    s_add_u32 s27, s29, 123136
    buffer_load_dwordx4 v15, s[12:15], s27 offen lds
    s_add_u32 m0, s26, 100096
    s_add_u32 s27, s29, 143616
    buffer_load_dwordx4 v15, s[12:15], s27 offen lds
    s_add_u32 m0, s26, 104448
    s_add_u32 s27, s29, 512
    buffer_load_dwordx4 v15, s[12:15], s27 offen lds
    s_add_u32 m0, s26, 108800
    s_add_u32 s27, s29, 20992
    buffer_load_dwordx4 v15, s[12:15], s27 offen lds
    s_add_u32 m0, s26, 113152
    s_add_u32 s27, s29, 41472
    buffer_load_dwordx4 v15, s[12:15], s27 offen lds
    s_add_u32 m0, s26, 117504
    s_add_u32 s27, s29, 61952
    buffer_load_dwordx4 v15, s[12:15], s27 offen lds
    s_add_u32 m0, s26, 121856
    s_add_u32 s27, s29, 82432
    buffer_load_dwordx4 v15, s[12:15], s27 offen lds
    s_add_u32 m0, s26, 126208
    s_add_u32 s27, s29, 102912
    buffer_load_dwordx4 v15, s[12:15], s27 offen lds
    s_add_u32 m0, s26, 130560
    s_add_u32 s27, s29, 123392
    buffer_load_dwordx4 v15, s[12:15], s27 offen lds
    s_add_u32 m0, s26, 134912
    s_add_u32 s27, s29, 143872
    buffer_load_dwordx4 v15, s[12:15], s27 offen lds
    s_waitcnt vmcnt(16)
    s_barrier
    ds_read_b64_tr_b16 a[64:65], v11 offset:0
    ds_read_b64_tr_b16 a[66:67], v11 offset:1088
    ds_read_b64_tr_b16 a[68:69], v11 offset:8704
    ds_read_b64_tr_b16 a[70:71], v11 offset:9792
    ds_read_b64_tr_b16 a[72:73], v11 offset:17408
    ds_read_b64_tr_b16 a[74:75], v11 offset:18496
    ds_read_b64_tr_b16 a[76:77], v11 offset:26112
    ds_read_b64_tr_b16 a[78:79], v11 offset:27200
    ds_read_b64_tr_b16 a[144:145], v12 offset:0
    ds_read_b64_tr_b16 a[146:147], v12 offset:1088
    ds_read_b64_tr_b16 a[148:149], v12 offset:8704
    ds_read_b64_tr_b16 a[150:151], v12 offset:9792
    ds_read_b64_tr_b16 a[152:153], v12 offset:17408
    ds_read_b64_tr_b16 a[154:155], v12 offset:18496
    ds_read_b64_tr_b16 a[156:157], v12 offset:26112
    ds_read_b64_tr_b16 a[158:159], v12 offset:27200
    ds_read_b64_tr_b16 a[160:161], v16 offset:34816
    ds_read_b64_tr_b16 a[162:163], v18 offset:34816
    ds_read_b64_tr_b16 a[164:165], v16 offset:43520
    ds_read_b64_tr_b16 a[166:167], v18 offset:43520
    ds_read_b64_tr_b16 a[168:169], v16 offset:52224
    ds_read_b64_tr_b16 a[170:171], v18 offset:52224
    ds_read_b64_tr_b16 a[172:173], v16 offset:60928
    ds_read_b64_tr_b16 a[174:175], v18 offset:60928
    ds_read_b64_tr_b16 a[176:177], v17 offset:34816
    ds_read_b64_tr_b16 a[178:179], v19 offset:34816
    ds_read_b64_tr_b16 a[180:181], v17 offset:43520
    ds_read_b64_tr_b16 a[182:183], v19 offset:43520
    ds_read_b64_tr_b16 a[184:185], v17 offset:52224
    ds_read_b64_tr_b16 a[186:187], v19 offset:52224
    ds_read_b64_tr_b16 a[188:189], v17 offset:60928
    ds_read_b64_tr_b16 a[190:191], v19 offset:60928
    s_waitcnt lgkmcnt(0)
    s_barrier
    s_add_u32 m0, s26, 0
    s_add_u32 s27, s29, 768
    buffer_load_dwordx4 v15, s[12:15], s27 offen lds
    s_add_u32 m0, s26, 4352
    s_add_u32 s27, s29, 21248
    buffer_load_dwordx4 v15, s[12:15], s27 offen lds
    s_add_u32 m0, s26, 8704
    s_add_u32 s27, s29, 41728
    buffer_load_dwordx4 v15, s[12:15], s27 offen lds
    s_add_u32 m0, s26, 13056
    s_add_u32 s27, s29, 62208
    buffer_load_dwordx4 v15, s[12:15], s27 offen lds
    s_add_u32 m0, s26, 17408
    s_add_u32 s27, s29, 82688
    buffer_load_dwordx4 v15, s[12:15], s27 offen lds
    s_add_u32 m0, s26, 21760
    s_add_u32 s27, s29, 103168
    buffer_load_dwordx4 v15, s[12:15], s27 offen lds
    s_add_u32 m0, s26, 26112
    s_add_u32 s27, s29, 123648
    buffer_load_dwordx4 v15, s[12:15], s27 offen lds
    s_add_u32 m0, s26, 30464
    s_add_u32 s27, s29, 144128
    buffer_load_dwordx4 v15, s[12:15], s27 offen lds
    s_add_u32 m0, s26, 34816
    s_add_u32 s27, s29, 1024
    buffer_load_dwordx4 v15, s[12:15], s27 offen lds
    s_add_u32 m0, s26, 39168
    s_add_u32 s27, s29, 21504
    buffer_load_dwordx4 v15, s[12:15], s27 offen lds
    s_add_u32 m0, s26, 43520
    s_add_u32 s27, s29, 41984
    buffer_load_dwordx4 v15, s[12:15], s27 offen lds
    s_add_u32 m0, s26, 47872
    s_add_u32 s27, s29, 62464
    buffer_load_dwordx4 v15, s[12:15], s27 offen lds
    s_add_u32 m0, s26, 52224
    s_add_u32 s27, s29, 82944
    buffer_load_dwordx4 v15, s[12:15], s27 offen lds
    s_add_u32 m0, s26, 56576
    s_add_u32 s27, s29, 103424
    buffer_load_dwordx4 v15, s[12:15], s27 offen lds
    s_add_u32 m0, s26, 60928
    s_add_u32 s27, s29, 123904
    buffer_load_dwordx4 v15, s[12:15], s27 offen lds
    s_add_u32 m0, s26, 65280
    s_add_u32 s27, s29, 144384
    buffer_load_dwordx4 v15, s[12:15], s27 offen lds
    s_waitcnt vmcnt(16)
    s_barrier
    ds_read_b64_tr_b16 a[192:193], v25 offset:0
    ds_read_b64_tr_b16 a[194:195], v27 offset:0
    ds_read_b64_tr_b16 a[196:197], v25 offset:8704
    ds_read_b64_tr_b16 a[198:199], v27 offset:8704
    ds_read_b64_tr_b16 a[200:201], v25 offset:17408
    ds_read_b64_tr_b16 a[202:203], v27 offset:17408
    ds_read_b64_tr_b16 a[204:205], v25 offset:26112
    ds_read_b64_tr_b16 a[206:207], v27 offset:26112
    ds_read_b64_tr_b16 a[208:209], v26 offset:0
    ds_read_b64_tr_b16 a[210:211], v28 offset:0
    ds_read_b64_tr_b16 a[212:213], v26 offset:8704
    ds_read_b64_tr_b16 a[214:215], v28 offset:8704
    ds_read_b64_tr_b16 a[216:217], v26 offset:17408
    ds_read_b64_tr_b16 a[218:219], v28 offset:17408
    ds_read_b64_tr_b16 a[220:221], v26 offset:26112
    ds_read_b64_tr_b16 a[222:223], v28 offset:26112
    ds_read_b64_tr_b16 a[224:225], v25 offset:34816
    ds_read_b64_tr_b16 a[226:227], v27 offset:34816
    ds_read_b64_tr_b16 a[228:229], v25 offset:43520
    ds_read_b64_tr_b16 a[230:231], v27 offset:43520
    ds_read_b64_tr_b16 a[232:233], v25 offset:52224
    ds_read_b64_tr_b16 a[234:235], v27 offset:52224
    ds_read_b64_tr_b16 a[236:237], v25 offset:60928
    ds_read_b64_tr_b16 a[238:239], v27 offset:60928
    ds_read_b64_tr_b16 a[240:241], v26 offset:34816
    ds_read_b64_tr_b16 a[242:243], v28 offset:34816
    ds_read_b64_tr_b16 a[244:245], v26 offset:43520
    ds_read_b64_tr_b16 a[246:247], v28 offset:43520
    ds_read_b64_tr_b16 a[248:249], v26 offset:52224
    ds_read_b64_tr_b16 a[250:251], v28 offset:52224
    ds_read_b64_tr_b16 a[252:253], v26 offset:60928
    ds_read_b64_tr_b16 a[254:255], v28 offset:60928
    s_waitcnt lgkmcnt(0)
    s_barrier
    s_waitcnt vmcnt(0)
    s_barrier
    ds_read_b64_tr_b16 v[192:193], v16 offset:0
    ds_read_b64_tr_b16 v[194:195], v18 offset:0
    ds_read_b64_tr_b16 v[196:197], v16 offset:8704
    ds_read_b64_tr_b16 v[198:199], v18 offset:8704
    ds_read_b64_tr_b16 v[200:201], v16 offset:17408
    ds_read_b64_tr_b16 v[202:203], v18 offset:17408
    ds_read_b64_tr_b16 v[204:205], v16 offset:26112
    ds_read_b64_tr_b16 v[206:207], v18 offset:26112
    ds_read_b64_tr_b16 v[208:209], v17 offset:0
    ds_read_b64_tr_b16 v[210:211], v19 offset:0
    ds_read_b64_tr_b16 v[212:213], v17 offset:8704
    ds_read_b64_tr_b16 v[214:215], v19 offset:8704
    ds_read_b64_tr_b16 v[216:217], v17 offset:17408
    ds_read_b64_tr_b16 v[218:219], v19 offset:17408
    ds_read_b64_tr_b16 v[220:221], v17 offset:26112
    ds_read_b64_tr_b16 v[222:223], v19 offset:26112
    ds_read_b64_tr_b16 v[224:225], v16 offset:34816
    ds_read_b64_tr_b16 v[226:227], v18 offset:34816
    ds_read_b64_tr_b16 v[228:229], v16 offset:43520
    ds_read_b64_tr_b16 v[230:231], v18 offset:43520
    ds_read_b64_tr_b16 v[232:233], v16 offset:52224
    ds_read_b64_tr_b16 v[234:235], v18 offset:52224
    ds_read_b64_tr_b16 v[236:237], v16 offset:60928
    ds_read_b64_tr_b16 v[238:239], v18 offset:60928
    ds_read_b64_tr_b16 v[240:241], v17 offset:34816
    ds_read_b64_tr_b16 v[242:243], v19 offset:34816
    ds_read_b64_tr_b16 v[244:245], v17 offset:43520
    ds_read_b64_tr_b16 v[246:247], v19 offset:43520
    ds_read_b64_tr_b16 v[248:249], v17 offset:52224
    ds_read_b64_tr_b16 v[250:251], v19 offset:52224
    ds_read_b64_tr_b16 v[252:253], v17 offset:60928
    ds_read_b64_tr_b16 v[254:255], v19 offset:60928
    s_waitcnt lgkmcnt(0)
    s_barrier
    v_lshrrev_b32 v30, 3, v2
    v_mul_u32_u24 v30, 43690, v30
    v_add_u32 v30, 17476, v30
    v_lshlrev_b32 v10, 4, v1
    v_mov_b32 v4, s24
    v_mul_u32_u24 v4, 5120, v4
    v_add_u32 v10, v10, v4
    v_lshlrev_b32 v11, 4, v1
    v_mov_b32 v12, s24
    v_lshlrev_b32 v12, 3, v12
    v_and_b32 v4, 1, v3
    v_lshlrev_b32 v4, 2, v4
    v_add_u32 v12, v12, v4
    v_lshrrev_b32 v4, 1, v3
    v_add_u32 v12, v12, v4
    v_lshlrev_b32 v12, 6, v12
    v_lshlrev_b32 v4, 2, v2
    v_add_u32 v12, v12, v4
    v_lshlrev_b32 v13, 4, v1
    v_mov_b32 v4, s24
    v_mul_u32_u24 v4, 5120, v4
    v_add_u32 v13, v13, v4
    v_lshlrev_b32 v14, 4, v1
    v_mov_b32 v4, s24
    v_mul_u32_u24 v4, 13312, v4
    v_add_u32 v14, v14, v4
    v_add_u32 v14, 3072, v14
    v_add_u32 v15, 1024, v14
    v_lshrrev_b32 v16, 1, v3
    v_lshlrev_b32 v16, 9, v16
    v_and_b32 v4, 7, v2
    v_lshlrev_b32 v4, 6, v4
    v_add_u32 v16, v16, v4
    v_and_b32 v4, 1, v3
    v_lshlrev_b32 v4, 5, v4
    v_add_u32 v16, v16, v4
    v_lshrrev_b32 v4, 3, v2
    v_lshlrev_b32 v4, 4, v4
    v_add_u32 v16, v16, v4
    v_add_u32 v16, 10240, v16
    v_lshrrev_b32 v17, 1, v3
    v_lshlrev_b32 v17, 3, v17
    v_and_b32 v4, 1, v3
    v_add_u32 v17, v17, v4
    v_mov_b32 v4, s24
    v_lshlrev_b32 v4, 1, v4
    v_add_u32 v17, v17, v4
    v_lshlrev_b32 v17, 14, v17
    v_mov_b32 v4, s32
    v_lshlrev_b32 v4, 8, v4
    v_add_u32 v17, v17, v4
    v_lshlrev_b32 v4, 4, v2
    v_add_u32 v17, v17, v4
    v_lshrrev_b32 v22, 1, v3
    v_mov_b32 v4, s24
    v_lshlrev_b32 v4, 1, v4
    v_add_u32 v22, v22, v4
    v_add_u32 v22, 32, v22
    v_lshlrev_b32 v22, 14, v22
    v_mov_b32 v4, s32
    v_lshlrev_b32 v4, 8, v4
    v_add_u32 v22, v22, v4
    v_lshlrev_b32 v4, 4, v2
    v_add_u32 v22, v22, v4
    v_mov_b32 v184, -1
    v_mov_b32 v185, -1
    v_mov_b32 v186, -1
    v_mov_b32 v187, -1
    v_mov_b32 v4, 4
    s_mov_b32 s30, 50000
PW_140:
    buffer_load_dword v5, v4, s[20:23], 0 offen sc1
    s_waitcnt vmcnt(0)
    v_readfirstlane_b32 s46, v5
    s_cmp_lg_u32 s46, 0
    s_cbranch_scc1 PE_141
    s_sleep 2
    s_sub_u32 s30, s30, 1
    s_cmp_lg_u32 s30, 0
    s_cbranch_scc1 PW_140
    s_endpgm
PE_141:
    s_and_b32 s46, s46, 2
    s_lshl_b32 s46, s46, 12
    s_sub_u32 s47, 0, s88
    s_and_b32 s47, s47, 0x1fffff
    s_add_u32 s46, s46, s47
    s_add_u32 s46, s46, 2097152
    s_mov_b32 s31, 0
    v_min_u32 v4, 0, v1
    v_lshlrev_b32 v4, 2, v4
    s_mov_b32 s30, 50000
WF_142:
    buffer_load_dword v5, v4, s[20:23], s31 offen sc1
    s_waitcnt vmcnt(0)
    v_cmp_ne_u32 vcc, 16, v5
    s_cbranch_vccz WE_143
    s_sleep 2
    s_sub_u32 s30, s30, 1
    s_cmp_lg_u32 s30, 0
    s_cbranch_scc1 WF_142
    s_endpgm
WE_143:
    v_min_u32 v31, 19, v1
    v_mov_b32 v4, s24
    v_and_b32 v4, 1, v4
    v_mul_u32_u24 v4, 20, v4
    v_add_u32 v31, v31, v4
    v_lshlrev_b32 v31, 7, v31
    v_add_u32 v31, 1753088, v31
    s_mov_b32 s33, 0
    s_mov_b32 s48, 2
    s_mov_b32 s49, 0
    s_mov_b32 s50, 1
    s_mov_b32 s54, 69206016
VO_144:
    v_mov_b32 v72, 0
    v_mov_b32 v73, 0
    v_mov_b32 v74, 0
    v_mov_b32 v75, 0
    v_mov_b32 v76, 0
    v_mov_b32 v77, 0
    v_mov_b32 v78, 0
    v_mov_b32 v79, 0
    v_mov_b32 v80, 0
    v_mov_b32 v81, 0
    v_mov_b32 v82, 0
    v_mov_b32 v83, 0
    v_mov_b32 v84, 0
    v_mov_b32 v85, 0
    v_mov_b32 v86, 0
    v_mov_b32 v87, 0
    v_mov_b32 v88, 0
    v_mov_b32 v89, 0
    v_mov_b32 v90, 0
    v_mov_b32 v91, 0
    v_mov_b32 v92, 0
    v_mov_b32 v93, 0
    v_mov_b32 v94, 0
    v_mov_b32 v95, 0
    v_mov_b32 v96, 0
    v_mov_b32 v97, 0
    v_mov_b32 v98, 0
    v_mov_b32 v99, 0
    v_mov_b32 v100, 0
    v_mov_b32 v101, 0
    v_mov_b32 v102, 0
    v_mov_b32 v103, 0
    v_mov_b32 v104, 0
    v_mov_b32 v105, 0
    v_mov_b32 v106, 0
    v_mov_b32 v107, 0
    v_mov_b32 v108, 0
    v_mov_b32 v109, 0
    v_mov_b32 v110, 0
    v_mov_b32 v111, 0
    v_mov_b32 v112, 0
    v_mov_b32 v113, 0
    v_mov_b32 v114, 0
    v_mov_b32 v115, 0
    v_mov_b32 v116, 0
    v_mov_b32 v117, 0
    v_mov_b32 v118, 0
    v_mov_b32 v119, 0
    s_and_b32 s34, s33, 3
    s_lshl_b32 s34, s34, 15
    s_add_u32 s34, s34, s46
    s_add_u32 s34, s34, 0
    s_and_b32 s36, s33, 1
    s_mul_i32 s36, s36, 655360
    s_add_u32 s36, s36, s46
    s_add_u32 s36, s36, 327680
    s_add_u32 s37, s36, 262144
    s_cmp_ge_u32 s24, 2
    s_cbranch_scc1 B1_145
    s_mov_b32 s30, 50000
PM_146:
    buffer_load_dwordx4 v[32:35], v13, s[4:7], s34 offen offset:0 sc1
    buffer_load_dwordx4 v[36:39], v13, s[4:7], s34 offen offset:1024 sc1
    buffer_load_dwordx4 v[40:43], v13, s[4:7], s34 offen offset:2048 sc1
    buffer_load_dwordx4 v[44:47], v14, s[4:7], s34 offen offset:0 sc1
    buffer_load_dwordx4 v[48:51], v15, s[4:7], s34 offen offset:0 sc1
    s_waitcnt vmcnt(4)
    ds_write_b128 v10, v[32:35] offset:0
    s_waitcnt vmcnt(3)
    ds_write_b128 v10, v[36:39] offset:1024
    s_waitcnt vmcnt(2)
    ds_write_b128 v10, v[40:43] offset:2048
    s_waitcnt vmcnt(1)
    ds_write_b128 v10, v[44:47] offset:3072
    s_waitcnt vmcnt(0)
    ds_write_b128 v10, v[48:51] offset:4096
    s_waitcnt vmcnt(0)
    v_max3_u32 v4, v32, v36, v40
    v_max3_u32 v4, v4, v44, v48
    v_cmp_eq_u32 vcc, -1, v4
    s_cbranch_vccz PO_147
    s_waitcnt lgkmcnt(0)
    s_sub_u32 s30, s30, 1
    s_cmp_lg_u32 s30, 0
    s_cbranch_scc1 PM_146
    s_endpgm
PO_147:
B1_145:
    s_waitcnt lgkmcnt(0)
    s_barrier
    ds_read_b128 v[32:35], v11 offset:0
    ds_read_b128 v[36:39], v11 offset:1024
    ds_read_b128 v[40:43], v11 offset:2048
    ds_read_b128 v[44:47], v11 offset:3072
    ds_read_b128 v[48:51], v11 offset:4096
    ds_read_b128 v[52:55], v11 offset:5120
    ds_read_b128 v[56:59], v11 offset:6144
    ds_read_b128 v[60:63], v11 offset:7168
    ds_read_b128 v[64:67], v11 offset:8192
    ds_read_b128 v[68:71], v11 offset:9216
    s_waitcnt lgkmcnt(9)
    v_smfmac_f32_16x16x64_bf16 v[72:75], v[32:35], a[0:7], v30
    v_smfmac_f32_16x16x64_bf16 v[76:79], v[32:35], a[80:87], v30
    s_waitcnt lgkmcnt(8)
    v_smfmac_f32_16x16x64_bf16 v[72:75], v[36:39], a[8:15], v30
    v_smfmac_f32_16x16x64_bf16 v[76:79], v[36:39], a[88:95], v30
    s_waitcnt lgkmcnt(7)
    v_smfmac_f32_16x16x64_bf16 v[72:75], v[40:43], a[16:23], v30
    v_smfmac_f32_16x16x64_bf16 v[76:79], v[40:43], a[96:103], v30
    s_waitcnt lgkmcnt(6)
    v_smfmac_f32_16x16x64_bf16 v[72:75], v[44:47], a[24:31], v30
    v_smfmac_f32_16x16x64_bf16 v[76:79], v[44:47], a[104:111], v30
    s_waitcnt lgkmcnt(5)
    v_smfmac_f32_16x16x64_bf16 v[72:75], v[48:51], a[32:39], v30
    v_smfmac_f32_16x16x64_bf16 v[76:79], v[48:51], a[112:119], v30
    s_waitcnt lgkmcnt(4)
    v_smfmac_f32_16x16x64_bf16 v[72:75], v[52:55], a[40:47], v30
    v_smfmac_f32_16x16x64_bf16 v[76:79], v[52:55], a[120:127], v30
    s_waitcnt lgkmcnt(3)
    v_smfmac_f32_16x16x64_bf16 v[72:75], v[56:59], a[48:55], v30
    v_smfmac_f32_16x16x64_bf16 v[76:79], v[56:59], a[128:135], v30
    s_waitcnt lgkmcnt(2)
    v_smfmac_f32_16x16x64_bf16 v[72:75], v[60:63], a[56:63], v30
    v_smfmac_f32_16x16x64_bf16 v[76:79], v[60:63], a[136:143], v30
    s_waitcnt lgkmcnt(1)
    v_smfmac_f32_16x16x64_bf16 v[72:75], v[64:67], a[64:71], v30
    v_smfmac_f32_16x16x64_bf16 v[76:79], v[64:67], a[144:151], v30
    s_waitcnt lgkmcnt(0)
    v_smfmac_f32_16x16x64_bf16 v[72:75], v[68:71], a[72:79], v30
    v_smfmac_f32_16x16x64_bf16 v[76:79], v[68:71], a[152:159], v30
    s_nop 6
    v_permlane32_swap_b32 v72, v73
    v_permlane32_swap_b32 v74, v75
    v_permlane32_swap_b32 v76, v77
    v_permlane32_swap_b32 v78, v79
    v_add_f32 v72, v72, v73
    v_add_f32 v74, v74, v75
    v_add_f32 v76, v76, v77
    v_add_f32 v78, v78, v79
    v_cvt_pk_bf16_f32 v4, v72, v76
    v_cvt_pk_bf16_f32 v5, v74, v78
    ds_write_b32 v12, v4 offset:10240
    ds_write_b32 v12, v5 offset:10368
    s_waitcnt lgkmcnt(0)
    s_barrier
    ds_read_b128 v[32:35], v16
    ds_read_b128 v[36:39], v16 offset:1024
    s_waitcnt lgkmcnt(0)
    v_smfmac_f32_16x16x64_bf16 v[80:83], v[32:35], a[160:167], v30
    v_smfmac_f32_16x16x64_bf16 v[84:87], v[32:35], a[176:183], v30
    v_smfmac_f32_16x16x64_bf16 v[88:91], v[32:35], a[192:199], v30
    v_smfmac_f32_16x16x64_bf16 v[92:95], v[32:35], a[208:215], v30
    v_smfmac_f32_16x16x64_bf16 v[80:83], v[36:39], a[168:175], v30
    v_smfmac_f32_16x16x64_bf16 v[84:87], v[36:39], a[184:191], v30
    v_smfmac_f32_16x16x64_bf16 v[88:91], v[36:39], a[200:207], v30
    v_smfmac_f32_16x16x64_bf16 v[92:95], v[36:39], a[216:223], v30
    v_smfmac_f32_16x16x64_bf16 v[96:99], v[32:35], a[224:231], v30
    v_smfmac_f32_16x16x64_bf16 v[100:103], v[32:35], a[240:247], v30
    s_nop 4
    v_permlane32_swap_b32 v80, v88
    v_permlane32_swap_b32 v81, v89
    v_permlane32_swap_b32 v82, v90
    v_smfmac_f32_16x16x64_bf16 v[104:107], v[32:35], v[192:199], v30
    v_permlane32_swap_b32 v83, v91
    v_permlane32_swap_b32 v84, v92
    v_permlane32_swap_b32 v85, v93
    v_smfmac_f32_16x16x64_bf16 v[108:111], v[32:35], v[208:215], v30
    v_permlane32_swap_b32 v86, v94
    v_permlane32_swap_b32 v87, v95
    v_add_f32 v80, v80, v88
    v_smfmac_f32_16x16x64_bf16 v[96:99], v[36:39], a[232:239], v30
    v_add_f32 v81, v81, v89
    v_add_f32 v82, v82, v90
    v_add_f32 v83, v83, v91
    v_smfmac_f32_16x16x64_bf16 v[100:103], v[36:39], a[248:255], v30
    v_add_f32 v84, v84, v92
    v_add_f32 v85, v85, v93
    v_add_f32 v86, v86, v94
    v_smfmac_f32_16x16x64_bf16 v[104:107], v[36:39], v[200:207], v30
    v_add_f32 v87, v87, v95
    v_cvt_pk_bf16_f32 v40, v80, v81
    v_cvt_pk_bf16_f32 v41, v82, v83
    v_smfmac_f32_16x16x64_bf16 v[108:111], v[36:39], v[216:223], v30
    v_cvt_pk_bf16_f32 v42, v84, v85
    v_cvt_pk_bf16_f32 v43, v86, v87
    s_nop 0
    v_permlane16_swap_b32 v40, v42
    v_permlane16_swap_b32 v41, v43
    v_min_u32 v40, -2, v40
    buffer_store_dwordx4 v[40:43], v17, s[4:7], s36 offen sc1
    v_smfmac_f32_16x16x64_bf16 v[112:115], v[32:35], v[224:231], v30
    v_smfmac_f32_16x16x64_bf16 v[116:119], v[32:35], v[240:247], v30
    v_permlane32_swap_b32 v96, v104
    v_permlane32_swap_b32 v97, v105
    v_permlane32_swap_b32 v98, v106
    v_smfmac_f32_16x16x64_bf16 v[112:115], v[36:39], v[232:239], v30
    v_permlane32_swap_b32 v99, v107
    v_permlane32_swap_b32 v100, v108
    v_permlane32_swap_b32 v101, v109
    v_smfmac_f32_16x16x64_bf16 v[116:119], v[36:39], v[248:255], v30
    v_permlane32_swap_b32 v102, v110
    v_permlane32_swap_b32 v103, v111
    v_add_f32 v96, v96, v104
    v_add_f32 v97, v97, v105
    v_add_f32 v98, v98, v106
    v_add_f32 v99, v99, v107
    v_add_f32 v100, v100, v108
    v_add_f32 v101, v101, v109
    v_add_f32 v102, v102, v110
    v_add_f32 v103, v103, v111
    v_cvt_pk_bf16_f32 v44, v96, v97
    v_cvt_pk_bf16_f32 v45, v98, v99
    v_cvt_pk_bf16_f32 v46, v100, v101
    v_cvt_pk_bf16_f32 v47, v102, v103
    s_nop 0
    v_permlane16_swap_b32 v44, v46
    v_permlane16_swap_b32 v45, v47
    v_min_u32 v44, -2, v44
    buffer_store_dwordx4 v[44:47], v17, s[4:7], s37 offen sc1
    v_permlane32_swap_b32 v112, v116
    v_permlane32_swap_b32 v113, v117
    v_permlane32_swap_b32 v114, v118
    v_permlane32_swap_b32 v115, v119
    v_add_f32 v112, v112, v116
    v_add_f32 v113, v113, v117
    v_add_f32 v114, v114, v118
    v_add_f32 v115, v115, v119
    v_cvt_pk_bf16_f32 v48, v112, v113
    v_cvt_pk_bf16_f32 v49, v114, v115
    v_min_u32 v48, -2, v48
    s_nop 0
    v_permlane16_swap_b32 v49, v51
    v_permlane16_swap_b32 v48, v50
    s_mov_b32 exec_lo, 0xffff
    s_mov_b32 exec_hi, 0xffff
    buffer_store_dwordx4 v[48:51], v22, s[4:7], s36 offen sc1
    s_mov_b64 exec, -1
    s_add_u32 s33, s33, 1
    s_cmp_lt_u32 s33, 64
    s_cbranch_scc1 VO_144
    s_waitcnt vmcnt(0)
EXIT:
    s_endpgm

.section .rodata,"a"
.p2align 6
.amdhsa_kernel concat_heads__softmax_full_mha__memory_aug_recurrent_mem_tr__prompt_kernel
  .amdhsa_next_free_vgpr 512
  .amdhsa_next_free_sgpr 102
  .amdhsa_accum_offset 256
  .amdhsa_group_segment_fixed_size 0
  .amdhsa_kernarg_size 104
  .amdhsa_user_sgpr_count 2
  .amdhsa_user_sgpr_kernarg_segment_ptr 1
  .amdhsa_system_sgpr_workgroup_id_x 1
.end_amdhsa_kernel
```
